```python
import torch

def _softmax(x, axis=-1):
    return torch.softmax(x, dim=axis)
def _gelu(x):
    return torch.nn.functional.gelu(x, approximate="tanh")
def _silu(x):
    return torch.nn.functional.silu(x)
def _sigmoid(x):
    return torch.sigmoid(x)
def _layernorm(x, axis=-1, eps=1e-5):
    m = x.mean(dim=axis, keepdim=True)
    v = x.var(dim=axis, keepdim=True, unbiased=False)
    return (x - m) / torch.sqrt(v + eps)
def _scatter_add(tgt, idx, src, axis=0):
    return tgt.clone().index_add_(axis, idx, src)
def _segment_sum(src, seg, n):
    out = torch.zeros((n,) + src.shape[1:], dtype=src.dtype)
    return out.index_add_(0, seg, src)
def _pad(x, pw):
    flat = tuple(v for pair in reversed(pw) for v in pair)
    return torch.nn.functional.pad(x, flat)

kernel_name = 'recurrent_scan__sliding_block__dense_activation_squared_relu__prompt'

def setup_inputs():

    _w = (lambda a: (lambda t: t.to(torch.bfloat16) if t.is_floating_point() else t)(torch.as_tensor(a)))
    def _A_setup():
        B, S, D = 1, 2048, 640
        return {
            "x": _w((lambda *s: torch.randn(*s, dtype=torch.bfloat16) * 0.05)(B, S, D)),
            "wqkv": _w((lambda *s: torch.randn(*s, dtype=torch.bfloat16) * 0.05)(D, 3 * D)),
            "wo": _w((lambda *s: torch.randn(*s, dtype=torch.bfloat16) * 0.05)(D, D)),
        }
    _A_in = _A_setup()

    def _B_setup():
        B, S, D, F = 1, 2048, 640, 1536
        return {
            "x": _w((lambda *s: torch.randn(*s, dtype=torch.bfloat16) * 0.05)(B, S, D)),
            "w1": _w((lambda *s: torch.randn(*s, dtype=torch.bfloat16) * 0.05)(D, F)),
            "b1": _w((lambda *s: torch.randn(*s, dtype=torch.bfloat16) * 0.4)(F)),
            "w2": _w((lambda *s: torch.randn(*s, dtype=torch.bfloat16) * 0.05)(F, D)),
            "b2": _w((lambda *s: torch.randn(*s, dtype=torch.bfloat16) * 0.8)(D)),
        }
    _B_in = _B_setup()

    return {
        "A_x": _A_in["x"],
        "A_wqkv": _A_in["wqkv"],
        "A_wo": _A_in["wo"],
        "B_x": _B_in["x"],
        "B_w1": _B_in["w1"],
        "B_b1": _B_in["b1"],
        "B_w2": _B_in["w2"],
        "B_b2": _B_in["b2"],
    }

def reference(A_x, A_wqkv, A_wo, B_x, B_w1, B_b1, B_w2, B_b2):
    def _A_ref(x, wqkv, wo):
        B, S, D = x.shape
        H = 32; Dh = D // H; W = 256
        qkv = (lambda x, *d: x.permute(*d))((x @ wqkv).reshape(B, S, 3, H, Dh), 2, 0, 3, 1, 4)
        q, k, v = qkv[0], qkv[1], qkv[2]
        scores = torch.einsum("bhqd,bhkd->bhqk", q, k) * (Dh ** -0.5)
        idx = torch.arange(S)
        mask = (idx[:, None] - idx[None, :] >= 0) & (idx[:, None] - idx[None, :] < W)
        scores = torch.where(mask[None, None], scores, -1e9)
        p = _softmax(scores, axis=-1)
        o = torch.einsum("bhqk,bhkd->bhqd", p, v)
        return (lambda x, *d: x.permute(*d))(o, 0, 2, 1, 3).reshape(B, S, D) @ wo

    def _B_ref(x, w1, b1, w2, b2):
        h = torch.einsum("bsd,df->bsf", x, w1) + b1
        zero = torch.zeros_like(h)
        r = torch.where(h > zero, h, zero)
        h = r * r
        out = torch.einsum("bsf,fd->bsd", h, w2) + b2
        return out

    x = A_x
    xn = _layernorm(x, axis=-1)
    s = _A_ref(xn, A_wqkv, A_wo)
    g = _silu(_B_ref(xn, B_w1, B_b1, B_w2, B_b2))
    return x + s * g
```

```asm
; @launch kernel=k1_kernel grid=(256,1,1) block=(256,1,1) lds=143360
; @launch kernel=k2_kernel grid=(256,1,1) block=(512,1,1) lds=163840
.amdgcn_target "amdgcn-amd-amdhsa--gfx950"
.text
.globl k1_kernel
.p2align 8
.type k1_kernel,@function
k1_kernel:
    s_cmp_ge_u32 s2, 256
    s_cbranch_scc1 K1_END
    s_load_dwordx16 s[4:19], s[0:1], 0
    s_load_dwordx4 s[20:23], s[0:1], 64
    s_load_dwordx2 s[24:25], s[0:1], 80
    v_and_b32 v1, 63, v0
    v_lshrrev_b32 v2, 6, v0
    s_nop 0
    v_readfirstlane_b32 s26, v2
    s_getpc_b64 s[90:91]
K1_PC:
    v_lshlrev_b32 v125, 7, v0
    v_min_u32 v126, K2_END-K1_PC, v125
    global_load_dword v124, v126, s[90:91]
    v_add_u32 v125, 0x8000, v125
    v_min_u32 v126, K2_END-K1_PC, v125
    global_load_dword v124, v126, s[90:91]
    v_add_u32 v125, 0x8000, v125
    v_min_u32 v126, K2_END-K1_PC, v125
    global_load_dword v124, v126, s[90:91]
    s_and_b32 s27, s2, 7
    s_lshr_b32 s3, s2, 3
    s_and_b32 s36, s27, 1
    s_lshl_b32 s36, s36, 3
    s_and_b32 s37, s3, 7
    s_add_u32 s36, s36, s37
    s_lshr_b32 s37, s27, 1
    s_lshl_b32 s37, s37, 2
    s_lshr_b32 s3, s3, 3
    s_add_u32 s37, s37, s3
    s_lshl_b32 s59, s36, 2
    s_add_u32 s59, s59, s26
    v_lshrrev_b32 v2, 3, v1
    v_and_b32 v3, 7, v1
    s_lshl_b32 s3, s59, 5
    v_add_u32 v4, 0, v2
    v_bfe_u32 v5, v4, 1, 3
    v_xor_b32 v5, v3, v5
    v_add_u32 v4, s3, v4
    v_mul_u32_u24 v4, 1280, v4
    v_lshl_add_u32 v8, v5, 4, v4
    v_add_u32 v4, 8, v2
    v_bfe_u32 v5, v4, 1, 3
    v_xor_b32 v5, v3, v5
    v_add_u32 v4, s3, v4
    v_mul_u32_u24 v4, 1280, v4
    v_lshl_add_u32 v9, v5, 4, v4
    v_add_u32 v4, 16, v2
    v_bfe_u32 v5, v4, 1, 3
    v_xor_b32 v5, v3, v5
    v_add_u32 v4, s3, v4
    v_mul_u32_u24 v4, 1280, v4
    v_lshl_add_u32 v10, v5, 4, v4
    v_add_u32 v4, 24, v2
    v_bfe_u32 v5, v4, 1, 3
    v_xor_b32 v5, v3, v5
    v_add_u32 v4, s3, v4
    v_mul_u32_u24 v4, 1280, v4
    v_lshl_add_u32 v11, v5, 4, v4
    v_and_b32 v2, 15, v1
    v_lshrrev_b32 v3, 4, v1
    v_lshrrev_b32 v4, 1, v2
    v_xor_b32 v4, v3, v4
    v_xor_b32 v5, 4, v4
    s_lshl_b32 s3, s26, 12
    s_add_u32 s74, s3, 30720
    v_lshlrev_b32 v2, 7, v2
    s_lshr_b32 s3, s26, 1
    s_lshl_b32 s3, s3, 13
    s_add_u32 s3, s3, 30720
    v_add_u32 v2, s3, v2
    v_lshl_add_u32 v24, v4, 4, v2
    v_lshl_add_u32 v25, v5, 4, v2
    s_waitcnt lgkmcnt(0)
    s_mov_b32 s28, s4
    s_mov_b32 s29, s5
    s_mov_b32 s30, 0x280000
    s_mov_b32 s31, 0x00020000
    s_cmp_lg_u32 s2, 255
    s_cbranch_scc1 K1_NZ_1
    s_add_u32 s32, s24, 0x2200000
    s_addc_u32 s33, s25, 0
    s_mov_b32 s34, 0x1000
    s_mov_b32 s35, 0x00020000
    s_lshl_b32 s3, s26, 10
    v_lshlrev_b32 v2, 4, v1
    v_add_u32 v2, s3, v2
    v_mov_b32 v4, 0
    v_mov_b32 v5, 0
    v_mov_b32 v6, 0
    v_mov_b32 v7, 0
    buffer_store_dwordx4 v[4:7], v2, s[32:35], 0 offen
    s_nop 1
K1_NZ_1:
    s_mov_b32 s42, s74
    s_movk_i32 s44, 0
    s_add_u32 m0, s42, 0
    s_nop 0
    buffer_load_dwordx4 v8, s[28:31], s44 offen lds
    s_add_u32 m0, s42, 1024
    s_nop 0
    buffer_load_dwordx4 v9, s[28:31], s44 offen lds
    s_add_u32 m0, s42, 2048
    s_nop 0
    buffer_load_dwordx4 v10, s[28:31], s44 offen lds
    s_add_u32 m0, s42, 3072
    s_nop 0
    buffer_load_dwordx4 v11, s[28:31], s44 offen lds
    s_cmp_ge_u32 s37, 8
    s_cbranch_scc1 K1_H
    s_mov_b32 s32, s6
    s_mov_b32 s33, s7
    s_mov_b32 s34, 0x258000
    s_mov_b32 s35, 0x00020000
    s_mul_i32 s38, s37, 480
    s_mov_b32 s48, s24
    s_mov_b32 s49, s25
    s_mov_b32 s50, 0xc00000
    s_mov_b32 s51, 0x00020000
    s_lshl_b32 s41, s26, 6
    s_mov_b32 s46, 3840
    v_add_u32 v2, s41, v1
    v_mul_u32_u24 v3, 2185, v2
    v_lshrrev_b32 v3, 16, v3
    v_mul_u32_u24 v4, 30, v3
    v_sub_u32 v4, v2, v4
    v_and_b32 v5, 35, v3
    v_bfe_u32 v6, v3, 4, 1
    v_lshl_or_b32 v5, v6, 2, v5
    v_bfe_u32 v6, v3, 2, 2
    v_lshl_or_b32 v5, v6, 3, v5
    v_mul_lo_u32 v5, v5, s46
    v_min_u32 v4, 29, v4
    v_lshl_add_u32 v5, v4, 4, v5
    v_add_u32 v16, s38, v5
    v_add_u32 v2, s41, v1
    v_add_u32 v2, 256, v2
    v_mul_u32_u24 v3, 2185, v2
    v_lshrrev_b32 v3, 16, v3
    v_mul_u32_u24 v4, 30, v3
    v_sub_u32 v4, v2, v4
    v_and_b32 v5, 35, v3
    v_bfe_u32 v6, v3, 4, 1
    v_lshl_or_b32 v5, v6, 2, v5
    v_bfe_u32 v6, v3, 2, 2
    v_lshl_or_b32 v5, v6, 3, v5
    v_mul_lo_u32 v5, v5, s46
    v_min_u32 v4, 29, v4
    v_lshl_add_u32 v5, v4, 4, v5
    v_add_u32 v17, s38, v5
    v_add_u32 v2, s41, v1
    v_add_u32 v2, 512, v2
    v_mul_u32_u24 v3, 2185, v2
    v_lshrrev_b32 v3, 16, v3
    v_mul_u32_u24 v4, 30, v3
    v_sub_u32 v4, v2, v4
    v_and_b32 v5, 35, v3
    v_bfe_u32 v6, v3, 4, 1
    v_lshl_or_b32 v5, v6, 2, v5
    v_bfe_u32 v6, v3, 2, 2
    v_lshl_or_b32 v5, v6, 3, v5
    v_mul_lo_u32 v5, v5, s46
    v_min_u32 v4, 29, v4
    v_lshl_add_u32 v5, v4, 4, v5
    v_add_u32 v18, s38, v5
    v_add_u32 v2, s41, v1
    v_add_u32 v2, 768, v2
    v_mul_u32_u24 v3, 2185, v2
    v_lshrrev_b32 v3, 16, v3
    v_mul_u32_u24 v4, 30, v3
    v_sub_u32 v4, v2, v4
    v_and_b32 v5, 35, v3
    v_bfe_u32 v6, v3, 4, 1
    v_lshl_or_b32 v5, v6, 2, v5
    v_bfe_u32 v6, v3, 2, 2
    v_lshl_or_b32 v5, v6, 3, v5
    v_mul_lo_u32 v5, v5, s46
    v_min_u32 v4, 29, v4
    v_lshl_add_u32 v5, v4, 4, v5
    v_add_u32 v19, s38, v5
    v_add_u32 v2, s41, v1
    v_add_u32 v2, 1024, v2
    v_mul_u32_u24 v3, 2185, v2
    v_lshrrev_b32 v3, 16, v3
    v_mul_u32_u24 v4, 30, v3
    v_sub_u32 v4, v2, v4
    v_and_b32 v5, 35, v3
    v_bfe_u32 v6, v3, 4, 1
    v_lshl_or_b32 v5, v6, 2, v5
    v_bfe_u32 v6, v3, 2, 2
    v_lshl_or_b32 v5, v6, 3, v5
    v_mul_lo_u32 v5, v5, s46
    v_min_u32 v4, 29, v4
    v_lshl_add_u32 v5, v4, 4, v5
    v_add_u32 v20, s38, v5
    v_add_u32 v2, s41, v1
    v_add_u32 v2, 1280, v2
    v_mul_u32_u24 v3, 2185, v2
    v_lshrrev_b32 v3, 16, v3
    v_mul_u32_u24 v4, 30, v3
    v_sub_u32 v4, v2, v4
    v_and_b32 v5, 35, v3
    v_bfe_u32 v6, v3, 4, 1
    v_lshl_or_b32 v5, v6, 2, v5
    v_bfe_u32 v6, v3, 2, 2
    v_lshl_or_b32 v5, v6, 3, v5
    v_mul_lo_u32 v5, v5, s46
    v_min_u32 v4, 29, v4
    v_lshl_add_u32 v5, v4, 4, v5
    v_add_u32 v21, s38, v5
    v_add_u32 v2, s41, v1
    v_add_u32 v2, 1536, v2
    v_mul_u32_u24 v3, 2185, v2
    v_lshrrev_b32 v3, 16, v3
    v_mul_u32_u24 v4, 30, v3
    v_sub_u32 v4, v2, v4
    v_and_b32 v5, 35, v3
    v_bfe_u32 v6, v3, 4, 1
    v_lshl_or_b32 v5, v6, 2, v5
    v_bfe_u32 v6, v3, 2, 2
    v_lshl_or_b32 v5, v6, 3, v5
    v_mul_lo_u32 v5, v5, s46
    v_min_u32 v4, 29, v4
    v_lshl_add_u32 v5, v4, 4, v5
    v_add_u32 v22, s38, v5
    v_add_u32 v2, s41, v1
    v_add_u32 v2, 1792, v2
    v_mul_u32_u24 v3, 2185, v2
    v_lshrrev_b32 v3, 16, v3
    v_mul_u32_u24 v4, 30, v3
    v_sub_u32 v4, v2, v4
    v_and_b32 v5, 35, v3
    v_bfe_u32 v6, v3, 4, 1
    v_lshl_or_b32 v5, v6, 2, v5
    v_bfe_u32 v6, v3, 2, 2
    v_lshl_or_b32 v5, v6, 3, v5
    v_mul_lo_u32 v5, v5, s46
    v_min_u32 v4, 29, v4
    v_lshl_add_u32 v5, v4, 4, v5
    v_add_u32 v23, s38, v5
    v_bfe_u32 v2, v1, 2, 4
    v_mul_u32_u24 v2, 480, v2
    v_and_b32 v3, 3, v1
    v_lshl_add_u32 v26, v3, 3, v2
    s_and_b32 s3, s26, 1
    s_mul_i32 s3, s3, 256
    v_add_u32 v26, s3, v26
    s_mul_i32 s47, s46, 64
    s_lshl_b32 s41, s26, 10
    s_mul_i32 s43, s47, 0
    s_add_u32 m0, s41, 0
    s_nop 0
    buffer_load_dwordx4 v16, s[32:35], s43 offen lds
    s_add_u32 m0, s41, 4096
    s_nop 0
    buffer_load_dwordx4 v17, s[32:35], s43 offen lds
    s_add_u32 m0, s41, 8192
    s_nop 0
    buffer_load_dwordx4 v18, s[32:35], s43 offen lds
    s_add_u32 m0, s41, 12288
    s_nop 0
    buffer_load_dwordx4 v19, s[32:35], s43 offen lds
    s_add_u32 m0, s41, 16384
    s_nop 0
    buffer_load_dwordx4 v20, s[32:35], s43 offen lds
    s_add_u32 m0, s41, 20480
    s_nop 0
    buffer_load_dwordx4 v21, s[32:35], s43 offen lds
    s_add_u32 m0, s41, 24576
    s_nop 0
    buffer_load_dwordx4 v22, s[32:35], s43 offen lds
    s_cmp_ge_u32 s26, 2
    s_cbranch_scc1 K1_SK_2
    s_add_u32 m0, s41, 28672
    s_nop 0
    buffer_load_dwordx4 v23, s[32:35], s43 offen lds
K1_SK_2:
    s_add_u32 s42, s74, 47104
    s_movk_i32 s44, 128
    s_add_u32 m0, s42, 0
    s_nop 0
    buffer_load_dwordx4 v8, s[28:31], s44 offen lds
    s_add_u32 m0, s42, 1024
    s_nop 0
    buffer_load_dwordx4 v9, s[28:31], s44 offen lds
    s_add_u32 m0, s42, 2048
    s_nop 0
    buffer_load_dwordx4 v10, s[28:31], s44 offen lds
    s_add_u32 m0, s42, 3072
    s_nop 0
    buffer_load_dwordx4 v11, s[28:31], s44 offen lds
    s_movk_i32 s44, 256
    s_mul_i32 s43, s47, 1
    s_add_u32 m0, s41, 47104
    s_nop 0
    buffer_load_dwordx4 v16, s[32:35], s43 offen lds
    s_add_u32 m0, s41, 51200
    s_nop 0
    buffer_load_dwordx4 v17, s[32:35], s43 offen lds
    s_add_u32 m0, s41, 55296
    s_nop 0
    buffer_load_dwordx4 v18, s[32:35], s43 offen lds
    s_add_u32 m0, s41, 59392
    s_nop 0
    buffer_load_dwordx4 v19, s[32:35], s43 offen lds
    s_add_u32 m0, s41, 63488
    s_nop 0
    buffer_load_dwordx4 v20, s[32:35], s43 offen lds
    s_add_u32 m0, s41, 67584
    s_nop 0
    buffer_load_dwordx4 v21, s[32:35], s43 offen lds
    s_add_u32 m0, s41, 71680
    s_nop 0
    buffer_load_dwordx4 v22, s[32:35], s43 offen lds
    s_cmp_ge_u32 s26, 2
    s_cbranch_scc1 K1_SK_3
    s_add_u32 m0, s41, 75776
    s_nop 0
    buffer_load_dwordx4 v23, s[32:35], s43 offen lds
K1_SK_3:
    s_lshr_b32 s60, s2, 3
    v_and_b32 v2, 31, v1
    v_lshrrev_b32 v3, 5, v1
    s_and_b32 s61, s27, 1
    s_lshl_b32 s61, s61, 10
    s_lshl_b32 s62, s60, 5
    s_add_u32 s61, s61, s62
    v_add_u32 v4, s61, v2
    v_mul_u32_u24 v4, 1280, v4
    s_lshl_b32 s62, s26, 1
    s_add_u32 s62, s62, 2
    v_add_u32 v5, s62, v3
    v_lshl_add_u32 v4, v5, 7, v4
    v_mov_b32 v126, v4
    s_mul_i32 s61, s60, 30
    v_min_u32 v2, 29, v2
    v_add_u32 v4, s61, v2
    v_mul_u32_u24 v6, 4370, v4
    v_lshrrev_b32 v6, 16, v6
    v_mul_u32_u24 v7, 15, v6
    v_sub_u32 v7, v4, v7
    v_lshl_add_u32 v6, v5, 6, v6
    v_mul_lo_u32 v6, v6, s46
    v_lshl_add_u32 v6, v7, 7, v6
    s_lshr_b32 s61, s27, 1
    s_and_b32 s61, s61, 1
    s_mul_i32 s61, s61, 1920
    v_add_u32 v6, s61, v6
    v_mov_b32 v127, v6
    s_cmp_lg_u32 s26, 0
    s_cbranch_scc1 K1_T_4
    buffer_load_dword v124, v126, s[28:31], 0 offen
    buffer_load_dword v125, v127, s[32:35], 0 offen
K1_T_4:
    v_mov_b32 v92, 0
    v_mov_b32 v93, 0
    v_mov_b32 v94, 0
    v_mov_b32 v95, 0
    v_mov_b32 v96, 0
    v_mov_b32 v97, 0
    v_mov_b32 v98, 0
    v_mov_b32 v99, 0
    v_mov_b32 v100, 0
    v_mov_b32 v101, 0
    v_mov_b32 v102, 0
    v_mov_b32 v103, 0
    v_mov_b32 v104, 0
    v_mov_b32 v105, 0
    v_mov_b32 v106, 0
    v_mov_b32 v107, 0
    v_mov_b32 v108, 0
    v_mov_b32 v109, 0
    v_mov_b32 v110, 0
    v_mov_b32 v111, 0
    v_mov_b32 v112, 0
    v_mov_b32 v113, 0
    v_mov_b32 v114, 0
    v_mov_b32 v115, 0
    v_mov_b32 v116, 0
    v_mov_b32 v117, 0
    v_mov_b32 v118, 0
    v_mov_b32 v119, 0
    v_mov_b32 v120, 0
    v_mov_b32 v121, 0
    v_mov_b32 v122, 0
    v_mov_b32 v123, 0
    v_mov_b32 v128, 0
    v_mov_b32 v129, 0
    v_mov_b32 v130, 0
    v_mov_b32 v131, 0
    v_mov_b32 v132, 0
    v_mov_b32 v133, 0
    v_mov_b32 v134, 0
    v_mov_b32 v135, 0
    v_mov_b32 v136, 0
    v_mov_b32 v137, 0
    v_mov_b32 v138, 0
    v_mov_b32 v139, 0
    v_mov_b32 v140, 0
    v_mov_b32 v141, 0
    v_mov_b32 v142, 0
    v_mov_b32 v143, 0
    v_mov_b32 v144, 0
    v_mov_b32 v145, 0
    v_mov_b32 v146, 0
    v_mov_b32 v147, 0
    v_mov_b32 v148, 0
    v_mov_b32 v149, 0
    v_mov_b32 v150, 0
    v_mov_b32 v151, 0
    v_mov_b32 v152, 0
    v_mov_b32 v153, 0
    v_mov_b32 v154, 0
    v_mov_b32 v155, 0
    v_mov_b32 v156, 0
    v_mov_b32 v157, 0
    v_mov_b32 v158, 0
    v_mov_b32 v159, 0
    v_mov_b32 v160, 0
    v_mov_b32 v161, 0
    v_mov_b32 v162, 0
    v_mov_b32 v163, 0
    v_mov_b32 v164, 0
    v_mov_b32 v165, 0
    v_mov_b32 v166, 0
    v_mov_b32 v167, 0
    v_mov_b32 v168, 0
    v_mov_b32 v169, 0
    v_mov_b32 v170, 0
    v_mov_b32 v171, 0
    v_mov_b32 v172, 0
    v_mov_b32 v173, 0
    v_mov_b32 v174, 0
    v_mov_b32 v175, 0
    v_mov_b32 v176, 0
    v_mov_b32 v177, 0
    v_mov_b32 v178, 0
    v_mov_b32 v179, 0
    v_mov_b32 v180, 0
    v_mov_b32 v181, 0
    v_mov_b32 v182, 0
    v_mov_b32 v183, 0
    v_mov_b32 v184, 0
    v_mov_b32 v185, 0
    v_mov_b32 v186, 0
    v_mov_b32 v187, 0
    v_mov_b32 v188, 0
    v_mov_b32 v189, 0
    v_mov_b32 v190, 0
    v_mov_b32 v191, 0
    v_mov_b32 v192, 0
    v_mov_b32 v193, 0
    v_mov_b32 v194, 0
    v_mov_b32 v195, 0
    v_mov_b32 v196, 0
    v_mov_b32 v197, 0
    v_mov_b32 v198, 0
    v_mov_b32 v199, 0
    v_mov_b32 v200, 0
    v_mov_b32 v201, 0
    v_mov_b32 v202, 0
    v_mov_b32 v203, 0
    v_mov_b32 v204, 0
    v_mov_b32 v205, 0
    v_mov_b32 v206, 0
    v_mov_b32 v207, 0
    v_mov_b32 v208, 0
    v_mov_b32 v209, 0
    v_mov_b32 v210, 0
    v_mov_b32 v211, 0
    v_mov_b32 v212, 0
    v_mov_b32 v213, 0
    v_mov_b32 v214, 0
    v_mov_b32 v215, 0
    v_mov_b32 v216, 0
    v_mov_b32 v217, 0
    v_mov_b32 v218, 0
    v_mov_b32 v219, 0
    v_mov_b32 v220, 0
    v_mov_b32 v221, 0
    v_mov_b32 v222, 0
    v_mov_b32 v223, 0
    v_mov_b32 v224, 0
    v_mov_b32 v225, 0
    v_mov_b32 v226, 0
    v_mov_b32 v227, 0
    v_mov_b32 v228, 0
    v_mov_b32 v229, 0
    v_mov_b32 v230, 0
    v_mov_b32 v231, 0
    v_mov_b32 v232, 0
    v_mov_b32 v233, 0
    v_mov_b32 v234, 0
    v_mov_b32 v235, 0
    v_mov_b32 v236, 0
    v_mov_b32 v237, 0
    v_mov_b32 v238, 0
    v_mov_b32 v239, 0
    v_mov_b32 v240, 0
    v_mov_b32 v241, 0
    v_mov_b32 v242, 0
    v_mov_b32 v243, 0
    v_mov_b32 v244, 0
    v_mov_b32 v245, 0
    v_mov_b32 v246, 0
    v_mov_b32 v247, 0
    v_mov_b32 v248, 0
    v_mov_b32 v249, 0
    v_mov_b32 v250, 0
    v_mov_b32 v251, 0
    v_mov_b32 v252, 0
    v_mov_b32 v253, 0
    v_mov_b32 v254, 0
    v_mov_b32 v255, 0
    v_mov_b32 v28, 0x3f803f80
    v_mov_b32 v29, 0x3f803f80
    v_mov_b32 v30, 0x3f803f80
    v_mov_b32 v31, 0x3f803f80
    s_mul_i32 s43, s47, 2
    s_cmp_eq_u32 s37, 5
    s_cbranch_scc1 K1_VB
    s_cmp_gt_u32 s37, 5
    s_cbranch_scc1 K1_VC
K1_VA:
    s_cmp_eq_u32 s26, 1
    s_cbranch_scc1 K1_VA_W1
    s_cmp_eq_u32 s26, 2
    s_cbranch_scc1 K1_VA_W2
    s_cmp_eq_u32 s26, 3
    s_cbranch_scc1 K1_VA_W3
K1_VA_W0:
    s_mov_b32 s70, 0
    s_mov_b32 s71, 47104
    s_mov_b32 s72, 94208
    v_add_u32 v27, s70, v26
    v_add_u32 v12, s71, v26
    v_add_u32 v13, s70, v24
    v_add_u32 v14, s70, v25
    v_add_u32 v15, s71, v24
    s_waitcnt vmcnt(14)
    s_barrier
    ds_read_b128 v[32:35], v13 offset:0
    ds_read_b128 v[36:39], v13 offset:2048
    ds_read_b128 v[40:43], v13 offset:4096
    ds_read_b128 v[44:47], v13 offset:6144
    ds_read_b64_tr_b16 v[64:65], v27 offset:0
    ds_read_b64_tr_b16 v[66:67], v27 offset:7680
    ds_read_b64_tr_b16 v[68:69], v27 offset:32
    ds_read_b64_tr_b16 v[70:71], v27 offset:7712
    ds_read_b64_tr_b16 v[72:73], v27 offset:64
    ds_read_b64_tr_b16 v[74:75], v27 offset:7744
    s_mov_b32 s45, 0
K1_LA0:
    s_add_u32 s42, s72, s41
    s_add_u32 s73, s72, s74
    s_waitcnt lgkmcnt(4)
    v_mfma_f32_16x16x32_bf16 v[128:131], v[64:67], v[32:35], v[128:131]
    ds_read_b64_tr_b16 v[76:77], v27 offset:96
    v_mfma_f32_16x16x32_bf16 v[132:135], v[64:67], v[36:39], v[132:135]
    ds_read_b64_tr_b16 v[78:79], v27 offset:7776
    s_add_u32 m0, s42, 0
    v_mfma_f32_16x16x32_bf16 v[136:139], v[64:67], v[40:43], v[136:139]
    buffer_load_dwordx4 v16, s[32:35], s43 offen lds
    v_mfma_f32_16x16x32_bf16 v[140:143], v[64:67], v[44:47], v[140:143]
    v_mfma_f32_16x16x32_bf16 v[108:111], v[64:67], v[28:31], v[108:111]
    v_mfma_f32_16x16x32_bf16 v[92:95], v[28:31], v[32:35], v[92:95]
    ds_read_b128 v[48:51], v14 offset:0
    ds_read_b128 v[52:55], v14 offset:2048
    ds_read_b128 v[56:59], v14 offset:4096
    ds_read_b128 v[60:63], v14 offset:6144
    s_waitcnt lgkmcnt(8)
    v_mfma_f32_16x16x32_bf16 v[144:147], v[68:71], v[32:35], v[144:147]
    ds_read_b64_tr_b16 v[64:65], v27 offset:128
    v_mfma_f32_16x16x32_bf16 v[148:151], v[68:71], v[36:39], v[148:151]
    ds_read_b64_tr_b16 v[66:67], v27 offset:7808
    s_add_u32 m0, s42, 4096
    v_mfma_f32_16x16x32_bf16 v[152:155], v[68:71], v[40:43], v[152:155]
    buffer_load_dwordx4 v17, s[32:35], s43 offen lds
    v_mfma_f32_16x16x32_bf16 v[156:159], v[68:71], v[44:47], v[156:159]
    v_mfma_f32_16x16x32_bf16 v[96:99], v[28:31], v[36:39], v[96:99]
    s_waitcnt lgkmcnt(8)
    v_mfma_f32_16x16x32_bf16 v[160:163], v[72:75], v[32:35], v[160:163]
    ds_read_b64_tr_b16 v[68:69], v27 offset:160
    v_mfma_f32_16x16x32_bf16 v[164:167], v[72:75], v[36:39], v[164:167]
    ds_read_b64_tr_b16 v[70:71], v27 offset:7840
    s_add_u32 m0, s42, 8192
    v_mfma_f32_16x16x32_bf16 v[168:171], v[72:75], v[40:43], v[168:171]
    buffer_load_dwordx4 v18, s[32:35], s43 offen lds
    v_mfma_f32_16x16x32_bf16 v[172:175], v[72:75], v[44:47], v[172:175]
    v_mfma_f32_16x16x32_bf16 v[112:115], v[72:75], v[28:31], v[112:115]
    s_waitcnt lgkmcnt(8)
    v_mfma_f32_16x16x32_bf16 v[176:179], v[76:79], v[32:35], v[176:179]
    ds_read_b64_tr_b16 v[72:73], v27 offset:192
    v_mfma_f32_16x16x32_bf16 v[180:183], v[76:79], v[36:39], v[180:183]
    ds_read_b64_tr_b16 v[74:75], v27 offset:7872
    s_add_u32 m0, s42, 12288
    v_mfma_f32_16x16x32_bf16 v[184:187], v[76:79], v[40:43], v[184:187]
    buffer_load_dwordx4 v19, s[32:35], s43 offen lds
    v_mfma_f32_16x16x32_bf16 v[188:191], v[76:79], v[44:47], v[188:191]
    s_waitcnt lgkmcnt(4)
    v_mfma_f32_16x16x32_bf16 v[192:195], v[64:67], v[32:35], v[192:195]
    ds_read_b64_tr_b16 v[76:77], v27 offset:224
    v_mfma_f32_16x16x32_bf16 v[196:199], v[64:67], v[36:39], v[196:199]
    ds_read_b64_tr_b16 v[78:79], v27 offset:7904
    s_add_u32 m0, s42, 16384
    v_mfma_f32_16x16x32_bf16 v[200:203], v[64:67], v[40:43], v[200:203]
    buffer_load_dwordx4 v20, s[32:35], s43 offen lds
    v_mfma_f32_16x16x32_bf16 v[204:207], v[64:67], v[44:47], v[204:207]
    v_mfma_f32_16x16x32_bf16 v[116:119], v[64:67], v[28:31], v[116:119]
    s_waitcnt lgkmcnt(4)
    v_mfma_f32_16x16x32_bf16 v[208:211], v[68:71], v[32:35], v[208:211]
    ds_read_b64_tr_b16 v[64:65], v27 offset:15360
    v_mfma_f32_16x16x32_bf16 v[212:215], v[68:71], v[36:39], v[212:215]
    ds_read_b64_tr_b16 v[66:67], v27 offset:23040
    s_add_u32 m0, s42, 20480
    v_mfma_f32_16x16x32_bf16 v[216:219], v[68:71], v[40:43], v[216:219]
    buffer_load_dwordx4 v21, s[32:35], s43 offen lds
    v_mfma_f32_16x16x32_bf16 v[220:223], v[68:71], v[44:47], v[220:223]
    s_waitcnt lgkmcnt(4)
    v_mfma_f32_16x16x32_bf16 v[224:227], v[72:75], v[32:35], v[224:227]
    ds_read_b64_tr_b16 v[68:69], v27 offset:15392
    v_mfma_f32_16x16x32_bf16 v[228:231], v[72:75], v[36:39], v[228:231]
    ds_read_b64_tr_b16 v[70:71], v27 offset:23072
    s_add_u32 m0, s42, 24576
    v_mfma_f32_16x16x32_bf16 v[232:235], v[72:75], v[40:43], v[232:235]
    buffer_load_dwordx4 v22, s[32:35], s43 offen lds
    v_mfma_f32_16x16x32_bf16 v[236:239], v[72:75], v[44:47], v[236:239]
    v_mfma_f32_16x16x32_bf16 v[120:123], v[72:75], v[28:31], v[120:123]
    s_waitcnt lgkmcnt(4)
    v_mfma_f32_16x16x32_bf16 v[240:243], v[76:79], v[32:35], v[240:243]
    ds_read_b64_tr_b16 v[72:73], v27 offset:15424
    v_mfma_f32_16x16x32_bf16 v[244:247], v[76:79], v[36:39], v[244:247]
    ds_read_b64_tr_b16 v[74:75], v27 offset:23104
    s_add_u32 m0, s42, 28672
    v_mfma_f32_16x16x32_bf16 v[248:251], v[76:79], v[40:43], v[248:251]
    buffer_load_dwordx4 v23, s[32:35], s43 offen lds
    v_mfma_f32_16x16x32_bf16 v[252:255], v[76:79], v[44:47], v[252:255]
    s_waitcnt lgkmcnt(4)
    v_mfma_f32_16x16x32_bf16 v[128:131], v[64:67], v[48:51], v[128:131]
    ds_read_b64_tr_b16 v[76:77], v27 offset:15456
    v_mfma_f32_16x16x32_bf16 v[132:135], v[64:67], v[52:55], v[132:135]
    ds_read_b64_tr_b16 v[78:79], v27 offset:23136
    s_add_u32 m0, s73, 0
    v_mfma_f32_16x16x32_bf16 v[136:139], v[64:67], v[56:59], v[136:139]
    buffer_load_dwordx4 v8, s[28:31], s44 offen lds
    v_mfma_f32_16x16x32_bf16 v[140:143], v[64:67], v[60:63], v[140:143]
    v_mfma_f32_16x16x32_bf16 v[108:111], v[64:67], v[28:31], v[108:111]
    v_mfma_f32_16x16x32_bf16 v[92:95], v[28:31], v[48:51], v[92:95]
    s_waitcnt lgkmcnt(4)
    v_mfma_f32_16x16x32_bf16 v[144:147], v[68:71], v[48:51], v[144:147]
    ds_read_b64_tr_b16 v[64:65], v27 offset:15488
    v_mfma_f32_16x16x32_bf16 v[148:151], v[68:71], v[52:55], v[148:151]
    ds_read_b64_tr_b16 v[66:67], v27 offset:23168
    s_add_u32 m0, s73, 1024
    v_mfma_f32_16x16x32_bf16 v[152:155], v[68:71], v[56:59], v[152:155]
    buffer_load_dwordx4 v9, s[28:31], s44 offen lds
    v_mfma_f32_16x16x32_bf16 v[156:159], v[68:71], v[60:63], v[156:159]
    v_mfma_f32_16x16x32_bf16 v[96:99], v[28:31], v[52:55], v[96:99]
    s_waitcnt lgkmcnt(4)
    v_mfma_f32_16x16x32_bf16 v[160:163], v[72:75], v[48:51], v[160:163]
    ds_read_b64_tr_b16 v[68:69], v27 offset:15520
    v_mfma_f32_16x16x32_bf16 v[164:167], v[72:75], v[52:55], v[164:167]
    ds_read_b64_tr_b16 v[70:71], v27 offset:23200
    s_add_u32 m0, s73, 2048
    v_mfma_f32_16x16x32_bf16 v[168:171], v[72:75], v[56:59], v[168:171]
    buffer_load_dwordx4 v10, s[28:31], s44 offen lds
    v_mfma_f32_16x16x32_bf16 v[172:175], v[72:75], v[60:63], v[172:175]
    v_mfma_f32_16x16x32_bf16 v[112:115], v[72:75], v[28:31], v[112:115]
    s_waitcnt lgkmcnt(4)
    v_mfma_f32_16x16x32_bf16 v[176:179], v[76:79], v[48:51], v[176:179]
    ds_read_b64_tr_b16 v[72:73], v27 offset:15552
    v_mfma_f32_16x16x32_bf16 v[180:183], v[76:79], v[52:55], v[180:183]
    ds_read_b64_tr_b16 v[74:75], v27 offset:23232
    s_add_u32 m0, s73, 3072
    v_mfma_f32_16x16x32_bf16 v[184:187], v[76:79], v[56:59], v[184:187]
    buffer_load_dwordx4 v11, s[28:31], s44 offen lds
    v_mfma_f32_16x16x32_bf16 v[188:191], v[76:79], v[60:63], v[188:191]
    s_waitcnt lgkmcnt(4)
    v_mfma_f32_16x16x32_bf16 v[192:195], v[64:67], v[48:51], v[192:195]
    ds_read_b64_tr_b16 v[76:77], v27 offset:15584
    v_mfma_f32_16x16x32_bf16 v[196:199], v[64:67], v[52:55], v[196:199]
    ds_read_b64_tr_b16 v[78:79], v27 offset:23264
    v_mfma_f32_16x16x32_bf16 v[200:203], v[64:67], v[56:59], v[200:203]
    v_mfma_f32_16x16x32_bf16 v[204:207], v[64:67], v[60:63], v[204:207]
    v_mfma_f32_16x16x32_bf16 v[116:119], v[64:67], v[28:31], v[116:119]
    s_waitcnt lgkmcnt(4)
    v_mfma_f32_16x16x32_bf16 v[208:211], v[68:71], v[48:51], v[208:211]
    v_mfma_f32_16x16x32_bf16 v[212:215], v[68:71], v[52:55], v[212:215]
    v_mfma_f32_16x16x32_bf16 v[216:219], v[68:71], v[56:59], v[216:219]
    v_mfma_f32_16x16x32_bf16 v[220:223], v[68:71], v[60:63], v[220:223]
    s_waitcnt vmcnt(12) lgkmcnt(0)
    s_barrier
    ds_read_b128 v[32:35], v15 offset:0
    ds_read_b128 v[36:39], v15 offset:2048
    ds_read_b128 v[40:43], v15 offset:4096
    ds_read_b128 v[44:47], v15 offset:6144
    v_mfma_f32_16x16x32_bf16 v[224:227], v[72:75], v[48:51], v[224:227]
    ds_read_b64_tr_b16 v[64:65], v12 offset:0
    ds_read_b64_tr_b16 v[66:67], v12 offset:7680
    v_mfma_f32_16x16x32_bf16 v[228:231], v[72:75], v[52:55], v[228:231]
    ds_read_b64_tr_b16 v[68:69], v12 offset:32
    ds_read_b64_tr_b16 v[70:71], v12 offset:7712
    v_mfma_f32_16x16x32_bf16 v[232:235], v[72:75], v[56:59], v[232:235]
    v_mfma_f32_16x16x32_bf16 v[236:239], v[72:75], v[60:63], v[236:239]
    v_mfma_f32_16x16x32_bf16 v[120:123], v[72:75], v[28:31], v[120:123]
    v_mfma_f32_16x16x32_bf16 v[240:243], v[76:79], v[48:51], v[240:243]
    ds_read_b64_tr_b16 v[72:73], v12 offset:64
    v_mfma_f32_16x16x32_bf16 v[244:247], v[76:79], v[52:55], v[244:247]
    ds_read_b64_tr_b16 v[74:75], v12 offset:7744
    v_mfma_f32_16x16x32_bf16 v[248:251], v[76:79], v[56:59], v[248:251]
    v_mfma_f32_16x16x32_bf16 v[252:255], v[76:79], v[60:63], v[252:255]
    s_add_u32 s43, s43, s47
    s_add_u32 s44, s44, 128
    s_min_u32 s44, s44, 1152
    s_mov_b32 s75, s70
    s_mov_b32 s70, s71
    s_mov_b32 s71, s72
    s_mov_b32 s72, s75
    v_add_u32 v27, s70, v26
    v_add_u32 v12, s71, v26
    v_add_u32 v13, s70, v24
    v_add_u32 v14, s70, v25
    v_add_u32 v15, s71, v24
    s_add_u32 s45, s45, 1
    s_cmp_lt_u32 s45, 10
    s_cbranch_scc1 K1_LA0
    s_waitcnt lgkmcnt(0)
    s_nop 9
    v_and_b32 v2, 15, v1
    v_lshrrev_b32 v3, 4, v1
    v_lshlrev_b32 v4, 4, v3
    v_add_u32 v4, 141312, v4
    v_cmp_eq_u32 vcc, 0, v2
    s_and_saveexec_b64 s[56:57], vcc
    ds_write_b128 v4, v[108:111] offset:0
    ds_write_b128 v4, v[112:115] offset:128
    ds_write_b128 v4, v[116:119] offset:256
    ds_write_b128 v4, v[120:123] offset:384
    s_mov_b64 exec, s[56:57]
    v_lshlrev_b32 v7, 3, v2
    v_add_u32 v7, 142336, v7
    v_cmp_eq_u32 vcc, 0, v3
    s_and_saveexec_b64 s[56:57], vcc
    ds_write_b32 v7, v92 offset:0
    ds_write_b32 v7, v96 offset:128
    s_mov_b64 exec, s[56:57]
    s_waitcnt vmcnt(0) lgkmcnt(0)
    s_barrier
    s_branch K1_EA
K1_VA_W1:
    s_mov_b32 s70, 0
    s_mov_b32 s71, 47104
    s_mov_b32 s72, 94208
    v_add_u32 v27, s70, v26
    v_add_u32 v12, s71, v26
    v_add_u32 v13, s70, v24
    v_add_u32 v14, s70, v25
    v_add_u32 v15, s71, v24
    s_waitcnt vmcnt(12)
    s_barrier
    ds_read_b128 v[32:35], v13 offset:0
    ds_read_b128 v[36:39], v13 offset:2048
    ds_read_b128 v[40:43], v13 offset:4096
    ds_read_b128 v[44:47], v13 offset:6144
    ds_read_b64_tr_b16 v[64:65], v27 offset:0
    ds_read_b64_tr_b16 v[66:67], v27 offset:7680
    ds_read_b64_tr_b16 v[68:69], v27 offset:32
    ds_read_b64_tr_b16 v[70:71], v27 offset:7712
    ds_read_b64_tr_b16 v[72:73], v27 offset:64
    ds_read_b64_tr_b16 v[74:75], v27 offset:7744
    s_mov_b32 s45, 0
K1_LA1:
    s_add_u32 s42, s72, s41
    s_add_u32 s73, s72, s74
    s_waitcnt lgkmcnt(4)
    v_mfma_f32_16x16x32_bf16 v[128:131], v[64:67], v[32:35], v[128:131]
    ds_read_b64_tr_b16 v[76:77], v27 offset:96
    v_mfma_f32_16x16x32_bf16 v[132:135], v[64:67], v[36:39], v[132:135]
    ds_read_b64_tr_b16 v[78:79], v27 offset:7776
    s_add_u32 m0, s42, 0
    v_mfma_f32_16x16x32_bf16 v[136:139], v[64:67], v[40:43], v[136:139]
    buffer_load_dwordx4 v16, s[32:35], s43 offen lds
    v_mfma_f32_16x16x32_bf16 v[140:143], v[64:67], v[44:47], v[140:143]
    v_mfma_f32_16x16x32_bf16 v[108:111], v[64:67], v[28:31], v[108:111]
    v_mfma_f32_16x16x32_bf16 v[92:95], v[32:35], v[32:35], v[92:95]
    ds_read_b128 v[48:51], v14 offset:0
    ds_read_b128 v[52:55], v14 offset:2048
    ds_read_b128 v[56:59], v14 offset:4096
    ds_read_b128 v[60:63], v14 offset:6144
    s_waitcnt lgkmcnt(8)
    v_mfma_f32_16x16x32_bf16 v[144:147], v[68:71], v[32:35], v[144:147]
    ds_read_b64_tr_b16 v[80:81], v27 offset:128
    v_mfma_f32_16x16x32_bf16 v[148:151], v[68:71], v[36:39], v[148:151]
    ds_read_b64_tr_b16 v[82:83], v27 offset:7808
    s_add_u32 m0, s42, 4096
    v_mfma_f32_16x16x32_bf16 v[152:155], v[68:71], v[40:43], v[152:155]
    buffer_load_dwordx4 v17, s[32:35], s43 offen lds
    v_mfma_f32_16x16x32_bf16 v[156:159], v[68:71], v[44:47], v[156:159]
    v_mfma_f32_16x16x32_bf16 v[96:99], v[36:39], v[36:39], v[96:99]
    s_waitcnt lgkmcnt(8)
    v_mfma_f32_16x16x32_bf16 v[160:163], v[72:75], v[32:35], v[160:163]
    ds_read_b64_tr_b16 v[84:85], v27 offset:160
    v_mfma_f32_16x16x32_bf16 v[164:167], v[72:75], v[36:39], v[164:167]
    ds_read_b64_tr_b16 v[86:87], v27 offset:7840
    s_add_u32 m0, s42, 8192
    v_mfma_f32_16x16x32_bf16 v[168:171], v[72:75], v[40:43], v[168:171]
    buffer_load_dwordx4 v18, s[32:35], s43 offen lds
    v_mfma_f32_16x16x32_bf16 v[172:175], v[72:75], v[44:47], v[172:175]
    v_mfma_f32_16x16x32_bf16 v[112:115], v[72:75], v[28:31], v[112:115]
    v_mfma_f32_16x16x32_bf16 v[100:103], v[40:43], v[40:43], v[100:103]
    s_waitcnt lgkmcnt(8)
    v_mfma_f32_16x16x32_bf16 v[176:179], v[76:79], v[32:35], v[176:179]
    ds_read_b64_tr_b16 v[88:89], v27 offset:192
    v_mfma_f32_16x16x32_bf16 v[180:183], v[76:79], v[36:39], v[180:183]
    ds_read_b64_tr_b16 v[90:91], v27 offset:7872
    s_add_u32 m0, s42, 12288
    v_mfma_f32_16x16x32_bf16 v[184:187], v[76:79], v[40:43], v[184:187]
    buffer_load_dwordx4 v19, s[32:35], s43 offen lds
    v_mfma_f32_16x16x32_bf16 v[188:191], v[76:79], v[44:47], v[188:191]
    v_mfma_f32_16x16x32_bf16 v[104:107], v[44:47], v[44:47], v[104:107]
    s_waitcnt lgkmcnt(4)
    v_mfma_f32_16x16x32_bf16 v[192:195], v[80:83], v[32:35], v[192:195]
    ds_read_b64_tr_b16 v[64:65], v27 offset:15360
    v_mfma_f32_16x16x32_bf16 v[196:199], v[80:83], v[36:39], v[196:199]
    ds_read_b64_tr_b16 v[66:67], v27 offset:23040
    s_add_u32 m0, s42, 16384
    v_mfma_f32_16x16x32_bf16 v[200:203], v[80:83], v[40:43], v[200:203]
    buffer_load_dwordx4 v20, s[32:35], s43 offen lds
    v_mfma_f32_16x16x32_bf16 v[204:207], v[80:83], v[44:47], v[204:207]
    v_mfma_f32_16x16x32_bf16 v[116:119], v[80:83], v[28:31], v[116:119]
    v_mfma_f32_16x16x32_bf16 v[240:243], v[28:31], v[40:43], v[240:243]
    s_waitcnt lgkmcnt(4)
    v_mfma_f32_16x16x32_bf16 v[208:211], v[84:87], v[32:35], v[208:211]
    ds_read_b64_tr_b16 v[68:69], v27 offset:15392
    v_mfma_f32_16x16x32_bf16 v[212:215], v[84:87], v[36:39], v[212:215]
    ds_read_b64_tr_b16 v[70:71], v27 offset:23072
    s_add_u32 m0, s42, 20480
    v_mfma_f32_16x16x32_bf16 v[216:219], v[84:87], v[40:43], v[216:219]
    buffer_load_dwordx4 v21, s[32:35], s43 offen lds
    v_mfma_f32_16x16x32_bf16 v[220:223], v[84:87], v[44:47], v[220:223]
    v_mfma_f32_16x16x32_bf16 v[244:247], v[28:31], v[44:47], v[244:247]
    s_waitcnt lgkmcnt(4)
    v_mfma_f32_16x16x32_bf16 v[224:227], v[88:91], v[32:35], v[224:227]
    ds_read_b64_tr_b16 v[72:73], v27 offset:15424
    v_mfma_f32_16x16x32_bf16 v[228:231], v[88:91], v[36:39], v[228:231]
    ds_read_b64_tr_b16 v[74:75], v27 offset:23104
    s_add_u32 m0, s42, 24576
    v_mfma_f32_16x16x32_bf16 v[232:235], v[88:91], v[40:43], v[232:235]
    buffer_load_dwordx4 v22, s[32:35], s43 offen lds
    v_mfma_f32_16x16x32_bf16 v[236:239], v[88:91], v[44:47], v[236:239]
    v_mfma_f32_16x16x32_bf16 v[120:123], v[88:91], v[28:31], v[120:123]
    s_waitcnt lgkmcnt(4)
    v_mfma_f32_16x16x32_bf16 v[128:131], v[64:67], v[48:51], v[128:131]
    ds_read_b64_tr_b16 v[76:77], v27 offset:15456
    v_mfma_f32_16x16x32_bf16 v[132:135], v[64:67], v[52:55], v[132:135]
    ds_read_b64_tr_b16 v[78:79], v27 offset:23136
    s_add_u32 m0, s42, 28672
    v_mfma_f32_16x16x32_bf16 v[136:139], v[64:67], v[56:59], v[136:139]
    buffer_load_dwordx4 v23, s[32:35], s43 offen lds
    v_mfma_f32_16x16x32_bf16 v[140:143], v[64:67], v[60:63], v[140:143]
    v_mfma_f32_16x16x32_bf16 v[108:111], v[64:67], v[28:31], v[108:111]
    v_mfma_f32_16x16x32_bf16 v[92:95], v[48:51], v[48:51], v[92:95]
    s_waitcnt lgkmcnt(4)
    v_mfma_f32_16x16x32_bf16 v[144:147], v[68:71], v[48:51], v[144:147]
    ds_read_b64_tr_b16 v[80:81], v27 offset:15488
    v_mfma_f32_16x16x32_bf16 v[148:151], v[68:71], v[52:55], v[148:151]
    ds_read_b64_tr_b16 v[82:83], v27 offset:23168
    s_add_u32 m0, s73, 0
    v_mfma_f32_16x16x32_bf16 v[152:155], v[68:71], v[56:59], v[152:155]
    buffer_load_dwordx4 v8, s[28:31], s44 offen lds
    v_mfma_f32_16x16x32_bf16 v[156:159], v[68:71], v[60:63], v[156:159]
    v_mfma_f32_16x16x32_bf16 v[96:99], v[52:55], v[52:55], v[96:99]
    s_waitcnt lgkmcnt(4)
    v_mfma_f32_16x16x32_bf16 v[160:163], v[72:75], v[48:51], v[160:163]
    ds_read_b64_tr_b16 v[84:85], v27 offset:15520
    v_mfma_f32_16x16x32_bf16 v[164:167], v[72:75], v[52:55], v[164:167]
    ds_read_b64_tr_b16 v[86:87], v27 offset:23200
    s_add_u32 m0, s73, 1024
    v_mfma_f32_16x16x32_bf16 v[168:171], v[72:75], v[56:59], v[168:171]
    buffer_load_dwordx4 v9, s[28:31], s44 offen lds
    v_mfma_f32_16x16x32_bf16 v[172:175], v[72:75], v[60:63], v[172:175]
    v_mfma_f32_16x16x32_bf16 v[112:115], v[72:75], v[28:31], v[112:115]
    v_mfma_f32_16x16x32_bf16 v[100:103], v[56:59], v[56:59], v[100:103]
    s_waitcnt lgkmcnt(4)
    v_mfma_f32_16x16x32_bf16 v[176:179], v[76:79], v[48:51], v[176:179]
    ds_read_b64_tr_b16 v[88:89], v27 offset:15552
    v_mfma_f32_16x16x32_bf16 v[180:183], v[76:79], v[52:55], v[180:183]
    ds_read_b64_tr_b16 v[90:91], v27 offset:23232
    s_add_u32 m0, s73, 2048
    v_mfma_f32_16x16x32_bf16 v[184:187], v[76:79], v[56:59], v[184:187]
    buffer_load_dwordx4 v10, s[28:31], s44 offen lds
    v_mfma_f32_16x16x32_bf16 v[188:191], v[76:79], v[60:63], v[188:191]
    v_mfma_f32_16x16x32_bf16 v[104:107], v[60:63], v[60:63], v[104:107]
    s_waitcnt lgkmcnt(4)
    v_mfma_f32_16x16x32_bf16 v[192:195], v[80:83], v[48:51], v[192:195]
    v_mfma_f32_16x16x32_bf16 v[196:199], v[80:83], v[52:55], v[196:199]
    s_add_u32 m0, s73, 3072
    v_mfma_f32_16x16x32_bf16 v[200:203], v[80:83], v[56:59], v[200:203]
    buffer_load_dwordx4 v11, s[28:31], s44 offen lds
    s_cmp_lg_u32 s45, 0
    s_cbranch_scc1 K1_T_5
    buffer_load_dword v124, v126, s[28:31], 0 offen
    buffer_load_dword v125, v127, s[32:35], 0 offen
K1_T_5:
    v_mfma_f32_16x16x32_bf16 v[204:207], v[80:83], v[60:63], v[204:207]
    v_mfma_f32_16x16x32_bf16 v[116:119], v[80:83], v[28:31], v[116:119]
    v_mfma_f32_16x16x32_bf16 v[240:243], v[28:31], v[56:59], v[240:243]
    s_waitcnt vmcnt(12) lgkmcnt(0)
    s_barrier
    ds_read_b128 v[32:35], v15 offset:0
    ds_read_b128 v[36:39], v15 offset:2048
    ds_read_b128 v[40:43], v15 offset:4096
    ds_read_b128 v[44:47], v15 offset:6144
    v_mfma_f32_16x16x32_bf16 v[208:211], v[84:87], v[48:51], v[208:211]
    ds_read_b64_tr_b16 v[64:65], v12 offset:0
    ds_read_b64_tr_b16 v[66:67], v12 offset:7680
    v_mfma_f32_16x16x32_bf16 v[212:215], v[84:87], v[52:55], v[212:215]
    ds_read_b64_tr_b16 v[68:69], v12 offset:32
    ds_read_b64_tr_b16 v[70:71], v12 offset:7712
    v_mfma_f32_16x16x32_bf16 v[216:219], v[84:87], v[56:59], v[216:219]
    v_mfma_f32_16x16x32_bf16 v[220:223], v[84:87], v[60:63], v[220:223]
    v_mfma_f32_16x16x32_bf16 v[244:247], v[28:31], v[60:63], v[244:247]
    v_mfma_f32_16x16x32_bf16 v[224:227], v[88:91], v[48:51], v[224:227]
    ds_read_b64_tr_b16 v[72:73], v12 offset:64
    v_mfma_f32_16x16x32_bf16 v[228:231], v[88:91], v[52:55], v[228:231]
    ds_read_b64_tr_b16 v[74:75], v12 offset:7744
    v_mfma_f32_16x16x32_bf16 v[232:235], v[88:91], v[56:59], v[232:235]
    v_mfma_f32_16x16x32_bf16 v[236:239], v[88:91], v[60:63], v[236:239]
    v_mfma_f32_16x16x32_bf16 v[120:123], v[88:91], v[28:31], v[120:123]
    s_add_u32 s43, s43, s47
    s_add_u32 s44, s44, 128
    s_min_u32 s44, s44, 1152
    s_mov_b32 s75, s70
    s_mov_b32 s70, s71
    s_mov_b32 s71, s72
    s_mov_b32 s72, s75
    v_add_u32 v27, s70, v26
    v_add_u32 v12, s71, v26
    v_add_u32 v13, s70, v24
    v_add_u32 v14, s70, v25
    v_add_u32 v15, s71, v24
    s_add_u32 s45, s45, 1
    s_cmp_lt_u32 s45, 10
    s_cbranch_scc1 K1_LA1
    s_waitcnt lgkmcnt(0)
    s_nop 9
    v_and_b32 v2, 15, v1
    v_lshrrev_b32 v3, 4, v1
    v_lshlrev_b32 v4, 4, v3
    v_add_u32 v4, 141312, v4
    v_cmp_eq_u32 vcc, 0, v2
    s_and_saveexec_b64 s[56:57], vcc
    ds_write_b128 v4, v[108:111] offset:512
    ds_write_b128 v4, v[112:115] offset:640
    ds_write_b128 v4, v[116:119] offset:768
    ds_write_b128 v4, v[120:123] offset:896
    s_mov_b64 exec, s[56:57]
    v_lshlrev_b32 v7, 3, v2
    v_add_u32 v7, 142336, v7
    v_cmp_eq_u32 vcc, 0, v3
    s_and_saveexec_b64 s[56:57], vcc
    ds_write_b32 v7, v240 offset:256
    ds_write_b32 v7, v244 offset:384
    s_mov_b64 exec, s[56:57]
    v_and_b32 v5, 3, v2
    v_lshrrev_b32 v6, 2, v2
    v_cmp_eq_u32 s[62:63], 1, v5
    v_cmp_eq_u32 s[64:65], 2, v5
    v_cmp_eq_u32 s[66:67], 3, v5
    v_cmp_eq_u32 vcc, v6, v3
    s_and_saveexec_b64 s[56:57], vcc
    v_mov_b32 v8, v92
    v_cndmask_b32 v8, v8, v93, s[62:63]
    v_cndmask_b32 v8, v8, v94, s[64:65]
    v_cndmask_b32 v8, v8, v95, s[66:67]
    ds_write_b32 v7, v8 offset:4
    s_nop 0
    v_mov_b32 v8, v96
    v_cndmask_b32 v8, v8, v97, s[62:63]
    v_cndmask_b32 v8, v8, v98, s[64:65]
    v_cndmask_b32 v8, v8, v99, s[66:67]
    ds_write_b32 v7, v8 offset:132
    s_nop 0
    v_mov_b32 v8, v100
    v_cndmask_b32 v8, v8, v101, s[62:63]
    v_cndmask_b32 v8, v8, v102, s[64:65]
    v_cndmask_b32 v8, v8, v103, s[66:67]
    ds_write_b32 v7, v8 offset:260
    s_nop 0
    v_mov_b32 v8, v104
    v_cndmask_b32 v8, v8, v105, s[62:63]
    v_cndmask_b32 v8, v8, v106, s[64:65]
    v_cndmask_b32 v8, v8, v107, s[66:67]
    ds_write_b32 v7, v8 offset:388
    s_nop 0
    s_mov_b64 exec, s[56:57]
    s_waitcnt vmcnt(0) lgkmcnt(0)
    s_barrier
    s_branch K1_EA
K1_VA_W2:
    s_mov_b32 s70, 0
    s_mov_b32 s71, 47104
    s_mov_b32 s72, 94208
    v_add_u32 v27, s70, v26
    v_add_u32 v12, s71, v26
    v_add_u32 v13, s70, v24
    v_add_u32 v14, s70, v25
    v_add_u32 v15, s71, v24
    s_waitcnt vmcnt(11)
    s_barrier
    ds_read_b128 v[32:35], v13 offset:0
    ds_read_b128 v[36:39], v13 offset:2048
    ds_read_b128 v[40:43], v13 offset:4096
    ds_read_b128 v[44:47], v13 offset:6144
    ds_read_b64_tr_b16 v[64:65], v27 offset:0
    ds_read_b64_tr_b16 v[66:67], v27 offset:7680
    ds_read_b64_tr_b16 v[68:69], v27 offset:32
    ds_read_b64_tr_b16 v[70:71], v27 offset:7712
    ds_read_b64_tr_b16 v[72:73], v27 offset:64
    ds_read_b64_tr_b16 v[74:75], v27 offset:7744
    s_mov_b32 s45, 0
K1_LA2:
    s_add_u32 s42, s72, s41
    s_add_u32 s73, s72, s74
    s_waitcnt lgkmcnt(4)
    v_mfma_f32_16x16x32_bf16 v[128:131], v[64:67], v[32:35], v[128:131]
    ds_read_b64_tr_b16 v[76:77], v27 offset:96
    v_mfma_f32_16x16x32_bf16 v[132:135], v[64:67], v[36:39], v[132:135]
    ds_read_b64_tr_b16 v[78:79], v27 offset:7776
    s_add_u32 m0, s42, 0
    v_mfma_f32_16x16x32_bf16 v[136:139], v[64:67], v[40:43], v[136:139]
    buffer_load_dwordx4 v16, s[32:35], s43 offen lds
    v_mfma_f32_16x16x32_bf16 v[140:143], v[64:67], v[44:47], v[140:143]
    v_mfma_f32_16x16x32_bf16 v[92:95], v[28:31], v[32:35], v[92:95]
    ds_read_b128 v[48:51], v14 offset:0
    ds_read_b128 v[52:55], v14 offset:2048
    ds_read_b128 v[56:59], v14 offset:4096
    ds_read_b128 v[60:63], v14 offset:6144
    s_waitcnt lgkmcnt(8)
    v_mfma_f32_16x16x32_bf16 v[144:147], v[68:71], v[32:35], v[144:147]
    ds_read_b64_tr_b16 v[64:65], v27 offset:128
    v_mfma_f32_16x16x32_bf16 v[148:151], v[68:71], v[36:39], v[148:151]
    ds_read_b64_tr_b16 v[66:67], v27 offset:7808
    s_add_u32 m0, s42, 4096
    v_mfma_f32_16x16x32_bf16 v[152:155], v[68:71], v[40:43], v[152:155]
    buffer_load_dwordx4 v17, s[32:35], s43 offen lds
    v_mfma_f32_16x16x32_bf16 v[156:159], v[68:71], v[44:47], v[156:159]
    v_mfma_f32_16x16x32_bf16 v[108:111], v[68:71], v[28:31], v[108:111]
    v_mfma_f32_16x16x32_bf16 v[96:99], v[28:31], v[36:39], v[96:99]
    s_waitcnt lgkmcnt(8)
    v_mfma_f32_16x16x32_bf16 v[160:163], v[72:75], v[32:35], v[160:163]
    ds_read_b64_tr_b16 v[68:69], v27 offset:160
    v_mfma_f32_16x16x32_bf16 v[164:167], v[72:75], v[36:39], v[164:167]
    ds_read_b64_tr_b16 v[70:71], v27 offset:7840
    s_add_u32 m0, s42, 8192
    v_mfma_f32_16x16x32_bf16 v[168:171], v[72:75], v[40:43], v[168:171]
    buffer_load_dwordx4 v18, s[32:35], s43 offen lds
    v_mfma_f32_16x16x32_bf16 v[172:175], v[72:75], v[44:47], v[172:175]
    s_waitcnt lgkmcnt(8)
    v_mfma_f32_16x16x32_bf16 v[176:179], v[76:79], v[32:35], v[176:179]
    ds_read_b64_tr_b16 v[72:73], v27 offset:192
    v_mfma_f32_16x16x32_bf16 v[180:183], v[76:79], v[36:39], v[180:183]
    ds_read_b64_tr_b16 v[74:75], v27 offset:7872
    s_add_u32 m0, s42, 12288
    v_mfma_f32_16x16x32_bf16 v[184:187], v[76:79], v[40:43], v[184:187]
    buffer_load_dwordx4 v19, s[32:35], s43 offen lds
    v_mfma_f32_16x16x32_bf16 v[188:191], v[76:79], v[44:47], v[188:191]
    v_mfma_f32_16x16x32_bf16 v[112:115], v[76:79], v[28:31], v[112:115]
    s_waitcnt lgkmcnt(4)
    v_mfma_f32_16x16x32_bf16 v[192:195], v[64:67], v[32:35], v[192:195]
    ds_read_b64_tr_b16 v[76:77], v27 offset:224
    v_mfma_f32_16x16x32_bf16 v[196:199], v[64:67], v[36:39], v[196:199]
    ds_read_b64_tr_b16 v[78:79], v27 offset:7904
    s_add_u32 m0, s42, 16384
    v_mfma_f32_16x16x32_bf16 v[200:203], v[64:67], v[40:43], v[200:203]
    buffer_load_dwordx4 v20, s[32:35], s43 offen lds
    v_mfma_f32_16x16x32_bf16 v[204:207], v[64:67], v[44:47], v[204:207]
    s_waitcnt lgkmcnt(4)
    v_mfma_f32_16x16x32_bf16 v[208:211], v[68:71], v[32:35], v[208:211]
    ds_read_b64_tr_b16 v[64:65], v27 offset:15360
    v_mfma_f32_16x16x32_bf16 v[212:215], v[68:71], v[36:39], v[212:215]
    ds_read_b64_tr_b16 v[66:67], v27 offset:23040
    s_add_u32 m0, s42, 20480
    v_mfma_f32_16x16x32_bf16 v[216:219], v[68:71], v[40:43], v[216:219]
    buffer_load_dwordx4 v21, s[32:35], s43 offen lds
    v_mfma_f32_16x16x32_bf16 v[220:223], v[68:71], v[44:47], v[220:223]
    v_mfma_f32_16x16x32_bf16 v[116:119], v[68:71], v[28:31], v[116:119]
    s_waitcnt lgkmcnt(4)
    v_mfma_f32_16x16x32_bf16 v[224:227], v[72:75], v[32:35], v[224:227]
    ds_read_b64_tr_b16 v[68:69], v27 offset:15392
    v_mfma_f32_16x16x32_bf16 v[228:231], v[72:75], v[36:39], v[228:231]
    ds_read_b64_tr_b16 v[70:71], v27 offset:23072
    s_add_u32 m0, s42, 24576
    v_mfma_f32_16x16x32_bf16 v[232:235], v[72:75], v[40:43], v[232:235]
    buffer_load_dwordx4 v22, s[32:35], s43 offen lds
    v_mfma_f32_16x16x32_bf16 v[236:239], v[72:75], v[44:47], v[236:239]
    s_waitcnt lgkmcnt(4)
    v_mfma_f32_16x16x32_bf16 v[240:243], v[76:79], v[32:35], v[240:243]
    ds_read_b64_tr_b16 v[72:73], v27 offset:15424
    v_mfma_f32_16x16x32_bf16 v[244:247], v[76:79], v[36:39], v[244:247]
    ds_read_b64_tr_b16 v[74:75], v27 offset:23104
    s_add_u32 m0, s73, 0
    v_mfma_f32_16x16x32_bf16 v[248:251], v[76:79], v[40:43], v[248:251]
    buffer_load_dwordx4 v8, s[28:31], s44 offen lds
    v_mfma_f32_16x16x32_bf16 v[252:255], v[76:79], v[44:47], v[252:255]
    v_mfma_f32_16x16x32_bf16 v[120:123], v[76:79], v[28:31], v[120:123]
    s_waitcnt lgkmcnt(4)
    v_mfma_f32_16x16x32_bf16 v[128:131], v[64:67], v[48:51], v[128:131]
    ds_read_b64_tr_b16 v[76:77], v27 offset:15456
    v_mfma_f32_16x16x32_bf16 v[132:135], v[64:67], v[52:55], v[132:135]
    ds_read_b64_tr_b16 v[78:79], v27 offset:23136
    s_add_u32 m0, s73, 1024
    v_mfma_f32_16x16x32_bf16 v[136:139], v[64:67], v[56:59], v[136:139]
    buffer_load_dwordx4 v9, s[28:31], s44 offen lds
    v_mfma_f32_16x16x32_bf16 v[140:143], v[64:67], v[60:63], v[140:143]
    v_mfma_f32_16x16x32_bf16 v[92:95], v[28:31], v[48:51], v[92:95]
    s_waitcnt lgkmcnt(4)
    v_mfma_f32_16x16x32_bf16 v[144:147], v[68:71], v[48:51], v[144:147]
    ds_read_b64_tr_b16 v[64:65], v27 offset:15488
    v_mfma_f32_16x16x32_bf16 v[148:151], v[68:71], v[52:55], v[148:151]
    ds_read_b64_tr_b16 v[66:67], v27 offset:23168
    s_add_u32 m0, s73, 2048
    v_mfma_f32_16x16x32_bf16 v[152:155], v[68:71], v[56:59], v[152:155]
    buffer_load_dwordx4 v10, s[28:31], s44 offen lds
    v_mfma_f32_16x16x32_bf16 v[156:159], v[68:71], v[60:63], v[156:159]
    v_mfma_f32_16x16x32_bf16 v[108:111], v[68:71], v[28:31], v[108:111]
    v_mfma_f32_16x16x32_bf16 v[96:99], v[28:31], v[52:55], v[96:99]
    s_waitcnt lgkmcnt(4)
    v_mfma_f32_16x16x32_bf16 v[160:163], v[72:75], v[48:51], v[160:163]
    ds_read_b64_tr_b16 v[68:69], v27 offset:15520
    v_mfma_f32_16x16x32_bf16 v[164:167], v[72:75], v[52:55], v[164:167]
    ds_read_b64_tr_b16 v[70:71], v27 offset:23200
    s_add_u32 m0, s73, 3072
    v_mfma_f32_16x16x32_bf16 v[168:171], v[72:75], v[56:59], v[168:171]
    buffer_load_dwordx4 v11, s[28:31], s44 offen lds
    s_cmp_lg_u32 s45, 2
    s_cbranch_scc1 K1_T_6
    buffer_load_dword v124, v126, s[28:31], 0 offen
    buffer_load_dword v125, v127, s[32:35], 0 offen
K1_T_6:
    v_mfma_f32_16x16x32_bf16 v[172:175], v[72:75], v[60:63], v[172:175]
    s_waitcnt lgkmcnt(4)
    v_mfma_f32_16x16x32_bf16 v[176:179], v[76:79], v[48:51], v[176:179]
    ds_read_b64_tr_b16 v[72:73], v27 offset:15552
    v_mfma_f32_16x16x32_bf16 v[180:183], v[76:79], v[52:55], v[180:183]
    ds_read_b64_tr_b16 v[74:75], v27 offset:23232
    v_mfma_f32_16x16x32_bf16 v[184:187], v[76:79], v[56:59], v[184:187]
    v_mfma_f32_16x16x32_bf16 v[188:191], v[76:79], v[60:63], v[188:191]
    v_mfma_f32_16x16x32_bf16 v[112:115], v[76:79], v[28:31], v[112:115]
    s_waitcnt lgkmcnt(4)
    v_mfma_f32_16x16x32_bf16 v[192:195], v[64:67], v[48:51], v[192:195]
    ds_read_b64_tr_b16 v[76:77], v27 offset:15584
    v_mfma_f32_16x16x32_bf16 v[196:199], v[64:67], v[52:55], v[196:199]
    ds_read_b64_tr_b16 v[78:79], v27 offset:23264
    v_mfma_f32_16x16x32_bf16 v[200:203], v[64:67], v[56:59], v[200:203]
    v_mfma_f32_16x16x32_bf16 v[204:207], v[64:67], v[60:63], v[204:207]
    s_waitcnt lgkmcnt(4)
    v_mfma_f32_16x16x32_bf16 v[208:211], v[68:71], v[48:51], v[208:211]
    v_mfma_f32_16x16x32_bf16 v[212:215], v[68:71], v[52:55], v[212:215]
    v_mfma_f32_16x16x32_bf16 v[216:219], v[68:71], v[56:59], v[216:219]
    v_mfma_f32_16x16x32_bf16 v[220:223], v[68:71], v[60:63], v[220:223]
    v_mfma_f32_16x16x32_bf16 v[116:119], v[68:71], v[28:31], v[116:119]
    s_waitcnt vmcnt(11) lgkmcnt(0)
    s_barrier
    ds_read_b128 v[32:35], v15 offset:0
    ds_read_b128 v[36:39], v15 offset:2048
    ds_read_b128 v[40:43], v15 offset:4096
    ds_read_b128 v[44:47], v15 offset:6144
    v_mfma_f32_16x16x32_bf16 v[224:227], v[72:75], v[48:51], v[224:227]
    ds_read_b64_tr_b16 v[64:65], v12 offset:0
    ds_read_b64_tr_b16 v[66:67], v12 offset:7680
    v_mfma_f32_16x16x32_bf16 v[228:231], v[72:75], v[52:55], v[228:231]
    ds_read_b64_tr_b16 v[68:69], v12 offset:32
    ds_read_b64_tr_b16 v[70:71], v12 offset:7712
    v_mfma_f32_16x16x32_bf16 v[232:235], v[72:75], v[56:59], v[232:235]
    v_mfma_f32_16x16x32_bf16 v[236:239], v[72:75], v[60:63], v[236:239]
    v_mfma_f32_16x16x32_bf16 v[240:243], v[76:79], v[48:51], v[240:243]
    ds_read_b64_tr_b16 v[72:73], v12 offset:64
    v_mfma_f32_16x16x32_bf16 v[244:247], v[76:79], v[52:55], v[244:247]
    ds_read_b64_tr_b16 v[74:75], v12 offset:7744
    v_mfma_f32_16x16x32_bf16 v[248:251], v[76:79], v[56:59], v[248:251]
    v_mfma_f32_16x16x32_bf16 v[252:255], v[76:79], v[60:63], v[252:255]
    v_mfma_f32_16x16x32_bf16 v[120:123], v[76:79], v[28:31], v[120:123]
    s_add_u32 s43, s43, s47
    s_add_u32 s44, s44, 128
    s_min_u32 s44, s44, 1152
    s_mov_b32 s75, s70
    s_mov_b32 s70, s71
    s_mov_b32 s71, s72
    s_mov_b32 s72, s75
    v_add_u32 v27, s70, v26
    v_add_u32 v12, s71, v26
    v_add_u32 v13, s70, v24
    v_add_u32 v14, s70, v25
    v_add_u32 v15, s71, v24
    s_add_u32 s45, s45, 1
    s_cmp_lt_u32 s45, 10
    s_cbranch_scc1 K1_LA2
    s_waitcnt lgkmcnt(0)
    s_nop 9
    v_and_b32 v2, 15, v1
    v_lshrrev_b32 v3, 4, v1
    v_lshlrev_b32 v4, 4, v3
    v_add_u32 v4, 141312, v4
    v_cmp_eq_u32 vcc, 0, v2
    s_and_saveexec_b64 s[56:57], vcc
    ds_write_b128 v4, v[108:111] offset:64
    ds_write_b128 v4, v[112:115] offset:192
    ds_write_b128 v4, v[116:119] offset:320
    ds_write_b128 v4, v[120:123] offset:448
    s_mov_b64 exec, s[56:57]
    v_lshlrev_b32 v7, 3, v2
    v_add_u32 v7, 142848, v7
    v_cmp_eq_u32 vcc, 0, v3
    s_and_saveexec_b64 s[56:57], vcc
    ds_write_b32 v7, v92 offset:0
    ds_write_b32 v7, v96 offset:128
    s_mov_b64 exec, s[56:57]
    s_waitcnt vmcnt(0) lgkmcnt(0)
    s_barrier
    s_branch K1_EA
K1_VA_W3:
    s_mov_b32 s70, 0
    s_mov_b32 s71, 47104
    s_mov_b32 s72, 94208
    v_add_u32 v27, s70, v26
    v_add_u32 v12, s71, v26
    v_add_u32 v13, s70, v24
    v_add_u32 v14, s70, v25
    v_add_u32 v15, s71, v24
    s_waitcnt vmcnt(11)
    s_barrier
    ds_read_b128 v[32:35], v13 offset:0
    ds_read_b128 v[36:39], v13 offset:2048
    ds_read_b128 v[40:43], v13 offset:4096
    ds_read_b128 v[44:47], v13 offset:6144
    ds_read_b64_tr_b16 v[64:65], v27 offset:0
    ds_read_b64_tr_b16 v[66:67], v27 offset:7680
    ds_read_b64_tr_b16 v[68:69], v27 offset:32
    ds_read_b64_tr_b16 v[70:71], v27 offset:7712
    ds_read_b64_tr_b16 v[72:73], v27 offset:64
    ds_read_b64_tr_b16 v[74:75], v27 offset:7744
    s_mov_b32 s45, 0
K1_LA3:
    s_add_u32 s42, s72, s41
    s_add_u32 s73, s72, s74
    s_waitcnt lgkmcnt(4)
    v_mfma_f32_16x16x32_bf16 v[128:131], v[64:67], v[32:35], v[128:131]
    ds_read_b64_tr_b16 v[76:77], v27 offset:96
    v_mfma_f32_16x16x32_bf16 v[132:135], v[64:67], v[36:39], v[132:135]
    ds_read_b64_tr_b16 v[78:79], v27 offset:7776
    s_add_u32 m0, s42, 0
    v_mfma_f32_16x16x32_bf16 v[136:139], v[64:67], v[40:43], v[136:139]
    buffer_load_dwordx4 v16, s[32:35], s43 offen lds
    v_mfma_f32_16x16x32_bf16 v[140:143], v[64:67], v[44:47], v[140:143]
    v_mfma_f32_16x16x32_bf16 v[92:95], v[32:35], v[32:35], v[92:95]
    ds_read_b128 v[48:51], v14 offset:0
    ds_read_b128 v[52:55], v14 offset:2048
    ds_read_b128 v[56:59], v14 offset:4096
    ds_read_b128 v[60:63], v14 offset:6144
    s_waitcnt lgkmcnt(8)
    v_mfma_f32_16x16x32_bf16 v[144:147], v[68:71], v[32:35], v[144:147]
    ds_read_b64_tr_b16 v[80:81], v27 offset:128
    v_mfma_f32_16x16x32_bf16 v[148:151], v[68:71], v[36:39], v[148:151]
    ds_read_b64_tr_b16 v[82:83], v27 offset:7808
    s_add_u32 m0, s42, 4096
    v_mfma_f32_16x16x32_bf16 v[152:155], v[68:71], v[40:43], v[152:155]
    buffer_load_dwordx4 v17, s[32:35], s43 offen lds
    v_mfma_f32_16x16x32_bf16 v[156:159], v[68:71], v[44:47], v[156:159]
    v_mfma_f32_16x16x32_bf16 v[108:111], v[68:71], v[28:31], v[108:111]
    v_mfma_f32_16x16x32_bf16 v[96:99], v[36:39], v[36:39], v[96:99]
    s_waitcnt lgkmcnt(8)
    v_mfma_f32_16x16x32_bf16 v[160:163], v[72:75], v[32:35], v[160:163]
    ds_read_b64_tr_b16 v[84:85], v27 offset:160
    v_mfma_f32_16x16x32_bf16 v[164:167], v[72:75], v[36:39], v[164:167]
    ds_read_b64_tr_b16 v[86:87], v27 offset:7840
    s_add_u32 m0, s42, 8192
    v_mfma_f32_16x16x32_bf16 v[168:171], v[72:75], v[40:43], v[168:171]
    buffer_load_dwordx4 v18, s[32:35], s43 offen lds
    v_mfma_f32_16x16x32_bf16 v[172:175], v[72:75], v[44:47], v[172:175]
    v_mfma_f32_16x16x32_bf16 v[100:103], v[40:43], v[40:43], v[100:103]
    s_waitcnt lgkmcnt(8)
    v_mfma_f32_16x16x32_bf16 v[176:179], v[76:79], v[32:35], v[176:179]
    ds_read_b64_tr_b16 v[88:89], v27 offset:192
    v_mfma_f32_16x16x32_bf16 v[180:183], v[76:79], v[36:39], v[180:183]
    ds_read_b64_tr_b16 v[90:91], v27 offset:7872
    s_add_u32 m0, s42, 12288
    v_mfma_f32_16x16x32_bf16 v[184:187], v[76:79], v[40:43], v[184:187]
    buffer_load_dwordx4 v19, s[32:35], s43 offen lds
    v_mfma_f32_16x16x32_bf16 v[188:191], v[76:79], v[44:47], v[188:191]
    v_mfma_f32_16x16x32_bf16 v[112:115], v[76:79], v[28:31], v[112:115]
    v_mfma_f32_16x16x32_bf16 v[104:107], v[44:47], v[44:47], v[104:107]
    s_waitcnt lgkmcnt(4)
    v_mfma_f32_16x16x32_bf16 v[192:195], v[80:83], v[32:35], v[192:195]
    ds_read_b64_tr_b16 v[64:65], v27 offset:15360
    v_mfma_f32_16x16x32_bf16 v[196:199], v[80:83], v[36:39], v[196:199]
    ds_read_b64_tr_b16 v[66:67], v27 offset:23040
    s_add_u32 m0, s42, 16384
    v_mfma_f32_16x16x32_bf16 v[200:203], v[80:83], v[40:43], v[200:203]
    buffer_load_dwordx4 v20, s[32:35], s43 offen lds
    v_mfma_f32_16x16x32_bf16 v[204:207], v[80:83], v[44:47], v[204:207]
    v_mfma_f32_16x16x32_bf16 v[240:243], v[28:31], v[40:43], v[240:243]
    s_waitcnt lgkmcnt(4)
    v_mfma_f32_16x16x32_bf16 v[208:211], v[84:87], v[32:35], v[208:211]
    ds_read_b64_tr_b16 v[68:69], v27 offset:15392
    v_mfma_f32_16x16x32_bf16 v[212:215], v[84:87], v[36:39], v[212:215]
    ds_read_b64_tr_b16 v[70:71], v27 offset:23072
    s_add_u32 m0, s42, 20480
    v_mfma_f32_16x16x32_bf16 v[216:219], v[84:87], v[40:43], v[216:219]
    buffer_load_dwordx4 v21, s[32:35], s43 offen lds
    v_mfma_f32_16x16x32_bf16 v[220:223], v[84:87], v[44:47], v[220:223]
    v_mfma_f32_16x16x32_bf16 v[116:119], v[84:87], v[28:31], v[116:119]
    v_mfma_f32_16x16x32_bf16 v[244:247], v[28:31], v[44:47], v[244:247]
    s_waitcnt lgkmcnt(4)
    v_mfma_f32_16x16x32_bf16 v[224:227], v[88:91], v[32:35], v[224:227]
    ds_read_b64_tr_b16 v[72:73], v27 offset:15424
    v_mfma_f32_16x16x32_bf16 v[228:231], v[88:91], v[36:39], v[228:231]
    ds_read_b64_tr_b16 v[74:75], v27 offset:23104
    s_add_u32 m0, s42, 24576
    v_mfma_f32_16x16x32_bf16 v[232:235], v[88:91], v[40:43], v[232:235]
    buffer_load_dwordx4 v22, s[32:35], s43 offen lds
    v_mfma_f32_16x16x32_bf16 v[236:239], v[88:91], v[44:47], v[236:239]
    s_waitcnt lgkmcnt(4)
    v_mfma_f32_16x16x32_bf16 v[128:131], v[64:67], v[48:51], v[128:131]
    ds_read_b64_tr_b16 v[76:77], v27 offset:15456
    v_mfma_f32_16x16x32_bf16 v[132:135], v[64:67], v[52:55], v[132:135]
    ds_read_b64_tr_b16 v[78:79], v27 offset:23136
    s_add_u32 m0, s73, 0
    v_mfma_f32_16x16x32_bf16 v[136:139], v[64:67], v[56:59], v[136:139]
    buffer_load_dwordx4 v8, s[28:31], s44 offen lds
    v_mfma_f32_16x16x32_bf16 v[140:143], v[64:67], v[60:63], v[140:143]
    v_mfma_f32_16x16x32_bf16 v[92:95], v[48:51], v[48:51], v[92:95]
    s_waitcnt lgkmcnt(4)
    v_mfma_f32_16x16x32_bf16 v[144:147], v[68:71], v[48:51], v[144:147]
    ds_read_b64_tr_b16 v[80:81], v27 offset:15488
    v_mfma_f32_16x16x32_bf16 v[148:151], v[68:71], v[52:55], v[148:151]
    ds_read_b64_tr_b16 v[82:83], v27 offset:23168
    s_add_u32 m0, s73, 1024
    v_mfma_f32_16x16x32_bf16 v[152:155], v[68:71], v[56:59], v[152:155]
    buffer_load_dwordx4 v9, s[28:31], s44 offen lds
    v_mfma_f32_16x16x32_bf16 v[156:159], v[68:71], v[60:63], v[156:159]
    v_mfma_f32_16x16x32_bf16 v[108:111], v[68:71], v[28:31], v[108:111]
    v_mfma_f32_16x16x32_bf16 v[96:99], v[52:55], v[52:55], v[96:99]
    s_waitcnt lgkmcnt(4)
    v_mfma_f32_16x16x32_bf16 v[160:163], v[72:75], v[48:51], v[160:163]
    ds_read_b64_tr_b16 v[84:85], v27 offset:15520
    v_mfma_f32_16x16x32_bf16 v[164:167], v[72:75], v[52:55], v[164:167]
    ds_read_b64_tr_b16 v[86:87], v27 offset:23200
    s_add_u32 m0, s73, 2048
    v_mfma_f32_16x16x32_bf16 v[168:171], v[72:75], v[56:59], v[168:171]
    buffer_load_dwordx4 v10, s[28:31], s44 offen lds
    v_mfma_f32_16x16x32_bf16 v[172:175], v[72:75], v[60:63], v[172:175]
    v_mfma_f32_16x16x32_bf16 v[100:103], v[56:59], v[56:59], v[100:103]
    s_waitcnt lgkmcnt(4)
    v_mfma_f32_16x16x32_bf16 v[176:179], v[76:79], v[48:51], v[176:179]
    ds_read_b64_tr_b16 v[88:89], v27 offset:15552
    v_mfma_f32_16x16x32_bf16 v[180:183], v[76:79], v[52:55], v[180:183]
    ds_read_b64_tr_b16 v[90:91], v27 offset:23232
    s_add_u32 m0, s73, 3072
    v_mfma_f32_16x16x32_bf16 v[184:187], v[76:79], v[56:59], v[184:187]
    buffer_load_dwordx4 v11, s[28:31], s44 offen lds
    s_cmp_lg_u32 s45, 4
    s_cbranch_scc1 K1_T_7
    buffer_load_dword v124, v126, s[28:31], 0 offen
    buffer_load_dword v125, v127, s[32:35], 0 offen
K1_T_7:
    v_mfma_f32_16x16x32_bf16 v[188:191], v[76:79], v[60:63], v[188:191]
    v_mfma_f32_16x16x32_bf16 v[112:115], v[76:79], v[28:31], v[112:115]
    v_mfma_f32_16x16x32_bf16 v[104:107], v[60:63], v[60:63], v[104:107]
    s_waitcnt lgkmcnt(4)
    v_mfma_f32_16x16x32_bf16 v[192:195], v[80:83], v[48:51], v[192:195]
    v_mfma_f32_16x16x32_bf16 v[196:199], v[80:83], v[52:55], v[196:199]
    v_mfma_f32_16x16x32_bf16 v[200:203], v[80:83], v[56:59], v[200:203]
    v_mfma_f32_16x16x32_bf16 v[204:207], v[80:83], v[60:63], v[204:207]
    v_mfma_f32_16x16x32_bf16 v[240:243], v[28:31], v[56:59], v[240:243]
    s_waitcnt vmcnt(11) lgkmcnt(0)
    s_barrier
    ds_read_b128 v[32:35], v15 offset:0
    ds_read_b128 v[36:39], v15 offset:2048
    ds_read_b128 v[40:43], v15 offset:4096
    ds_read_b128 v[44:47], v15 offset:6144
    v_mfma_f32_16x16x32_bf16 v[208:211], v[84:87], v[48:51], v[208:211]
    ds_read_b64_tr_b16 v[64:65], v12 offset:0
    ds_read_b64_tr_b16 v[66:67], v12 offset:7680
    v_mfma_f32_16x16x32_bf16 v[212:215], v[84:87], v[52:55], v[212:215]
    ds_read_b64_tr_b16 v[68:69], v12 offset:32
    ds_read_b64_tr_b16 v[70:71], v12 offset:7712
    v_mfma_f32_16x16x32_bf16 v[216:219], v[84:87], v[56:59], v[216:219]
    v_mfma_f32_16x16x32_bf16 v[220:223], v[84:87], v[60:63], v[220:223]
    v_mfma_f32_16x16x32_bf16 v[116:119], v[84:87], v[28:31], v[116:119]
    v_mfma_f32_16x16x32_bf16 v[244:247], v[28:31], v[60:63], v[244:247]
    v_mfma_f32_16x16x32_bf16 v[224:227], v[88:91], v[48:51], v[224:227]
    ds_read_b64_tr_b16 v[72:73], v12 offset:64
    v_mfma_f32_16x16x32_bf16 v[228:231], v[88:91], v[52:55], v[228:231]
    ds_read_b64_tr_b16 v[74:75], v12 offset:7744
    v_mfma_f32_16x16x32_bf16 v[232:235], v[88:91], v[56:59], v[232:235]
    v_mfma_f32_16x16x32_bf16 v[236:239], v[88:91], v[60:63], v[236:239]
    s_add_u32 s43, s43, s47
    s_add_u32 s44, s44, 128
    s_min_u32 s44, s44, 1152
    s_mov_b32 s75, s70
    s_mov_b32 s70, s71
    s_mov_b32 s71, s72
    s_mov_b32 s72, s75
    v_add_u32 v27, s70, v26
    v_add_u32 v12, s71, v26
    v_add_u32 v13, s70, v24
    v_add_u32 v14, s70, v25
    v_add_u32 v15, s71, v24
    s_add_u32 s45, s45, 1
    s_cmp_lt_u32 s45, 10
    s_cbranch_scc1 K1_LA3
    s_waitcnt lgkmcnt(0)
    s_nop 9
    v_and_b32 v2, 15, v1
    v_lshrrev_b32 v3, 4, v1
    v_lshlrev_b32 v4, 4, v3
    v_add_u32 v4, 141312, v4
    v_cmp_eq_u32 vcc, 0, v2
    s_and_saveexec_b64 s[56:57], vcc
    ds_write_b128 v4, v[108:111] offset:576
    ds_write_b128 v4, v[112:115] offset:704
    ds_write_b128 v4, v[116:119] offset:832
    s_mov_b64 exec, s[56:57]
    v_lshlrev_b32 v7, 3, v2
    v_add_u32 v7, 142848, v7
    v_cmp_eq_u32 vcc, 0, v3
    s_and_saveexec_b64 s[56:57], vcc
    ds_write_b32 v7, v240 offset:256
    ds_write_b32 v7, v244 offset:384
    s_mov_b64 exec, s[56:57]
    v_and_b32 v5, 3, v2
    v_lshrrev_b32 v6, 2, v2
    v_cmp_eq_u32 s[62:63], 1, v5
    v_cmp_eq_u32 s[64:65], 2, v5
    v_cmp_eq_u32 s[66:67], 3, v5
    v_cmp_eq_u32 vcc, v6, v3
    s_and_saveexec_b64 s[56:57], vcc
    v_mov_b32 v8, v92
    v_cndmask_b32 v8, v8, v93, s[62:63]
    v_cndmask_b32 v8, v8, v94, s[64:65]
    v_cndmask_b32 v8, v8, v95, s[66:67]
    ds_write_b32 v7, v8 offset:4
    s_nop 0
    v_mov_b32 v8, v96
    v_cndmask_b32 v8, v8, v97, s[62:63]
    v_cndmask_b32 v8, v8, v98, s[64:65]
    v_cndmask_b32 v8, v8, v99, s[66:67]
    ds_write_b32 v7, v8 offset:132
    s_nop 0
    v_mov_b32 v8, v100
    v_cndmask_b32 v8, v8, v101, s[62:63]
    v_cndmask_b32 v8, v8, v102, s[64:65]
    v_cndmask_b32 v8, v8, v103, s[66:67]
    ds_write_b32 v7, v8 offset:260
    s_nop 0
    v_mov_b32 v8, v104
    v_cndmask_b32 v8, v8, v105, s[62:63]
    v_cndmask_b32 v8, v8, v106, s[64:65]
    v_cndmask_b32 v8, v8, v107, s[66:67]
    ds_write_b32 v7, v8 offset:388
    s_nop 0
    s_mov_b64 exec, s[56:57]
    s_waitcnt vmcnt(0) lgkmcnt(0)
    s_barrier
    s_branch K1_EA
K1_EA:
    v_and_b32 v2, 15, v1
    v_lshrrev_b32 v3, 4, v1
    s_cmp_ge_u32 s26, 2
    s_cbranch_scc1 K1_S2_8
    s_lshl_b32 s3, s26, 9
    s_add_u32 s3, s3, 142336
    v_lshlrev_b32 v7, 3, v1
    v_add_u32 v7, s3, v7
    ds_read_b64 v[8:9], v7
    s_waitcnt lgkmcnt(0)
    v_mul_f32 v9, 0x3acccccd, v9
    v_mul_f32 v8, 0x3acccccd, v8
    v_fma_f32 v9, -v8, v8, v9
    v_max_f32 v9, 0, v9
    v_add_f32 v9, 0x3727c5ac, v9
    v_rsq_f32 v10, v9
    s_nop 5
    v_mul_f32 v11, v8, v10
    v_sub_f32 v11, 0, v11
    ds_write_b64 v7, v[10:11]
    s_waitcnt lgkmcnt(0)
K1_S2_8:
    s_barrier
    s_lshr_b32 s58, s26, 1
    s_lshl_b32 s58, s58, 9
    s_add_u32 s58, s58, 142336
    s_and_b32 s57, s26, 1
    s_cmp_eq_u32 s57, 1
    s_cbranch_scc1 K1_EA1
    v_lshlrev_b32 v7, 3, v2
    v_add_u32 v7, s58, v7
    ds_read_b64 v[32:33], v7 offset:0
    ds_read_b64 v[34:35], v7 offset:128
    ds_read_b64 v[36:37], v7 offset:256
    ds_read_b64 v[38:39], v7 offset:384
    v_lshlrev_b32 v4, 4, v3
    v_add_u32 v4, 141312, v4
    v_lshlrev_b32 v5, 2, v2
    v_add_u32 v5, 141312, v5
    ds_read_b128 v[72:75], v4 offset:0
    ds_read_b128 v[76:79], v4 offset:64
    ds_read_b128 v[80:83], v4 offset:128
    ds_read_b128 v[84:87], v4 offset:192
    ds_read_b128 v[88:91], v4 offset:256
    ds_read_b128 v[92:95], v4 offset:320
    ds_read_b128 v[96:99], v4 offset:384
    ds_read_b128 v[100:103], v4 offset:448
    s_lshr_b32 s60, s26, 1
    s_mul_i32 s61, s60, 2560
    s_lshl_b32 s62, s60, 12
    v_add_u32 v8, 0, v3
    v_mul_u32_u24 v9, 205, v8
    v_lshrrev_b32 v9, 10, v9
    v_mul_u32_u24 v10, 5, v9
    v_sub_u32 v10, v8, v10
    v_lshrrev_b32 v11, 1, v10
    v_lshlrev_b32 v11, 9, v11
    v_cmp_eq_u32 vcc, 4, v10
    v_and_b32 v10, 1, v10
    v_lshl_or_b32 v11, v10, 3, v11
    v_lshl_add_u32 v11, v2, 4, v11
    v_lshlrev_b32 v10, 3, v2
    v_add_u32 v10, 0x400, v10
    v_cndmask_b32 v11, v11, v10, vcc
    v_lshl_add_u32 v11, v9, 13, v11
    v_add_u32 v104, s61, v11
    v_add_u32 v112, 0x100, v104
    v_add_u32 v8, 4, v3
    v_mul_u32_u24 v9, 205, v8
    v_lshrrev_b32 v9, 10, v9
    v_mul_u32_u24 v10, 5, v9
    v_sub_u32 v10, v8, v10
    v_lshrrev_b32 v11, 1, v10
    v_lshlrev_b32 v11, 9, v11
    v_cmp_eq_u32 vcc, 4, v10
    v_and_b32 v10, 1, v10
    v_lshl_or_b32 v11, v10, 3, v11
    v_lshl_add_u32 v11, v2, 4, v11
    v_lshlrev_b32 v10, 3, v2
    v_add_u32 v10, 0x400, v10
    v_cndmask_b32 v11, v11, v10, vcc
    v_lshl_add_u32 v11, v9, 13, v11
    v_add_u32 v105, s61, v11
    v_mov_b32 v10, 0x100
    v_mov_b32 v8, 0x80
    v_cndmask_b32 v10, v10, v8, vcc
    v_add_u32 v113, v10, v105
    v_add_u32 v8, 8, v3
    v_mul_u32_u24 v9, 205, v8
    v_lshrrev_b32 v9, 10, v9
    v_mul_u32_u24 v10, 5, v9
    v_sub_u32 v10, v8, v10
    v_lshrrev_b32 v11, 1, v10
    v_lshlrev_b32 v11, 9, v11
    v_cmp_eq_u32 vcc, 4, v10
    v_and_b32 v10, 1, v10
    v_lshl_or_b32 v11, v10, 3, v11
    v_lshl_add_u32 v11, v2, 4, v11
    v_lshlrev_b32 v10, 3, v2
    v_add_u32 v10, 0x400, v10
    v_cndmask_b32 v11, v11, v10, vcc
    v_lshl_add_u32 v11, v9, 13, v11
    v_add_u32 v106, s61, v11
    v_mov_b32 v10, 0x100
    v_mov_b32 v8, 0x80
    v_cndmask_b32 v10, v10, v8, vcc
    v_add_u32 v114, v10, v106
    v_add_u32 v8, 12, v3
    v_mul_u32_u24 v9, 205, v8
    v_lshrrev_b32 v9, 10, v9
    v_mul_u32_u24 v10, 5, v9
    v_sub_u32 v10, v8, v10
    v_lshrrev_b32 v11, 1, v10
    v_lshlrev_b32 v11, 9, v11
    v_cmp_eq_u32 vcc, 4, v10
    v_and_b32 v10, 1, v10
    v_lshl_or_b32 v11, v10, 3, v11
    v_lshl_add_u32 v11, v2, 4, v11
    v_lshlrev_b32 v10, 3, v2
    v_add_u32 v10, 0x400, v10
    v_cndmask_b32 v11, v11, v10, vcc
    v_lshl_add_u32 v11, v9, 13, v11
    v_add_u32 v107, s61, v11
    v_mov_b32 v10, 0x100
    v_mov_b32 v8, 0x80
    v_cndmask_b32 v10, v10, v8, vcc
    v_add_u32 v115, v10, v107
    v_add_u32 v8, 16, v3
    v_mul_u32_u24 v9, 205, v8
    v_lshrrev_b32 v9, 10, v9
    v_mul_u32_u24 v10, 5, v9
    v_sub_u32 v10, v8, v10
    v_lshrrev_b32 v11, 1, v10
    v_lshlrev_b32 v11, 9, v11
    v_cmp_eq_u32 vcc, 4, v10
    v_and_b32 v10, 1, v10
    v_lshl_or_b32 v11, v10, 3, v11
    v_lshl_add_u32 v11, v2, 4, v11
    v_lshlrev_b32 v10, 3, v2
    v_add_u32 v10, 0x400, v10
    v_cndmask_b32 v11, v11, v10, vcc
    v_lshl_add_u32 v11, v9, 13, v11
    v_add_u32 v108, s61, v11
    v_mov_b32 v10, 0x100
    v_mov_b32 v8, 0x80
    v_cndmask_b32 v10, v10, v8, vcc
    v_add_u32 v116, v10, v108
    v_add_u32 v8, 20, v3
    v_mul_u32_u24 v9, 205, v8
    v_lshrrev_b32 v9, 10, v9
    v_mul_u32_u24 v10, 5, v9
    v_sub_u32 v10, v8, v10
    v_lshrrev_b32 v11, 1, v10
    v_lshlrev_b32 v11, 9, v11
    v_cmp_eq_u32 vcc, 4, v10
    v_and_b32 v10, 1, v10
    v_lshl_or_b32 v11, v10, 3, v11
    v_lshl_add_u32 v11, v2, 4, v11
    v_lshlrev_b32 v10, 3, v2
    v_add_u32 v10, 0x400, v10
    v_cndmask_b32 v11, v11, v10, vcc
    v_lshl_add_u32 v11, v9, 13, v11
    v_add_u32 v109, s61, v11
    v_add_u32 v117, 0x100, v109
    v_add_u32 v8, 24, v3
    v_mul_u32_u24 v9, 205, v8
    v_lshrrev_b32 v9, 10, v9
    v_mul_u32_u24 v10, 5, v9
    v_sub_u32 v10, v8, v10
    v_lshrrev_b32 v11, 1, v10
    v_lshlrev_b32 v11, 9, v11
    v_cmp_eq_u32 vcc, 4, v10
    v_and_b32 v10, 1, v10
    v_lshl_or_b32 v11, v10, 3, v11
    v_lshl_add_u32 v11, v2, 4, v11
    v_lshlrev_b32 v10, 3, v2
    v_add_u32 v10, 0x400, v10
    v_cndmask_b32 v11, v11, v10, vcc
    v_lshl_add_u32 v11, v9, 13, v11
    v_add_u32 v110, s61, v11
    v_mov_b32 v10, 0x100
    v_mov_b32 v8, 0x80
    v_cndmask_b32 v10, v10, v8, vcc
    v_add_u32 v118, v10, v110
    v_add_u32 v8, 28, v3
    v_mul_u32_u24 v9, 205, v8
    v_lshrrev_b32 v9, 10, v9
    v_mul_u32_u24 v10, 5, v9
    v_sub_u32 v10, v8, v10
    v_lshrrev_b32 v11, 1, v10
    v_lshlrev_b32 v11, 9, v11
    v_cmp_eq_u32 vcc, 4, v10
    v_and_b32 v10, 1, v10
    v_lshl_or_b32 v11, v10, 3, v11
    v_lshl_add_u32 v11, v2, 4, v11
    v_lshlrev_b32 v10, 3, v2
    v_add_u32 v10, 0x400, v10
    v_cndmask_b32 v11, v11, v10, vcc
    v_lshl_add_u32 v11, v9, 13, v11
    v_add_u32 v111, s61, v11
    v_mov_b32 v10, 0x100
    v_mov_b32 v8, 0x80
    v_cndmask_b32 v10, v10, v8, vcc
    v_add_u32 v119, v10, v111
    s_waitcnt lgkmcnt(0)
    v_mul_f32 v8, v33, v72
    v_mul_f32 v9, v33, v73
    v_mul_f32 v10, v33, v74
    v_mul_f32 v11, v33, v75
    v_fma_f32 v8, v128, v32, v8
    v_fma_f32 v9, v129, v32, v9
    v_fma_f32 v10, v130, v32, v10
    v_fma_f32 v11, v131, v32, v11
    v_cvt_pk_bf16_f32 v12, v8, v9
    v_cvt_pk_bf16_f32 v13, v10, v11
    ds_write_b64 v104, v[12:13] offset:0
    v_mul_f32 v16, v35, v72
    v_mul_f32 v17, v35, v73
    v_mul_f32 v18, v35, v74
    v_mul_f32 v19, v35, v75
    v_fma_f32 v16, v132, v34, v16
    v_fma_f32 v17, v133, v34, v17
    v_fma_f32 v18, v134, v34, v18
    v_fma_f32 v19, v135, v34, v19
    v_cvt_pk_bf16_f32 v20, v16, v17
    v_cvt_pk_bf16_f32 v21, v18, v19
    ds_write_b64 v112, v[20:21] offset:0
    v_mul_f32 v8, v37, v72
    v_mul_f32 v9, v37, v73
    v_mul_f32 v10, v37, v74
    v_mul_f32 v11, v37, v75
    v_fma_f32 v8, v136, v36, v8
    v_fma_f32 v9, v137, v36, v9
    v_fma_f32 v10, v138, v36, v10
    v_fma_f32 v11, v139, v36, v11
    v_cvt_pk_bf16_f32 v12, v8, v9
    v_cvt_pk_bf16_f32 v13, v10, v11
    ds_write_b64 v104, v[12:13] offset:1280
    v_mul_f32 v16, v39, v72
    v_mul_f32 v17, v39, v73
    v_mul_f32 v18, v39, v74
    v_mul_f32 v19, v39, v75
    v_fma_f32 v16, v140, v38, v16
    v_fma_f32 v17, v141, v38, v17
    v_fma_f32 v18, v142, v38, v18
    v_fma_f32 v19, v143, v38, v19
    v_cvt_pk_bf16_f32 v20, v16, v17
    v_cvt_pk_bf16_f32 v21, v18, v19
    ds_write_b64 v112, v[20:21] offset:1280
    v_mul_f32 v8, v33, v76
    v_mul_f32 v9, v33, v77
    v_mul_f32 v10, v33, v78
    v_mul_f32 v11, v33, v79
    v_fma_f32 v8, v144, v32, v8
    v_fma_f32 v9, v145, v32, v9
    v_fma_f32 v10, v146, v32, v10
    v_fma_f32 v11, v147, v32, v11
    v_cvt_pk_bf16_f32 v12, v8, v9
    v_cvt_pk_bf16_f32 v13, v10, v11
    ds_write_b64 v105, v[12:13] offset:0
    v_mul_f32 v16, v35, v76
    v_mul_f32 v17, v35, v77
    v_mul_f32 v18, v35, v78
    v_mul_f32 v19, v35, v79
    v_fma_f32 v16, v148, v34, v16
    v_fma_f32 v17, v149, v34, v17
    v_fma_f32 v18, v150, v34, v18
    v_fma_f32 v19, v151, v34, v19
    v_cvt_pk_bf16_f32 v20, v16, v17
    v_cvt_pk_bf16_f32 v21, v18, v19
    ds_write_b64 v113, v[20:21] offset:0
    v_mul_f32 v8, v37, v76
    v_mul_f32 v9, v37, v77
    v_mul_f32 v10, v37, v78
    v_mul_f32 v11, v37, v79
    v_fma_f32 v8, v152, v36, v8
    v_fma_f32 v9, v153, v36, v9
    v_fma_f32 v10, v154, v36, v10
    v_fma_f32 v11, v155, v36, v11
    v_cvt_pk_bf16_f32 v12, v8, v9
    v_cvt_pk_bf16_f32 v13, v10, v11
    ds_write_b64 v105, v[12:13] offset:1280
    v_mul_f32 v16, v39, v76
    v_mul_f32 v17, v39, v77
    v_mul_f32 v18, v39, v78
    v_mul_f32 v19, v39, v79
    v_fma_f32 v16, v156, v38, v16
    v_fma_f32 v17, v157, v38, v17
    v_fma_f32 v18, v158, v38, v18
    v_fma_f32 v19, v159, v38, v19
    v_cvt_pk_bf16_f32 v20, v16, v17
    v_cvt_pk_bf16_f32 v21, v18, v19
    ds_write_b64 v113, v[20:21] offset:1280
    v_mul_f32 v8, v33, v80
    v_mul_f32 v9, v33, v81
    v_mul_f32 v10, v33, v82
    v_mul_f32 v11, v33, v83
    v_fma_f32 v8, v160, v32, v8
    v_fma_f32 v9, v161, v32, v9
    v_fma_f32 v10, v162, v32, v10
    v_fma_f32 v11, v163, v32, v11
    v_cvt_pk_bf16_f32 v12, v8, v9
    v_cvt_pk_bf16_f32 v13, v10, v11
    ds_write_b64 v106, v[12:13] offset:0
    v_mul_f32 v16, v35, v80
    v_mul_f32 v17, v35, v81
    v_mul_f32 v18, v35, v82
    v_mul_f32 v19, v35, v83
    v_fma_f32 v16, v164, v34, v16
    v_fma_f32 v17, v165, v34, v17
    v_fma_f32 v18, v166, v34, v18
    v_fma_f32 v19, v167, v34, v19
    v_cvt_pk_bf16_f32 v20, v16, v17
    v_cvt_pk_bf16_f32 v21, v18, v19
    ds_write_b64 v114, v[20:21] offset:0
    v_mul_f32 v8, v37, v80
    v_mul_f32 v9, v37, v81
    v_mul_f32 v10, v37, v82
    v_mul_f32 v11, v37, v83
    v_fma_f32 v8, v168, v36, v8
    v_fma_f32 v9, v169, v36, v9
    v_fma_f32 v10, v170, v36, v10
    v_fma_f32 v11, v171, v36, v11
    v_cvt_pk_bf16_f32 v12, v8, v9
    v_cvt_pk_bf16_f32 v13, v10, v11
    ds_write_b64 v106, v[12:13] offset:1280
    v_mul_f32 v16, v39, v80
    v_mul_f32 v17, v39, v81
    v_mul_f32 v18, v39, v82
    v_mul_f32 v19, v39, v83
    v_fma_f32 v16, v172, v38, v16
    v_fma_f32 v17, v173, v38, v17
    v_fma_f32 v18, v174, v38, v18
    v_fma_f32 v19, v175, v38, v19
    v_cvt_pk_bf16_f32 v20, v16, v17
    v_cvt_pk_bf16_f32 v21, v18, v19
    ds_write_b64 v114, v[20:21] offset:1280
    v_mul_f32 v8, v33, v84
    v_mul_f32 v9, v33, v85
    v_mul_f32 v10, v33, v86
    v_mul_f32 v11, v33, v87
    v_fma_f32 v8, v176, v32, v8
    v_fma_f32 v9, v177, v32, v9
    v_fma_f32 v10, v178, v32, v10
    v_fma_f32 v11, v179, v32, v11
    v_cvt_pk_bf16_f32 v12, v8, v9
    v_cvt_pk_bf16_f32 v13, v10, v11
    ds_write_b64 v107, v[12:13] offset:0
    v_mul_f32 v16, v35, v84
    v_mul_f32 v17, v35, v85
    v_mul_f32 v18, v35, v86
    v_mul_f32 v19, v35, v87
    v_fma_f32 v16, v180, v34, v16
    v_fma_f32 v17, v181, v34, v17
    v_fma_f32 v18, v182, v34, v18
    v_fma_f32 v19, v183, v34, v19
    v_cvt_pk_bf16_f32 v20, v16, v17
    v_cvt_pk_bf16_f32 v21, v18, v19
    ds_write_b64 v115, v[20:21] offset:0
    v_mul_f32 v8, v37, v84
    v_mul_f32 v9, v37, v85
    v_mul_f32 v10, v37, v86
    v_mul_f32 v11, v37, v87
    v_fma_f32 v8, v184, v36, v8
    v_fma_f32 v9, v185, v36, v9
    v_fma_f32 v10, v186, v36, v10
    v_fma_f32 v11, v187, v36, v11
    v_cvt_pk_bf16_f32 v12, v8, v9
    v_cvt_pk_bf16_f32 v13, v10, v11
    ds_write_b64 v107, v[12:13] offset:1280
    v_mul_f32 v16, v39, v84
    v_mul_f32 v17, v39, v85
    v_mul_f32 v18, v39, v86
    v_mul_f32 v19, v39, v87
    v_fma_f32 v16, v188, v38, v16
    v_fma_f32 v17, v189, v38, v17
    v_fma_f32 v18, v190, v38, v18
    v_fma_f32 v19, v191, v38, v19
    v_cvt_pk_bf16_f32 v20, v16, v17
    v_cvt_pk_bf16_f32 v21, v18, v19
    ds_write_b64 v115, v[20:21] offset:1280
    v_mul_f32 v8, v33, v88
    v_mul_f32 v9, v33, v89
    v_mul_f32 v10, v33, v90
    v_mul_f32 v11, v33, v91
    v_fma_f32 v8, v192, v32, v8
    v_fma_f32 v9, v193, v32, v9
    v_fma_f32 v10, v194, v32, v10
    v_fma_f32 v11, v195, v32, v11
    v_cvt_pk_bf16_f32 v12, v8, v9
    v_cvt_pk_bf16_f32 v13, v10, v11
    ds_write_b64 v108, v[12:13] offset:0
    v_mul_f32 v16, v35, v88
    v_mul_f32 v17, v35, v89
    v_mul_f32 v18, v35, v90
    v_mul_f32 v19, v35, v91
    v_fma_f32 v16, v196, v34, v16
    v_fma_f32 v17, v197, v34, v17
    v_fma_f32 v18, v198, v34, v18
    v_fma_f32 v19, v199, v34, v19
    v_cvt_pk_bf16_f32 v20, v16, v17
    v_cvt_pk_bf16_f32 v21, v18, v19
    ds_write_b64 v116, v[20:21] offset:0
    v_mul_f32 v8, v37, v88
    v_mul_f32 v9, v37, v89
    v_mul_f32 v10, v37, v90
    v_mul_f32 v11, v37, v91
    v_fma_f32 v8, v200, v36, v8
    v_fma_f32 v9, v201, v36, v9
    v_fma_f32 v10, v202, v36, v10
    v_fma_f32 v11, v203, v36, v11
    v_cvt_pk_bf16_f32 v12, v8, v9
    v_cvt_pk_bf16_f32 v13, v10, v11
    ds_write_b64 v108, v[12:13] offset:1280
    v_mul_f32 v16, v39, v88
    v_mul_f32 v17, v39, v89
    v_mul_f32 v18, v39, v90
    v_mul_f32 v19, v39, v91
    v_fma_f32 v16, v204, v38, v16
    v_fma_f32 v17, v205, v38, v17
    v_fma_f32 v18, v206, v38, v18
    v_fma_f32 v19, v207, v38, v19
    v_cvt_pk_bf16_f32 v20, v16, v17
    v_cvt_pk_bf16_f32 v21, v18, v19
    ds_write_b64 v116, v[20:21] offset:1280
    v_mul_f32 v8, v33, v92
    v_mul_f32 v9, v33, v93
    v_mul_f32 v10, v33, v94
    v_mul_f32 v11, v33, v95
    v_fma_f32 v8, v208, v32, v8
    v_fma_f32 v9, v209, v32, v9
    v_fma_f32 v10, v210, v32, v10
    v_fma_f32 v11, v211, v32, v11
    v_cvt_pk_bf16_f32 v12, v8, v9
    v_cvt_pk_bf16_f32 v13, v10, v11
    ds_write_b64 v109, v[12:13] offset:0
    v_mul_f32 v16, v35, v92
    v_mul_f32 v17, v35, v93
    v_mul_f32 v18, v35, v94
    v_mul_f32 v19, v35, v95
    v_fma_f32 v16, v212, v34, v16
    v_fma_f32 v17, v213, v34, v17
    v_fma_f32 v18, v214, v34, v18
    v_fma_f32 v19, v215, v34, v19
    v_cvt_pk_bf16_f32 v20, v16, v17
    v_cvt_pk_bf16_f32 v21, v18, v19
    ds_write_b64 v117, v[20:21] offset:0
    v_mul_f32 v8, v37, v92
    v_mul_f32 v9, v37, v93
    v_mul_f32 v10, v37, v94
    v_mul_f32 v11, v37, v95
    v_fma_f32 v8, v216, v36, v8
    v_fma_f32 v9, v217, v36, v9
    v_fma_f32 v10, v218, v36, v10
    v_fma_f32 v11, v219, v36, v11
    v_cvt_pk_bf16_f32 v12, v8, v9
    v_cvt_pk_bf16_f32 v13, v10, v11
    ds_write_b64 v109, v[12:13] offset:1280
    v_mul_f32 v16, v39, v92
    v_mul_f32 v17, v39, v93
    v_mul_f32 v18, v39, v94
    v_mul_f32 v19, v39, v95
    v_fma_f32 v16, v220, v38, v16
    v_fma_f32 v17, v221, v38, v17
    v_fma_f32 v18, v222, v38, v18
    v_fma_f32 v19, v223, v38, v19
    v_cvt_pk_bf16_f32 v20, v16, v17
    v_cvt_pk_bf16_f32 v21, v18, v19
    ds_write_b64 v117, v[20:21] offset:1280
    v_mul_f32 v8, v33, v96
    v_mul_f32 v9, v33, v97
    v_mul_f32 v10, v33, v98
    v_mul_f32 v11, v33, v99
    v_fma_f32 v8, v224, v32, v8
    v_fma_f32 v9, v225, v32, v9
    v_fma_f32 v10, v226, v32, v10
    v_fma_f32 v11, v227, v32, v11
    v_cvt_pk_bf16_f32 v12, v8, v9
    v_cvt_pk_bf16_f32 v13, v10, v11
    ds_write_b64 v110, v[12:13] offset:0
    v_mul_f32 v16, v35, v96
    v_mul_f32 v17, v35, v97
    v_mul_f32 v18, v35, v98
    v_mul_f32 v19, v35, v99
    v_fma_f32 v16, v228, v34, v16
    v_fma_f32 v17, v229, v34, v17
    v_fma_f32 v18, v230, v34, v18
    v_fma_f32 v19, v231, v34, v19
    v_cvt_pk_bf16_f32 v20, v16, v17
    v_cvt_pk_bf16_f32 v21, v18, v19
    ds_write_b64 v118, v[20:21] offset:0
    v_mul_f32 v8, v37, v96
    v_mul_f32 v9, v37, v97
    v_mul_f32 v10, v37, v98
    v_mul_f32 v11, v37, v99
    v_fma_f32 v8, v232, v36, v8
    v_fma_f32 v9, v233, v36, v9
    v_fma_f32 v10, v234, v36, v10
    v_fma_f32 v11, v235, v36, v11
    v_cvt_pk_bf16_f32 v12, v8, v9
    v_cvt_pk_bf16_f32 v13, v10, v11
    ds_write_b64 v110, v[12:13] offset:1280
    v_mul_f32 v16, v39, v96
    v_mul_f32 v17, v39, v97
    v_mul_f32 v18, v39, v98
    v_mul_f32 v19, v39, v99
    v_fma_f32 v16, v236, v38, v16
    v_fma_f32 v17, v237, v38, v17
    v_fma_f32 v18, v238, v38, v18
    v_fma_f32 v19, v239, v38, v19
    v_cvt_pk_bf16_f32 v20, v16, v17
    v_cvt_pk_bf16_f32 v21, v18, v19
    ds_write_b64 v118, v[20:21] offset:1280
    v_mul_f32 v8, v33, v100
    v_mul_f32 v9, v33, v101
    v_mul_f32 v10, v33, v102
    v_mul_f32 v11, v33, v103
    v_fma_f32 v8, v240, v32, v8
    v_fma_f32 v9, v241, v32, v9
    v_fma_f32 v10, v242, v32, v10
    v_fma_f32 v11, v243, v32, v11
    v_cvt_pk_bf16_f32 v12, v8, v9
    v_cvt_pk_bf16_f32 v13, v10, v11
    ds_write_b64 v111, v[12:13] offset:0
    v_mul_f32 v16, v35, v100
    v_mul_f32 v17, v35, v101
    v_mul_f32 v18, v35, v102
    v_mul_f32 v19, v35, v103
    v_fma_f32 v16, v244, v34, v16
    v_fma_f32 v17, v245, v34, v17
    v_fma_f32 v18, v246, v34, v18
    v_fma_f32 v19, v247, v34, v19
    v_cvt_pk_bf16_f32 v20, v16, v17
    v_cvt_pk_bf16_f32 v21, v18, v19
    ds_write_b64 v119, v[20:21] offset:0
    v_mul_f32 v8, v37, v100
    v_mul_f32 v9, v37, v101
    v_mul_f32 v10, v37, v102
    v_mul_f32 v11, v37, v103
    v_fma_f32 v8, v248, v36, v8
    v_fma_f32 v9, v249, v36, v9
    v_fma_f32 v10, v250, v36, v10
    v_fma_f32 v11, v251, v36, v11
    v_cvt_pk_bf16_f32 v12, v8, v9
    v_cvt_pk_bf16_f32 v13, v10, v11
    ds_write_b64 v111, v[12:13] offset:1280
    v_mul_f32 v16, v39, v100
    v_mul_f32 v17, v39, v101
    v_mul_f32 v18, v39, v102
    v_mul_f32 v19, v39, v103
    v_fma_f32 v16, v252, v38, v16
    v_fma_f32 v17, v253, v38, v17
    v_fma_f32 v18, v254, v38, v18
    v_fma_f32 v19, v255, v38, v19
    v_cvt_pk_bf16_f32 v20, v16, v17
    v_cvt_pk_bf16_f32 v21, v18, v19
    ds_write_b64 v119, v[20:21] offset:1280
    s_branch K1_FA
K1_EA1:
    v_lshlrev_b32 v7, 3, v2
    v_add_u32 v7, s58, v7
    ds_read_b64 v[32:33], v7 offset:0
    ds_read_b64 v[34:35], v7 offset:128
    ds_read_b64 v[36:37], v7 offset:256
    ds_read_b64 v[38:39], v7 offset:384
    v_lshlrev_b32 v4, 4, v3
    v_add_u32 v4, 141312, v4
    v_lshlrev_b32 v5, 2, v2
    v_add_u32 v5, 141312, v5
    ds_read_b128 v[72:75], v4 offset:512
    ds_read_b128 v[76:79], v4 offset:576
    ds_read_b128 v[80:83], v4 offset:640
    ds_read_b128 v[84:87], v4 offset:704
    ds_read_b128 v[88:91], v4 offset:768
    ds_read_b128 v[92:95], v4 offset:832
    ds_read_b128 v[96:99], v4 offset:896
    s_lshr_b32 s60, s26, 1
    s_mul_i32 s61, s60, 2560
    s_lshl_b32 s62, s60, 12
    v_add_u32 v8, 32, v3
    v_mul_u32_u24 v9, 205, v8
    v_lshrrev_b32 v9, 10, v9
    v_mul_u32_u24 v10, 5, v9
    v_sub_u32 v10, v8, v10
    v_lshrrev_b32 v11, 1, v10
    v_lshlrev_b32 v11, 9, v11
    v_cmp_eq_u32 vcc, 4, v10
    v_and_b32 v10, 1, v10
    v_lshl_or_b32 v11, v10, 3, v11
    v_lshl_add_u32 v11, v2, 4, v11
    v_lshlrev_b32 v10, 3, v2
    v_add_u32 v10, 0x400, v10
    v_cndmask_b32 v11, v11, v10, vcc
    v_lshl_add_u32 v11, v9, 13, v11
    v_add_u32 v104, s61, v11
    v_mov_b32 v10, 0x100
    v_mov_b32 v8, 0x80
    v_cndmask_b32 v10, v10, v8, vcc
    v_add_u32 v112, v10, v104
    v_add_u32 v8, 36, v3
    v_mul_u32_u24 v9, 205, v8
    v_lshrrev_b32 v9, 10, v9
    v_mul_u32_u24 v10, 5, v9
    v_sub_u32 v10, v8, v10
    v_lshrrev_b32 v11, 1, v10
    v_lshlrev_b32 v11, 9, v11
    v_cmp_eq_u32 vcc, 4, v10
    v_and_b32 v10, 1, v10
    v_lshl_or_b32 v11, v10, 3, v11
    v_lshl_add_u32 v11, v2, 4, v11
    v_lshlrev_b32 v10, 3, v2
    v_add_u32 v10, 0x400, v10
    v_cndmask_b32 v11, v11, v10, vcc
    v_lshl_add_u32 v11, v9, 13, v11
    v_add_u32 v105, s61, v11
    v_mov_b32 v10, 0x100
    v_mov_b32 v8, 0x80
    v_cndmask_b32 v10, v10, v8, vcc
    v_add_u32 v113, v10, v105
    v_add_u32 v8, 40, v3
    v_mul_u32_u24 v9, 205, v8
    v_lshrrev_b32 v9, 10, v9
    v_mul_u32_u24 v10, 5, v9
    v_sub_u32 v10, v8, v10
    v_lshrrev_b32 v11, 1, v10
    v_lshlrev_b32 v11, 9, v11
    v_cmp_eq_u32 vcc, 4, v10
    v_and_b32 v10, 1, v10
    v_lshl_or_b32 v11, v10, 3, v11
    v_lshl_add_u32 v11, v2, 4, v11
    v_lshlrev_b32 v10, 3, v2
    v_add_u32 v10, 0x400, v10
    v_cndmask_b32 v11, v11, v10, vcc
    v_lshl_add_u32 v11, v9, 13, v11
    v_add_u32 v106, s61, v11
    v_add_u32 v114, 0x100, v106
    v_add_u32 v8, 44, v3
    v_mul_u32_u24 v9, 205, v8
    v_lshrrev_b32 v9, 10, v9
    v_mul_u32_u24 v10, 5, v9
    v_sub_u32 v10, v8, v10
    v_lshrrev_b32 v11, 1, v10
    v_lshlrev_b32 v11, 9, v11
    v_cmp_eq_u32 vcc, 4, v10
    v_and_b32 v10, 1, v10
    v_lshl_or_b32 v11, v10, 3, v11
    v_lshl_add_u32 v11, v2, 4, v11
    v_lshlrev_b32 v10, 3, v2
    v_add_u32 v10, 0x400, v10
    v_cndmask_b32 v11, v11, v10, vcc
    v_lshl_add_u32 v11, v9, 13, v11
    v_add_u32 v107, s61, v11
    v_mov_b32 v10, 0x100
    v_mov_b32 v8, 0x80
    v_cndmask_b32 v10, v10, v8, vcc
    v_add_u32 v115, v10, v107
    v_add_u32 v8, 48, v3
    v_mul_u32_u24 v9, 205, v8
    v_lshrrev_b32 v9, 10, v9
    v_mul_u32_u24 v10, 5, v9
    v_sub_u32 v10, v8, v10
    v_lshrrev_b32 v11, 1, v10
    v_lshlrev_b32 v11, 9, v11
    v_cmp_eq_u32 vcc, 4, v10
    v_and_b32 v10, 1, v10
    v_lshl_or_b32 v11, v10, 3, v11
    v_lshl_add_u32 v11, v2, 4, v11
    v_lshlrev_b32 v10, 3, v2
    v_add_u32 v10, 0x400, v10
    v_cndmask_b32 v11, v11, v10, vcc
    v_lshl_add_u32 v11, v9, 13, v11
    v_add_u32 v108, s61, v11
    v_mov_b32 v10, 0x100
    v_mov_b32 v8, 0x80
    v_cndmask_b32 v10, v10, v8, vcc
    v_add_u32 v116, v10, v108
    v_add_u32 v8, 52, v3
    v_mul_u32_u24 v9, 205, v8
    v_lshrrev_b32 v9, 10, v9
    v_mul_u32_u24 v10, 5, v9
    v_sub_u32 v10, v8, v10
    v_lshrrev_b32 v11, 1, v10
    v_lshlrev_b32 v11, 9, v11
    v_cmp_eq_u32 vcc, 4, v10
    v_and_b32 v10, 1, v10
    v_lshl_or_b32 v11, v10, 3, v11
    v_lshl_add_u32 v11, v2, 4, v11
    v_lshlrev_b32 v10, 3, v2
    v_add_u32 v10, 0x400, v10
    v_cndmask_b32 v11, v11, v10, vcc
    v_lshl_add_u32 v11, v9, 13, v11
    v_add_u32 v109, s61, v11
    v_mov_b32 v10, 0x100
    v_mov_b32 v8, 0x80
    v_cndmask_b32 v10, v10, v8, vcc
    v_add_u32 v117, v10, v109
    v_add_u32 v8, 56, v3
    v_mul_u32_u24 v9, 205, v8
    v_lshrrev_b32 v9, 10, v9
    v_mul_u32_u24 v10, 5, v9
    v_sub_u32 v10, v8, v10
    v_lshrrev_b32 v11, 1, v10
    v_lshlrev_b32 v11, 9, v11
    v_cmp_eq_u32 vcc, 4, v10
    v_and_b32 v10, 1, v10
    v_lshl_or_b32 v11, v10, 3, v11
    v_lshl_add_u32 v11, v2, 4, v11
    v_lshlrev_b32 v10, 3, v2
    v_add_u32 v10, 0x400, v10
    v_cndmask_b32 v11, v11, v10, vcc
    v_lshl_add_u32 v11, v9, 13, v11
    v_add_u32 v110, s61, v11
    v_mov_b32 v10, 0x100
    v_mov_b32 v8, 0x80
    v_cndmask_b32 v10, v10, v8, vcc
    v_add_u32 v118, v10, v110
    s_waitcnt lgkmcnt(0)
    v_mul_f32 v8, v33, v72
    v_mul_f32 v9, v33, v73
    v_mul_f32 v10, v33, v74
    v_mul_f32 v11, v33, v75
    v_fma_f32 v8, v128, v32, v8
    v_fma_f32 v9, v129, v32, v9
    v_fma_f32 v10, v130, v32, v10
    v_fma_f32 v11, v131, v32, v11
    v_cvt_pk_bf16_f32 v12, v8, v9
    v_cvt_pk_bf16_f32 v13, v10, v11
    ds_write_b64 v104, v[12:13] offset:0
    v_mul_f32 v16, v35, v72
    v_mul_f32 v17, v35, v73
    v_mul_f32 v18, v35, v74
    v_mul_f32 v19, v35, v75
    v_fma_f32 v16, v132, v34, v16
    v_fma_f32 v17, v133, v34, v17
    v_fma_f32 v18, v134, v34, v18
    v_fma_f32 v19, v135, v34, v19
    v_cvt_pk_bf16_f32 v20, v16, v17
    v_cvt_pk_bf16_f32 v21, v18, v19
    ds_write_b64 v112, v[20:21] offset:0
    v_mul_f32 v8, v37, v72
    v_mul_f32 v9, v37, v73
    v_mul_f32 v10, v37, v74
    v_mul_f32 v11, v37, v75
    v_fma_f32 v8, v136, v36, v8
    v_fma_f32 v9, v137, v36, v9
    v_fma_f32 v10, v138, v36, v10
    v_fma_f32 v11, v139, v36, v11
    v_cvt_pk_bf16_f32 v12, v8, v9
    v_cvt_pk_bf16_f32 v13, v10, v11
    ds_write_b64 v104, v[12:13] offset:1280
    v_mul_f32 v16, v39, v72
    v_mul_f32 v17, v39, v73
    v_mul_f32 v18, v39, v74
    v_mul_f32 v19, v39, v75
    v_fma_f32 v16, v140, v38, v16
    v_fma_f32 v17, v141, v38, v17
    v_fma_f32 v18, v142, v38, v18
    v_fma_f32 v19, v143, v38, v19
    v_cvt_pk_bf16_f32 v20, v16, v17
    v_cvt_pk_bf16_f32 v21, v18, v19
    ds_write_b64 v112, v[20:21] offset:1280
    v_mul_f32 v8, v33, v76
    v_mul_f32 v9, v33, v77
    v_mul_f32 v10, v33, v78
    v_mul_f32 v11, v33, v79
    v_fma_f32 v8, v144, v32, v8
    v_fma_f32 v9, v145, v32, v9
    v_fma_f32 v10, v146, v32, v10
    v_fma_f32 v11, v147, v32, v11
    v_cvt_pk_bf16_f32 v12, v8, v9
    v_cvt_pk_bf16_f32 v13, v10, v11
    ds_write_b64 v105, v[12:13] offset:0
    v_mul_f32 v16, v35, v76
    v_mul_f32 v17, v35, v77
    v_mul_f32 v18, v35, v78
    v_mul_f32 v19, v35, v79
    v_fma_f32 v16, v148, v34, v16
    v_fma_f32 v17, v149, v34, v17
    v_fma_f32 v18, v150, v34, v18
    v_fma_f32 v19, v151, v34, v19
    v_cvt_pk_bf16_f32 v20, v16, v17
    v_cvt_pk_bf16_f32 v21, v18, v19
    ds_write_b64 v113, v[20:21] offset:0
    v_mul_f32 v8, v37, v76
    v_mul_f32 v9, v37, v77
    v_mul_f32 v10, v37, v78
    v_mul_f32 v11, v37, v79
    v_fma_f32 v8, v152, v36, v8
    v_fma_f32 v9, v153, v36, v9
    v_fma_f32 v10, v154, v36, v10
    v_fma_f32 v11, v155, v36, v11
    v_cvt_pk_bf16_f32 v12, v8, v9
    v_cvt_pk_bf16_f32 v13, v10, v11
    ds_write_b64 v105, v[12:13] offset:1280
    v_mul_f32 v16, v39, v76
    v_mul_f32 v17, v39, v77
    v_mul_f32 v18, v39, v78
    v_mul_f32 v19, v39, v79
    v_fma_f32 v16, v156, v38, v16
    v_fma_f32 v17, v157, v38, v17
    v_fma_f32 v18, v158, v38, v18
    v_fma_f32 v19, v159, v38, v19
    v_cvt_pk_bf16_f32 v20, v16, v17
    v_cvt_pk_bf16_f32 v21, v18, v19
    ds_write_b64 v113, v[20:21] offset:1280
    v_mul_f32 v8, v33, v80
    v_mul_f32 v9, v33, v81
    v_mul_f32 v10, v33, v82
    v_mul_f32 v11, v33, v83
    v_fma_f32 v8, v160, v32, v8
    v_fma_f32 v9, v161, v32, v9
    v_fma_f32 v10, v162, v32, v10
    v_fma_f32 v11, v163, v32, v11
    v_cvt_pk_bf16_f32 v12, v8, v9
    v_cvt_pk_bf16_f32 v13, v10, v11
    ds_write_b64 v106, v[12:13] offset:0
    v_mul_f32 v16, v35, v80
    v_mul_f32 v17, v35, v81
    v_mul_f32 v18, v35, v82
    v_mul_f32 v19, v35, v83
    v_fma_f32 v16, v164, v34, v16
    v_fma_f32 v17, v165, v34, v17
    v_fma_f32 v18, v166, v34, v18
    v_fma_f32 v19, v167, v34, v19
    v_cvt_pk_bf16_f32 v20, v16, v17
    v_cvt_pk_bf16_f32 v21, v18, v19
    ds_write_b64 v114, v[20:21] offset:0
    v_mul_f32 v8, v37, v80
    v_mul_f32 v9, v37, v81
    v_mul_f32 v10, v37, v82
    v_mul_f32 v11, v37, v83
    v_fma_f32 v8, v168, v36, v8
    v_fma_f32 v9, v169, v36, v9
    v_fma_f32 v10, v170, v36, v10
    v_fma_f32 v11, v171, v36, v11
    v_cvt_pk_bf16_f32 v12, v8, v9
    v_cvt_pk_bf16_f32 v13, v10, v11
    ds_write_b64 v106, v[12:13] offset:1280
    v_mul_f32 v16, v39, v80
    v_mul_f32 v17, v39, v81
    v_mul_f32 v18, v39, v82
    v_mul_f32 v19, v39, v83
    v_fma_f32 v16, v172, v38, v16
    v_fma_f32 v17, v173, v38, v17
    v_fma_f32 v18, v174, v38, v18
    v_fma_f32 v19, v175, v38, v19
    v_cvt_pk_bf16_f32 v20, v16, v17
    v_cvt_pk_bf16_f32 v21, v18, v19
    ds_write_b64 v114, v[20:21] offset:1280
    v_mul_f32 v8, v33, v84
    v_mul_f32 v9, v33, v85
    v_mul_f32 v10, v33, v86
    v_mul_f32 v11, v33, v87
    v_fma_f32 v8, v176, v32, v8
    v_fma_f32 v9, v177, v32, v9
    v_fma_f32 v10, v178, v32, v10
    v_fma_f32 v11, v179, v32, v11
    v_cvt_pk_bf16_f32 v12, v8, v9
    v_cvt_pk_bf16_f32 v13, v10, v11
    ds_write_b64 v107, v[12:13] offset:0
    v_mul_f32 v16, v35, v84
    v_mul_f32 v17, v35, v85
    v_mul_f32 v18, v35, v86
    v_mul_f32 v19, v35, v87
    v_fma_f32 v16, v180, v34, v16
    v_fma_f32 v17, v181, v34, v17
    v_fma_f32 v18, v182, v34, v18
    v_fma_f32 v19, v183, v34, v19
    v_cvt_pk_bf16_f32 v20, v16, v17
    v_cvt_pk_bf16_f32 v21, v18, v19
    ds_write_b64 v115, v[20:21] offset:0
    v_mul_f32 v8, v37, v84
    v_mul_f32 v9, v37, v85
    v_mul_f32 v10, v37, v86
    v_mul_f32 v11, v37, v87
    v_fma_f32 v8, v184, v36, v8
    v_fma_f32 v9, v185, v36, v9
    v_fma_f32 v10, v186, v36, v10
    v_fma_f32 v11, v187, v36, v11
    v_cvt_pk_bf16_f32 v12, v8, v9
    v_cvt_pk_bf16_f32 v13, v10, v11
    ds_write_b64 v107, v[12:13] offset:1280
    v_mul_f32 v16, v39, v84
    v_mul_f32 v17, v39, v85
    v_mul_f32 v18, v39, v86
    v_mul_f32 v19, v39, v87
    v_fma_f32 v16, v188, v38, v16
    v_fma_f32 v17, v189, v38, v17
    v_fma_f32 v18, v190, v38, v18
    v_fma_f32 v19, v191, v38, v19
    v_cvt_pk_bf16_f32 v20, v16, v17
    v_cvt_pk_bf16_f32 v21, v18, v19
    ds_write_b64 v115, v[20:21] offset:1280
    v_mul_f32 v8, v33, v88
    v_mul_f32 v9, v33, v89
    v_mul_f32 v10, v33, v90
    v_mul_f32 v11, v33, v91
    v_fma_f32 v8, v192, v32, v8
    v_fma_f32 v9, v193, v32, v9
    v_fma_f32 v10, v194, v32, v10
    v_fma_f32 v11, v195, v32, v11
    v_cvt_pk_bf16_f32 v12, v8, v9
    v_cvt_pk_bf16_f32 v13, v10, v11
    ds_write_b64 v108, v[12:13] offset:0
    v_mul_f32 v16, v35, v88
    v_mul_f32 v17, v35, v89
    v_mul_f32 v18, v35, v90
    v_mul_f32 v19, v35, v91
    v_fma_f32 v16, v196, v34, v16
    v_fma_f32 v17, v197, v34, v17
    v_fma_f32 v18, v198, v34, v18
    v_fma_f32 v19, v199, v34, v19
    v_cvt_pk_bf16_f32 v20, v16, v17
    v_cvt_pk_bf16_f32 v21, v18, v19
    ds_write_b64 v116, v[20:21] offset:0
    v_mul_f32 v8, v37, v88
    v_mul_f32 v9, v37, v89
    v_mul_f32 v10, v37, v90
    v_mul_f32 v11, v37, v91
    v_fma_f32 v8, v200, v36, v8
    v_fma_f32 v9, v201, v36, v9
    v_fma_f32 v10, v202, v36, v10
    v_fma_f32 v11, v203, v36, v11
    v_cvt_pk_bf16_f32 v12, v8, v9
    v_cvt_pk_bf16_f32 v13, v10, v11
    ds_write_b64 v108, v[12:13] offset:1280
    v_mul_f32 v16, v39, v88
    v_mul_f32 v17, v39, v89
    v_mul_f32 v18, v39, v90
    v_mul_f32 v19, v39, v91
    v_fma_f32 v16, v204, v38, v16
    v_fma_f32 v17, v205, v38, v17
    v_fma_f32 v18, v206, v38, v18
    v_fma_f32 v19, v207, v38, v19
    v_cvt_pk_bf16_f32 v20, v16, v17
    v_cvt_pk_bf16_f32 v21, v18, v19
    ds_write_b64 v116, v[20:21] offset:1280
    v_mul_f32 v8, v33, v92
    v_mul_f32 v9, v33, v93
    v_mul_f32 v10, v33, v94
    v_mul_f32 v11, v33, v95
    v_fma_f32 v8, v208, v32, v8
    v_fma_f32 v9, v209, v32, v9
    v_fma_f32 v10, v210, v32, v10
    v_fma_f32 v11, v211, v32, v11
    v_cvt_pk_bf16_f32 v12, v8, v9
    v_cvt_pk_bf16_f32 v13, v10, v11
    ds_write_b64 v109, v[12:13] offset:0
    v_mul_f32 v16, v35, v92
    v_mul_f32 v17, v35, v93
    v_mul_f32 v18, v35, v94
    v_mul_f32 v19, v35, v95
    v_fma_f32 v16, v212, v34, v16
    v_fma_f32 v17, v213, v34, v17
    v_fma_f32 v18, v214, v34, v18
    v_fma_f32 v19, v215, v34, v19
    v_cvt_pk_bf16_f32 v20, v16, v17
    v_cvt_pk_bf16_f32 v21, v18, v19
    ds_write_b64 v117, v[20:21] offset:0
    v_mul_f32 v8, v37, v92
    v_mul_f32 v9, v37, v93
    v_mul_f32 v10, v37, v94
    v_mul_f32 v11, v37, v95
    v_fma_f32 v8, v216, v36, v8
    v_fma_f32 v9, v217, v36, v9
    v_fma_f32 v10, v218, v36, v10
    v_fma_f32 v11, v219, v36, v11
    v_cvt_pk_bf16_f32 v12, v8, v9
    v_cvt_pk_bf16_f32 v13, v10, v11
    ds_write_b64 v109, v[12:13] offset:1280
    v_mul_f32 v16, v39, v92
    v_mul_f32 v17, v39, v93
    v_mul_f32 v18, v39, v94
    v_mul_f32 v19, v39, v95
    v_fma_f32 v16, v220, v38, v16
    v_fma_f32 v17, v221, v38, v17
    v_fma_f32 v18, v222, v38, v18
    v_fma_f32 v19, v223, v38, v19
    v_cvt_pk_bf16_f32 v20, v16, v17
    v_cvt_pk_bf16_f32 v21, v18, v19
    ds_write_b64 v117, v[20:21] offset:1280
    v_mul_f32 v8, v33, v96
    v_mul_f32 v9, v33, v97
    v_mul_f32 v10, v33, v98
    v_mul_f32 v11, v33, v99
    v_fma_f32 v8, v224, v32, v8
    v_fma_f32 v9, v225, v32, v9
    v_fma_f32 v10, v226, v32, v10
    v_fma_f32 v11, v227, v32, v11
    v_cvt_pk_bf16_f32 v12, v8, v9
    v_cvt_pk_bf16_f32 v13, v10, v11
    ds_write_b64 v110, v[12:13] offset:0
    v_mul_f32 v16, v35, v96
    v_mul_f32 v17, v35, v97
    v_mul_f32 v18, v35, v98
    v_mul_f32 v19, v35, v99
    v_fma_f32 v16, v228, v34, v16
    v_fma_f32 v17, v229, v34, v17
    v_fma_f32 v18, v230, v34, v18
    v_fma_f32 v19, v231, v34, v19
    v_cvt_pk_bf16_f32 v20, v16, v17
    v_cvt_pk_bf16_f32 v21, v18, v19
    ds_write_b64 v118, v[20:21] offset:0
    v_mul_f32 v8, v37, v96
    v_mul_f32 v9, v37, v97
    v_mul_f32 v10, v37, v98
    v_mul_f32 v11, v37, v99
    v_fma_f32 v8, v232, v36, v8
    v_fma_f32 v9, v233, v36, v9
    v_fma_f32 v10, v234, v36, v10
    v_fma_f32 v11, v235, v36, v11
    v_cvt_pk_bf16_f32 v12, v8, v9
    v_cvt_pk_bf16_f32 v13, v10, v11
    ds_write_b64 v110, v[12:13] offset:1280
    v_mul_f32 v16, v39, v96
    v_mul_f32 v17, v39, v97
    v_mul_f32 v18, v39, v98
    v_mul_f32 v19, v39, v99
    v_fma_f32 v16, v236, v38, v16
    v_fma_f32 v17, v237, v38, v17
    v_fma_f32 v18, v238, v38, v18
    v_fma_f32 v19, v239, v38, v19
    v_cvt_pk_bf16_f32 v20, v16, v17
    v_cvt_pk_bf16_f32 v21, v18, v19
    ds_write_b64 v118, v[20:21] offset:1280
K1_FA:
    s_waitcnt lgkmcnt(0)
    s_barrier
    v_lshlrev_b32 v6, 4, v1
    s_lshl_b32 s3, s26, 13
    v_add_u32 v7, s3, v6
    v_add_u32 v5, 0x1000, v6
    v_add_u32 v4, 0x10000, v7
    s_mul_i32 s60, s37, 12
    s_add_u32 s60, s60, s26
    s_add_u32 s61, s60, 0
    s_cmp_ge_u32 s61, 32
    s_cselect_b32 s62, 0x180000, 0
    s_mul_i32 s61, s61, 81920
    s_add_u32 s61, s61, s62
    s_mul_i32 s62, s36, 5120
    s_add_u32 s61, s61, s62
    ds_read_b128 v[32:35], v7 offset:0
    ds_read_b128 v[36:39], v7 offset:1024
    ds_read_b128 v[40:43], v7 offset:2048
    ds_read_b128 v[44:47], v7 offset:3072
    ds_read_b128 v[48:51], v7 offset:4096
    s_waitcnt lgkmcnt(4)
    buffer_store_dwordx4 v[32:35], v6, s[48:51], s61 offen offset:0 sc1
    s_waitcnt lgkmcnt(3)
    buffer_store_dwordx4 v[36:39], v6, s[48:51], s61 offen offset:1024 sc1
    s_waitcnt lgkmcnt(2)
    buffer_store_dwordx4 v[40:43], v6, s[48:51], s61 offen offset:2048 sc1
    s_waitcnt lgkmcnt(1)
    buffer_store_dwordx4 v[44:47], v6, s[48:51], s61 offen offset:3072 sc1
    s_waitcnt lgkmcnt(0)
    buffer_store_dwordx4 v[48:51], v5, s[48:51], s61 offen offset:0 sc1
    s_add_u32 s61, s60, 4
    s_cmp_ge_u32 s61, 32
    s_cselect_b32 s62, 0x180000, 0
    s_mul_i32 s61, s61, 81920
    s_add_u32 s61, s61, s62
    s_mul_i32 s62, s36, 5120
    s_add_u32 s61, s61, s62
    ds_read_b128 v[64:67], v7 offset:32768
    ds_read_b128 v[68:71], v7 offset:33792
    ds_read_b128 v[72:75], v7 offset:34816
    ds_read_b128 v[76:79], v7 offset:35840
    ds_read_b128 v[80:83], v7 offset:36864
    s_waitcnt lgkmcnt(4)
    buffer_store_dwordx4 v[64:67], v6, s[48:51], s61 offen offset:0 sc1
    s_waitcnt lgkmcnt(3)
    buffer_store_dwordx4 v[68:71], v6, s[48:51], s61 offen offset:1024 sc1
    s_waitcnt lgkmcnt(2)
    buffer_store_dwordx4 v[72:75], v6, s[48:51], s61 offen offset:2048 sc1
    s_waitcnt lgkmcnt(1)
    buffer_store_dwordx4 v[76:79], v6, s[48:51], s61 offen offset:3072 sc1
    s_waitcnt lgkmcnt(0)
    buffer_store_dwordx4 v[80:83], v5, s[48:51], s61 offen offset:0 sc1
    s_add_u32 s61, s60, 8
    s_cmp_ge_u32 s61, 32
    s_cselect_b32 s62, 0x180000, 0
    s_mul_i32 s61, s61, 81920
    s_add_u32 s61, s61, s62
    s_mul_i32 s62, s36, 5120
    s_add_u32 s61, s61, s62
    ds_read_b128 v[32:35], v4 offset:0
    ds_read_b128 v[36:39], v4 offset:1024
    ds_read_b128 v[40:43], v4 offset:2048
    ds_read_b128 v[44:47], v4 offset:3072
    ds_read_b128 v[48:51], v4 offset:4096
    s_waitcnt lgkmcnt(4)
    buffer_store_dwordx4 v[32:35], v6, s[48:51], s61 offen offset:0 sc1
    s_waitcnt lgkmcnt(3)
    buffer_store_dwordx4 v[36:39], v6, s[48:51], s61 offen offset:1024 sc1
    s_waitcnt lgkmcnt(2)
    buffer_store_dwordx4 v[40:43], v6, s[48:51], s61 offen offset:2048 sc1
    s_waitcnt lgkmcnt(1)
    buffer_store_dwordx4 v[44:47], v6, s[48:51], s61 offen offset:3072 sc1
    s_waitcnt lgkmcnt(0)
    buffer_store_dwordx4 v[48:51], v5, s[48:51], s61 offen offset:0 sc1
    s_mov_b64 exec, -1
    s_waitcnt vmcnt(0)
    s_endpgm
K1_VB:
    s_cmp_eq_u32 s26, 1
    s_cbranch_scc1 K1_VB_W1
    s_cmp_eq_u32 s26, 2
    s_cbranch_scc1 K1_VB_W2
    s_cmp_eq_u32 s26, 3
    s_cbranch_scc1 K1_VB_W3
K1_VB_W0:
    s_mov_b32 s70, 0
    s_mov_b32 s71, 47104
    s_mov_b32 s72, 94208
    v_add_u32 v27, s70, v26
    v_add_u32 v12, s71, v26
    v_add_u32 v13, s70, v24
    v_add_u32 v14, s70, v25
    v_add_u32 v15, s71, v24
    s_waitcnt vmcnt(14)
    s_barrier
    ds_read_b128 v[32:35], v13 offset:0
    ds_read_b128 v[36:39], v13 offset:2048
    ds_read_b128 v[40:43], v13 offset:4096
    ds_read_b128 v[44:47], v13 offset:6144
    ds_read_b64_tr_b16 v[64:65], v27 offset:0
    ds_read_b64_tr_b16 v[66:67], v27 offset:7680
    ds_read_b64_tr_b16 v[68:69], v27 offset:32
    ds_read_b64_tr_b16 v[70:71], v27 offset:7712
    ds_read_b64_tr_b16 v[72:73], v27 offset:64
    ds_read_b64_tr_b16 v[74:75], v27 offset:7744
    s_mov_b32 s45, 0
K1_LB0:
    s_add_u32 s42, s72, s41
    s_add_u32 s73, s72, s74
    s_waitcnt lgkmcnt(4)
    v_mfma_f32_16x16x32_bf16 v[128:131], v[64:67], v[32:35], v[128:131]
    ds_read_b64_tr_b16 v[76:77], v27 offset:96
    v_mfma_f32_16x16x32_bf16 v[132:135], v[64:67], v[36:39], v[132:135]
    ds_read_b64_tr_b16 v[78:79], v27 offset:7776
    s_add_u32 m0, s42, 0
    v_mfma_f32_16x16x32_bf16 v[136:139], v[64:67], v[40:43], v[136:139]
    buffer_load_dwordx4 v16, s[32:35], s43 offen lds
    v_mfma_f32_16x16x32_bf16 v[140:143], v[64:67], v[44:47], v[140:143]
    v_mfma_f32_16x16x32_bf16 v[108:111], v[64:67], v[28:31], v[108:111]
    v_mfma_f32_16x16x32_bf16 v[92:95], v[28:31], v[32:35], v[92:95]
    ds_read_b128 v[48:51], v14 offset:0
    ds_read_b128 v[52:55], v14 offset:2048
    ds_read_b128 v[56:59], v14 offset:4096
    ds_read_b128 v[60:63], v14 offset:6144
    s_waitcnt lgkmcnt(8)
    v_mfma_f32_16x16x32_bf16 v[144:147], v[68:71], v[32:35], v[144:147]
    ds_read_b64_tr_b16 v[64:65], v27 offset:128
    v_mfma_f32_16x16x32_bf16 v[148:151], v[68:71], v[36:39], v[148:151]
    ds_read_b64_tr_b16 v[66:67], v27 offset:7808
    s_add_u32 m0, s42, 4096
    v_mfma_f32_16x16x32_bf16 v[152:155], v[68:71], v[40:43], v[152:155]
    buffer_load_dwordx4 v17, s[32:35], s43 offen lds
    v_mfma_f32_16x16x32_bf16 v[156:159], v[68:71], v[44:47], v[156:159]
    v_mfma_f32_16x16x32_bf16 v[96:99], v[28:31], v[36:39], v[96:99]
    s_waitcnt lgkmcnt(8)
    v_mfma_f32_16x16x32_bf16 v[160:163], v[72:75], v[32:35], v[160:163]
    ds_read_b64_tr_b16 v[68:69], v27 offset:160
    v_mfma_f32_16x16x32_bf16 v[164:167], v[72:75], v[36:39], v[164:167]
    ds_read_b64_tr_b16 v[70:71], v27 offset:7840
    s_add_u32 m0, s42, 8192
    v_mfma_f32_16x16x32_bf16 v[168:171], v[72:75], v[40:43], v[168:171]
    buffer_load_dwordx4 v18, s[32:35], s43 offen lds
    v_mfma_f32_16x16x32_bf16 v[172:175], v[72:75], v[44:47], v[172:175]
    v_mfma_f32_16x16x32_bf16 v[112:115], v[72:75], v[28:31], v[112:115]
    s_waitcnt lgkmcnt(8)
    v_mfma_f32_16x16x32_bf16 v[176:179], v[76:79], v[32:35], v[176:179]
    ds_read_b64_tr_b16 v[72:73], v27 offset:192
    v_mfma_f32_16x16x32_bf16 v[180:183], v[76:79], v[36:39], v[180:183]
    ds_read_b64_tr_b16 v[74:75], v27 offset:7872
    s_add_u32 m0, s42, 12288
    v_mfma_f32_16x16x32_bf16 v[184:187], v[76:79], v[40:43], v[184:187]
    buffer_load_dwordx4 v19, s[32:35], s43 offen lds
    v_mfma_f32_16x16x32_bf16 v[188:191], v[76:79], v[44:47], v[188:191]
    s_waitcnt lgkmcnt(4)
    v_mfma_f32_16x16x32_bf16 v[192:195], v[64:67], v[32:35], v[192:195]
    ds_read_b64_tr_b16 v[76:77], v27 offset:224
    v_mfma_f32_16x16x32_bf16 v[196:199], v[64:67], v[36:39], v[196:199]
    ds_read_b64_tr_b16 v[78:79], v27 offset:7904
    s_add_u32 m0, s42, 16384
    v_mfma_f32_16x16x32_bf16 v[200:203], v[64:67], v[40:43], v[200:203]
    buffer_load_dwordx4 v20, s[32:35], s43 offen lds
    v_mfma_f32_16x16x32_bf16 v[204:207], v[64:67], v[44:47], v[204:207]
    v_mfma_f32_16x16x32_bf16 v[116:119], v[64:67], v[28:31], v[116:119]
    s_waitcnt lgkmcnt(4)
    v_mfma_f32_16x16x32_bf16 v[208:211], v[32:35], v[68:71], v[208:211]
    ds_read_b64_tr_b16 v[64:65], v27 offset:15360
    v_mfma_f32_16x16x32_bf16 v[212:215], v[36:39], v[68:71], v[212:215]
    ds_read_b64_tr_b16 v[66:67], v27 offset:23040
    s_add_u32 m0, s42, 20480
    v_mfma_f32_16x16x32_bf16 v[216:219], v[40:43], v[68:71], v[216:219]
    buffer_load_dwordx4 v21, s[32:35], s43 offen lds
    v_mfma_f32_16x16x32_bf16 v[220:223], v[44:47], v[68:71], v[220:223]
    s_waitcnt lgkmcnt(4)
    v_mfma_f32_16x16x32_bf16 v[224:227], v[32:35], v[72:75], v[224:227]
    ds_read_b64_tr_b16 v[68:69], v27 offset:15392
    v_mfma_f32_16x16x32_bf16 v[228:231], v[36:39], v[72:75], v[228:231]
    ds_read_b64_tr_b16 v[70:71], v27 offset:23072
    s_add_u32 m0, s42, 24576
    v_mfma_f32_16x16x32_bf16 v[232:235], v[40:43], v[72:75], v[232:235]
    buffer_load_dwordx4 v22, s[32:35], s43 offen lds
    v_mfma_f32_16x16x32_bf16 v[236:239], v[44:47], v[72:75], v[236:239]
    v_mfma_f32_16x16x32_bf16 v[120:123], v[72:75], v[28:31], v[120:123]
    s_waitcnt lgkmcnt(4)
    v_mfma_f32_16x16x32_bf16 v[240:243], v[32:35], v[76:79], v[240:243]
    ds_read_b64_tr_b16 v[72:73], v27 offset:15424
    v_mfma_f32_16x16x32_bf16 v[244:247], v[36:39], v[76:79], v[244:247]
    ds_read_b64_tr_b16 v[74:75], v27 offset:23104
    s_add_u32 m0, s42, 28672
    v_mfma_f32_16x16x32_bf16 v[248:251], v[40:43], v[76:79], v[248:251]
    buffer_load_dwordx4 v23, s[32:35], s43 offen lds
    v_mfma_f32_16x16x32_bf16 v[252:255], v[44:47], v[76:79], v[252:255]
    s_waitcnt lgkmcnt(4)
    v_mfma_f32_16x16x32_bf16 v[128:131], v[64:67], v[48:51], v[128:131]
    ds_read_b64_tr_b16 v[76:77], v27 offset:15456
    v_mfma_f32_16x16x32_bf16 v[132:135], v[64:67], v[52:55], v[132:135]
    ds_read_b64_tr_b16 v[78:79], v27 offset:23136
    s_add_u32 m0, s73, 0
    v_mfma_f32_16x16x32_bf16 v[136:139], v[64:67], v[56:59], v[136:139]
    buffer_load_dwordx4 v8, s[28:31], s44 offen lds
    v_mfma_f32_16x16x32_bf16 v[140:143], v[64:67], v[60:63], v[140:143]
    v_mfma_f32_16x16x32_bf16 v[108:111], v[64:67], v[28:31], v[108:111]
    v_mfma_f32_16x16x32_bf16 v[92:95], v[28:31], v[48:51], v[92:95]
    s_waitcnt lgkmcnt(4)
    v_mfma_f32_16x16x32_bf16 v[144:147], v[68:71], v[48:51], v[144:147]
    ds_read_b64_tr_b16 v[64:65], v27 offset:15488
    v_mfma_f32_16x16x32_bf16 v[148:151], v[68:71], v[52:55], v[148:151]
    ds_read_b64_tr_b16 v[66:67], v27 offset:23168
    s_add_u32 m0, s73, 1024
    v_mfma_f32_16x16x32_bf16 v[152:155], v[68:71], v[56:59], v[152:155]
    buffer_load_dwordx4 v9, s[28:31], s44 offen lds
    v_mfma_f32_16x16x32_bf16 v[156:159], v[68:71], v[60:63], v[156:159]
    v_mfma_f32_16x16x32_bf16 v[96:99], v[28:31], v[52:55], v[96:99]
    s_waitcnt lgkmcnt(4)
    v_mfma_f32_16x16x32_bf16 v[160:163], v[72:75], v[48:51], v[160:163]
    ds_read_b64_tr_b16 v[68:69], v27 offset:15520
    v_mfma_f32_16x16x32_bf16 v[164:167], v[72:75], v[52:55], v[164:167]
    ds_read_b64_tr_b16 v[70:71], v27 offset:23200
    s_add_u32 m0, s73, 2048
    v_mfma_f32_16x16x32_bf16 v[168:171], v[72:75], v[56:59], v[168:171]
    buffer_load_dwordx4 v10, s[28:31], s44 offen lds
    v_mfma_f32_16x16x32_bf16 v[172:175], v[72:75], v[60:63], v[172:175]
    v_mfma_f32_16x16x32_bf16 v[112:115], v[72:75], v[28:31], v[112:115]
    s_waitcnt lgkmcnt(4)
    v_mfma_f32_16x16x32_bf16 v[176:179], v[76:79], v[48:51], v[176:179]
    ds_read_b64_tr_b16 v[72:73], v27 offset:15552
    v_mfma_f32_16x16x32_bf16 v[180:183], v[76:79], v[52:55], v[180:183]
    ds_read_b64_tr_b16 v[74:75], v27 offset:23232
    s_add_u32 m0, s73, 3072
    v_mfma_f32_16x16x32_bf16 v[184:187], v[76:79], v[56:59], v[184:187]
    buffer_load_dwordx4 v11, s[28:31], s44 offen lds
    v_mfma_f32_16x16x32_bf16 v[188:191], v[76:79], v[60:63], v[188:191]
    s_waitcnt lgkmcnt(4)
    v_mfma_f32_16x16x32_bf16 v[192:195], v[64:67], v[48:51], v[192:195]
    ds_read_b64_tr_b16 v[76:77], v27 offset:15584
    v_mfma_f32_16x16x32_bf16 v[196:199], v[64:67], v[52:55], v[196:199]
    ds_read_b64_tr_b16 v[78:79], v27 offset:23264
    v_mfma_f32_16x16x32_bf16 v[200:203], v[64:67], v[56:59], v[200:203]
    v_mfma_f32_16x16x32_bf16 v[204:207], v[64:67], v[60:63], v[204:207]
    v_mfma_f32_16x16x32_bf16 v[116:119], v[64:67], v[28:31], v[116:119]
    s_waitcnt lgkmcnt(4)
    v_mfma_f32_16x16x32_bf16 v[208:211], v[48:51], v[68:71], v[208:211]
    v_mfma_f32_16x16x32_bf16 v[212:215], v[52:55], v[68:71], v[212:215]
    v_mfma_f32_16x16x32_bf16 v[216:219], v[56:59], v[68:71], v[216:219]
    v_mfma_f32_16x16x32_bf16 v[220:223], v[60:63], v[68:71], v[220:223]
    s_waitcnt vmcnt(12) lgkmcnt(0)
    s_barrier
    ds_read_b128 v[32:35], v15 offset:0
    ds_read_b128 v[36:39], v15 offset:2048
    ds_read_b128 v[40:43], v15 offset:4096
    ds_read_b128 v[44:47], v15 offset:6144
    v_mfma_f32_16x16x32_bf16 v[224:227], v[48:51], v[72:75], v[224:227]
    ds_read_b64_tr_b16 v[64:65], v12 offset:0
    ds_read_b64_tr_b16 v[66:67], v12 offset:7680
    v_mfma_f32_16x16x32_bf16 v[228:231], v[52:55], v[72:75], v[228:231]
    ds_read_b64_tr_b16 v[68:69], v12 offset:32
    ds_read_b64_tr_b16 v[70:71], v12 offset:7712
    v_mfma_f32_16x16x32_bf16 v[232:235], v[56:59], v[72:75], v[232:235]
    v_mfma_f32_16x16x32_bf16 v[236:239], v[60:63], v[72:75], v[236:239]
    v_mfma_f32_16x16x32_bf16 v[120:123], v[72:75], v[28:31], v[120:123]
    v_mfma_f32_16x16x32_bf16 v[240:243], v[48:51], v[76:79], v[240:243]
    ds_read_b64_tr_b16 v[72:73], v12 offset:64
    v_mfma_f32_16x16x32_bf16 v[244:247], v[52:55], v[76:79], v[244:247]
    ds_read_b64_tr_b16 v[74:75], v12 offset:7744
    v_mfma_f32_16x16x32_bf16 v[248:251], v[56:59], v[76:79], v[248:251]
    v_mfma_f32_16x16x32_bf16 v[252:255], v[60:63], v[76:79], v[252:255]
    s_add_u32 s43, s43, s47
    s_add_u32 s44, s44, 128
    s_min_u32 s44, s44, 1152
    s_mov_b32 s75, s70
    s_mov_b32 s70, s71
    s_mov_b32 s71, s72
    s_mov_b32 s72, s75
    v_add_u32 v27, s70, v26
    v_add_u32 v12, s71, v26
    v_add_u32 v13, s70, v24
    v_add_u32 v14, s70, v25
    v_add_u32 v15, s71, v24
    s_add_u32 s45, s45, 1
    s_cmp_lt_u32 s45, 10
    s_cbranch_scc1 K1_LB0
    s_waitcnt lgkmcnt(0)
    s_nop 9
    v_and_b32 v2, 15, v1
    v_lshrrev_b32 v3, 4, v1
    v_lshlrev_b32 v4, 4, v3
    v_add_u32 v4, 141312, v4
    v_cmp_eq_u32 vcc, 0, v2
    s_and_saveexec_b64 s[56:57], vcc
    ds_write_b128 v4, v[108:111] offset:0
    ds_write_b128 v4, v[112:115] offset:128
    ds_write_b128 v4, v[116:119] offset:256
    ds_write_b128 v4, v[120:123] offset:384
    s_mov_b64 exec, s[56:57]
    v_lshlrev_b32 v7, 3, v2
    v_add_u32 v7, 142336, v7
    v_cmp_eq_u32 vcc, 0, v3
    s_and_saveexec_b64 s[56:57], vcc
    ds_write_b32 v7, v92 offset:0
    ds_write_b32 v7, v96 offset:128
    s_mov_b64 exec, s[56:57]
    s_waitcnt vmcnt(0) lgkmcnt(0)
    s_barrier
    s_branch K1_EB
K1_VB_W1:
    s_mov_b32 s70, 0
    s_mov_b32 s71, 47104
    s_mov_b32 s72, 94208
    v_add_u32 v27, s70, v26
    v_add_u32 v12, s71, v26
    v_add_u32 v13, s70, v24
    v_add_u32 v14, s70, v25
    v_add_u32 v15, s71, v24
    s_waitcnt vmcnt(12)
    s_barrier
    ds_read_b128 v[32:35], v13 offset:0
    ds_read_b128 v[36:39], v13 offset:2048
    ds_read_b128 v[40:43], v13 offset:4096
    ds_read_b128 v[44:47], v13 offset:6144
    ds_read_b64_tr_b16 v[64:65], v27 offset:0
    ds_read_b64_tr_b16 v[66:67], v27 offset:7680
    ds_read_b64_tr_b16 v[68:69], v27 offset:32
    ds_read_b64_tr_b16 v[70:71], v27 offset:7712
    ds_read_b64_tr_b16 v[72:73], v27 offset:64
    ds_read_b64_tr_b16 v[74:75], v27 offset:7744
    s_mov_b32 s45, 0
K1_LB1:
    s_add_u32 s42, s72, s41
    s_add_u32 s73, s72, s74
    s_waitcnt lgkmcnt(4)
    v_mfma_f32_16x16x32_bf16 v[128:131], v[32:35], v[64:67], v[128:131]
    ds_read_b64_tr_b16 v[76:77], v27 offset:96
    v_mfma_f32_16x16x32_bf16 v[132:135], v[36:39], v[64:67], v[132:135]
    ds_read_b64_tr_b16 v[78:79], v27 offset:7776
    s_add_u32 m0, s42, 0
    v_mfma_f32_16x16x32_bf16 v[136:139], v[40:43], v[64:67], v[136:139]
    buffer_load_dwordx4 v16, s[32:35], s43 offen lds
    v_mfma_f32_16x16x32_bf16 v[140:143], v[44:47], v[64:67], v[140:143]
    v_mfma_f32_16x16x32_bf16 v[108:111], v[64:67], v[28:31], v[108:111]
    v_mfma_f32_16x16x32_bf16 v[92:95], v[32:35], v[32:35], v[92:95]
    ds_read_b128 v[48:51], v14 offset:0
    ds_read_b128 v[52:55], v14 offset:2048
    ds_read_b128 v[56:59], v14 offset:4096
    ds_read_b128 v[60:63], v14 offset:6144
    s_waitcnt lgkmcnt(8)
    v_mfma_f32_16x16x32_bf16 v[144:147], v[32:35], v[68:71], v[144:147]
    ds_read_b64_tr_b16 v[80:81], v27 offset:128
    v_mfma_f32_16x16x32_bf16 v[148:151], v[36:39], v[68:71], v[148:151]
    ds_read_b64_tr_b16 v[82:83], v27 offset:7808
    s_add_u32 m0, s42, 4096
    v_mfma_f32_16x16x32_bf16 v[152:155], v[40:43], v[68:71], v[152:155]
    buffer_load_dwordx4 v17, s[32:35], s43 offen lds
    v_mfma_f32_16x16x32_bf16 v[156:159], v[44:47], v[68:71], v[156:159]
    v_mfma_f32_16x16x32_bf16 v[96:99], v[36:39], v[36:39], v[96:99]
    s_waitcnt lgkmcnt(8)
    v_mfma_f32_16x16x32_bf16 v[160:163], v[32:35], v[72:75], v[160:163]
    ds_read_b64_tr_b16 v[84:85], v27 offset:160
    v_mfma_f32_16x16x32_bf16 v[164:167], v[36:39], v[72:75], v[164:167]
    ds_read_b64_tr_b16 v[86:87], v27 offset:7840
    s_add_u32 m0, s42, 8192
    v_mfma_f32_16x16x32_bf16 v[168:171], v[40:43], v[72:75], v[168:171]
    buffer_load_dwordx4 v18, s[32:35], s43 offen lds
    v_mfma_f32_16x16x32_bf16 v[172:175], v[44:47], v[72:75], v[172:175]
    v_mfma_f32_16x16x32_bf16 v[112:115], v[72:75], v[28:31], v[112:115]
    v_mfma_f32_16x16x32_bf16 v[100:103], v[40:43], v[40:43], v[100:103]
    s_waitcnt lgkmcnt(8)
    v_mfma_f32_16x16x32_bf16 v[176:179], v[32:35], v[76:79], v[176:179]
    ds_read_b64_tr_b16 v[88:89], v27 offset:192
    v_mfma_f32_16x16x32_bf16 v[180:183], v[36:39], v[76:79], v[180:183]
    ds_read_b64_tr_b16 v[90:91], v27 offset:7872
    s_add_u32 m0, s42, 12288
    v_mfma_f32_16x16x32_bf16 v[184:187], v[40:43], v[76:79], v[184:187]
    buffer_load_dwordx4 v19, s[32:35], s43 offen lds
    v_mfma_f32_16x16x32_bf16 v[188:191], v[44:47], v[76:79], v[188:191]
    v_mfma_f32_16x16x32_bf16 v[104:107], v[44:47], v[44:47], v[104:107]
    s_waitcnt lgkmcnt(4)
    v_mfma_f32_16x16x32_bf16 v[192:195], v[32:35], v[80:83], v[192:195]
    ds_read_b64_tr_b16 v[64:65], v27 offset:15360
    v_mfma_f32_16x16x32_bf16 v[196:199], v[36:39], v[80:83], v[196:199]
    ds_read_b64_tr_b16 v[66:67], v27 offset:23040
    s_add_u32 m0, s42, 16384
    v_mfma_f32_16x16x32_bf16 v[200:203], v[40:43], v[80:83], v[200:203]
    buffer_load_dwordx4 v20, s[32:35], s43 offen lds
    v_mfma_f32_16x16x32_bf16 v[204:207], v[44:47], v[80:83], v[204:207]
    v_mfma_f32_16x16x32_bf16 v[116:119], v[80:83], v[28:31], v[116:119]
    v_mfma_f32_16x16x32_bf16 v[240:243], v[28:31], v[40:43], v[240:243]
    s_waitcnt lgkmcnt(4)
    v_mfma_f32_16x16x32_bf16 v[208:211], v[32:35], v[84:87], v[208:211]
    ds_read_b64_tr_b16 v[68:69], v27 offset:15392
    v_mfma_f32_16x16x32_bf16 v[212:215], v[36:39], v[84:87], v[212:215]
    ds_read_b64_tr_b16 v[70:71], v27 offset:23072
    s_add_u32 m0, s42, 20480
    v_mfma_f32_16x16x32_bf16 v[216:219], v[40:43], v[84:87], v[216:219]
    buffer_load_dwordx4 v21, s[32:35], s43 offen lds
    v_mfma_f32_16x16x32_bf16 v[220:223], v[44:47], v[84:87], v[220:223]
    v_mfma_f32_16x16x32_bf16 v[244:247], v[28:31], v[44:47], v[244:247]
    s_waitcnt lgkmcnt(4)
    v_mfma_f32_16x16x32_bf16 v[224:227], v[32:35], v[88:91], v[224:227]
    ds_read_b64_tr_b16 v[72:73], v27 offset:15424
    v_mfma_f32_16x16x32_bf16 v[228:231], v[36:39], v[88:91], v[228:231]
    ds_read_b64_tr_b16 v[74:75], v27 offset:23104
    s_add_u32 m0, s42, 24576
    v_mfma_f32_16x16x32_bf16 v[232:235], v[40:43], v[88:91], v[232:235]
    buffer_load_dwordx4 v22, s[32:35], s43 offen lds
    v_mfma_f32_16x16x32_bf16 v[236:239], v[44:47], v[88:91], v[236:239]
    v_mfma_f32_16x16x32_bf16 v[120:123], v[88:91], v[28:31], v[120:123]
    s_waitcnt lgkmcnt(4)
    v_mfma_f32_16x16x32_bf16 v[128:131], v[48:51], v[64:67], v[128:131]
    ds_read_b64_tr_b16 v[76:77], v27 offset:15456
    v_mfma_f32_16x16x32_bf16 v[132:135], v[52:55], v[64:67], v[132:135]
    ds_read_b64_tr_b16 v[78:79], v27 offset:23136
    s_add_u32 m0, s42, 28672
    v_mfma_f32_16x16x32_bf16 v[136:139], v[56:59], v[64:67], v[136:139]
    buffer_load_dwordx4 v23, s[32:35], s43 offen lds
    v_mfma_f32_16x16x32_bf16 v[140:143], v[60:63], v[64:67], v[140:143]
    v_mfma_f32_16x16x32_bf16 v[108:111], v[64:67], v[28:31], v[108:111]
    v_mfma_f32_16x16x32_bf16 v[92:95], v[48:51], v[48:51], v[92:95]
    s_waitcnt lgkmcnt(4)
    v_mfma_f32_16x16x32_bf16 v[144:147], v[48:51], v[68:71], v[144:147]
    ds_read_b64_tr_b16 v[80:81], v27 offset:15488
    v_mfma_f32_16x16x32_bf16 v[148:151], v[52:55], v[68:71], v[148:151]
    ds_read_b64_tr_b16 v[82:83], v27 offset:23168
    s_add_u32 m0, s73, 0
    v_mfma_f32_16x16x32_bf16 v[152:155], v[56:59], v[68:71], v[152:155]
    buffer_load_dwordx4 v8, s[28:31], s44 offen lds
    v_mfma_f32_16x16x32_bf16 v[156:159], v[60:63], v[68:71], v[156:159]
    v_mfma_f32_16x16x32_bf16 v[96:99], v[52:55], v[52:55], v[96:99]
    s_waitcnt lgkmcnt(4)
    v_mfma_f32_16x16x32_bf16 v[160:163], v[48:51], v[72:75], v[160:163]
    ds_read_b64_tr_b16 v[84:85], v27 offset:15520
    v_mfma_f32_16x16x32_bf16 v[164:167], v[52:55], v[72:75], v[164:167]
    ds_read_b64_tr_b16 v[86:87], v27 offset:23200
    s_add_u32 m0, s73, 1024
    v_mfma_f32_16x16x32_bf16 v[168:171], v[56:59], v[72:75], v[168:171]
    buffer_load_dwordx4 v9, s[28:31], s44 offen lds
    v_mfma_f32_16x16x32_bf16 v[172:175], v[60:63], v[72:75], v[172:175]
    v_mfma_f32_16x16x32_bf16 v[112:115], v[72:75], v[28:31], v[112:115]
    v_mfma_f32_16x16x32_bf16 v[100:103], v[56:59], v[56:59], v[100:103]
    s_waitcnt lgkmcnt(4)
    v_mfma_f32_16x16x32_bf16 v[176:179], v[48:51], v[76:79], v[176:179]
    ds_read_b64_tr_b16 v[88:89], v27 offset:15552
    v_mfma_f32_16x16x32_bf16 v[180:183], v[52:55], v[76:79], v[180:183]
    ds_read_b64_tr_b16 v[90:91], v27 offset:23232
    s_add_u32 m0, s73, 2048
    v_mfma_f32_16x16x32_bf16 v[184:187], v[56:59], v[76:79], v[184:187]
    buffer_load_dwordx4 v10, s[28:31], s44 offen lds
    v_mfma_f32_16x16x32_bf16 v[188:191], v[60:63], v[76:79], v[188:191]
    v_mfma_f32_16x16x32_bf16 v[104:107], v[60:63], v[60:63], v[104:107]
    s_waitcnt lgkmcnt(4)
    v_mfma_f32_16x16x32_bf16 v[192:195], v[48:51], v[80:83], v[192:195]
    v_mfma_f32_16x16x32_bf16 v[196:199], v[52:55], v[80:83], v[196:199]
    s_add_u32 m0, s73, 3072
    v_mfma_f32_16x16x32_bf16 v[200:203], v[56:59], v[80:83], v[200:203]
    buffer_load_dwordx4 v11, s[28:31], s44 offen lds
    s_cmp_lg_u32 s45, 0
    s_cbranch_scc1 K1_T_9
    buffer_load_dword v124, v126, s[28:31], 0 offen
    buffer_load_dword v125, v127, s[32:35], 0 offen
K1_T_9:
    v_mfma_f32_16x16x32_bf16 v[204:207], v[60:63], v[80:83], v[204:207]
    v_mfma_f32_16x16x32_bf16 v[116:119], v[80:83], v[28:31], v[116:119]
    v_mfma_f32_16x16x32_bf16 v[240:243], v[28:31], v[56:59], v[240:243]
    s_waitcnt vmcnt(12) lgkmcnt(0)
    s_barrier
    ds_read_b128 v[32:35], v15 offset:0
    ds_read_b128 v[36:39], v15 offset:2048
    ds_read_b128 v[40:43], v15 offset:4096
    ds_read_b128 v[44:47], v15 offset:6144
    v_mfma_f32_16x16x32_bf16 v[208:211], v[48:51], v[84:87], v[208:211]
    ds_read_b64_tr_b16 v[64:65], v12 offset:0
    ds_read_b64_tr_b16 v[66:67], v12 offset:7680
    v_mfma_f32_16x16x32_bf16 v[212:215], v[52:55], v[84:87], v[212:215]
    ds_read_b64_tr_b16 v[68:69], v12 offset:32
    ds_read_b64_tr_b16 v[70:71], v12 offset:7712
    v_mfma_f32_16x16x32_bf16 v[216:219], v[56:59], v[84:87], v[216:219]
    v_mfma_f32_16x16x32_bf16 v[220:223], v[60:63], v[84:87], v[220:223]
    v_mfma_f32_16x16x32_bf16 v[244:247], v[28:31], v[60:63], v[244:247]
    v_mfma_f32_16x16x32_bf16 v[224:227], v[48:51], v[88:91], v[224:227]
    ds_read_b64_tr_b16 v[72:73], v12 offset:64
    v_mfma_f32_16x16x32_bf16 v[228:231], v[52:55], v[88:91], v[228:231]
    ds_read_b64_tr_b16 v[74:75], v12 offset:7744
    v_mfma_f32_16x16x32_bf16 v[232:235], v[56:59], v[88:91], v[232:235]
    v_mfma_f32_16x16x32_bf16 v[236:239], v[60:63], v[88:91], v[236:239]
    v_mfma_f32_16x16x32_bf16 v[120:123], v[88:91], v[28:31], v[120:123]
    s_add_u32 s43, s43, s47
    s_add_u32 s44, s44, 128
    s_min_u32 s44, s44, 1152
    s_mov_b32 s75, s70
    s_mov_b32 s70, s71
    s_mov_b32 s71, s72
    s_mov_b32 s72, s75
    v_add_u32 v27, s70, v26
    v_add_u32 v12, s71, v26
    v_add_u32 v13, s70, v24
    v_add_u32 v14, s70, v25
    v_add_u32 v15, s71, v24
    s_add_u32 s45, s45, 1
    s_cmp_lt_u32 s45, 10
    s_cbranch_scc1 K1_LB1
    s_waitcnt lgkmcnt(0)
    s_nop 9
    v_and_b32 v2, 15, v1
    v_lshrrev_b32 v3, 4, v1
    v_lshlrev_b32 v4, 4, v3
    v_add_u32 v4, 141312, v4
    v_cmp_eq_u32 vcc, 0, v2
    s_and_saveexec_b64 s[56:57], vcc
    ds_write_b128 v4, v[108:111] offset:512
    ds_write_b128 v4, v[112:115] offset:640
    ds_write_b128 v4, v[116:119] offset:768
    ds_write_b128 v4, v[120:123] offset:896
    s_mov_b64 exec, s[56:57]
    v_lshlrev_b32 v7, 3, v2
    v_add_u32 v7, 142336, v7
    v_cmp_eq_u32 vcc, 0, v3
    s_and_saveexec_b64 s[56:57], vcc
    ds_write_b32 v7, v240 offset:256
    ds_write_b32 v7, v244 offset:384
    s_mov_b64 exec, s[56:57]
    v_and_b32 v5, 3, v2
    v_lshrrev_b32 v6, 2, v2
    v_cmp_eq_u32 s[62:63], 1, v5
    v_cmp_eq_u32 s[64:65], 2, v5
    v_cmp_eq_u32 s[66:67], 3, v5
    v_cmp_eq_u32 vcc, v6, v3
    s_and_saveexec_b64 s[56:57], vcc
    v_mov_b32 v8, v92
    v_cndmask_b32 v8, v8, v93, s[62:63]
    v_cndmask_b32 v8, v8, v94, s[64:65]
    v_cndmask_b32 v8, v8, v95, s[66:67]
    ds_write_b32 v7, v8 offset:4
    s_nop 0
    v_mov_b32 v8, v96
    v_cndmask_b32 v8, v8, v97, s[62:63]
    v_cndmask_b32 v8, v8, v98, s[64:65]
    v_cndmask_b32 v8, v8, v99, s[66:67]
    ds_write_b32 v7, v8 offset:132
    s_nop 0
    v_mov_b32 v8, v100
    v_cndmask_b32 v8, v8, v101, s[62:63]
    v_cndmask_b32 v8, v8, v102, s[64:65]
    v_cndmask_b32 v8, v8, v103, s[66:67]
    ds_write_b32 v7, v8 offset:260
    s_nop 0
    v_mov_b32 v8, v104
    v_cndmask_b32 v8, v8, v105, s[62:63]
    v_cndmask_b32 v8, v8, v106, s[64:65]
    v_cndmask_b32 v8, v8, v107, s[66:67]
    ds_write_b32 v7, v8 offset:388
    s_nop 0
    s_mov_b64 exec, s[56:57]
    s_waitcnt vmcnt(0) lgkmcnt(0)
    s_barrier
    s_branch K1_EB
K1_VB_W2:
    s_mov_b32 s70, 0
    s_mov_b32 s71, 47104
    s_mov_b32 s72, 94208
    v_add_u32 v27, s70, v26
    v_add_u32 v12, s71, v26
    v_add_u32 v13, s70, v24
    v_add_u32 v14, s70, v25
    v_add_u32 v15, s71, v24
    s_waitcnt vmcnt(11)
    s_barrier
    ds_read_b128 v[32:35], v13 offset:0
    ds_read_b128 v[36:39], v13 offset:2048
    ds_read_b128 v[40:43], v13 offset:4096
    ds_read_b128 v[44:47], v13 offset:6144
    ds_read_b64_tr_b16 v[64:65], v27 offset:0
    ds_read_b64_tr_b16 v[66:67], v27 offset:7680
    ds_read_b64_tr_b16 v[68:69], v27 offset:32
    ds_read_b64_tr_b16 v[70:71], v27 offset:7712
    ds_read_b64_tr_b16 v[72:73], v27 offset:64
    ds_read_b64_tr_b16 v[74:75], v27 offset:7744
    s_mov_b32 s45, 0
K1_LB2:
    s_add_u32 s42, s72, s41
    s_add_u32 s73, s72, s74
    s_waitcnt lgkmcnt(4)
    v_mfma_f32_16x16x32_bf16 v[128:131], v[64:67], v[32:35], v[128:131]
    ds_read_b64_tr_b16 v[76:77], v27 offset:96
    v_mfma_f32_16x16x32_bf16 v[132:135], v[64:67], v[36:39], v[132:135]
    ds_read_b64_tr_b16 v[78:79], v27 offset:7776
    s_add_u32 m0, s42, 0
    v_mfma_f32_16x16x32_bf16 v[136:139], v[64:67], v[40:43], v[136:139]
    buffer_load_dwordx4 v16, s[32:35], s43 offen lds
    v_mfma_f32_16x16x32_bf16 v[140:143], v[64:67], v[44:47], v[140:143]
    v_mfma_f32_16x16x32_bf16 v[92:95], v[28:31], v[32:35], v[92:95]
    ds_read_b128 v[48:51], v14 offset:0
    ds_read_b128 v[52:55], v14 offset:2048
    ds_read_b128 v[56:59], v14 offset:4096
    ds_read_b128 v[60:63], v14 offset:6144
    s_waitcnt lgkmcnt(8)
    v_mfma_f32_16x16x32_bf16 v[144:147], v[68:71], v[32:35], v[144:147]
    ds_read_b64_tr_b16 v[64:65], v27 offset:128
    v_mfma_f32_16x16x32_bf16 v[148:151], v[68:71], v[36:39], v[148:151]
    ds_read_b64_tr_b16 v[66:67], v27 offset:7808
    s_add_u32 m0, s42, 4096
    v_mfma_f32_16x16x32_bf16 v[152:155], v[68:71], v[40:43], v[152:155]
    buffer_load_dwordx4 v17, s[32:35], s43 offen lds
    v_mfma_f32_16x16x32_bf16 v[156:159], v[68:71], v[44:47], v[156:159]
    v_mfma_f32_16x16x32_bf16 v[108:111], v[68:71], v[28:31], v[108:111]
    v_mfma_f32_16x16x32_bf16 v[96:99], v[28:31], v[36:39], v[96:99]
    s_waitcnt lgkmcnt(8)
    v_mfma_f32_16x16x32_bf16 v[160:163], v[72:75], v[32:35], v[160:163]
    ds_read_b64_tr_b16 v[68:69], v27 offset:160
    v_mfma_f32_16x16x32_bf16 v[164:167], v[72:75], v[36:39], v[164:167]
    ds_read_b64_tr_b16 v[70:71], v27 offset:7840
    s_add_u32 m0, s42, 8192
    v_mfma_f32_16x16x32_bf16 v[168:171], v[72:75], v[40:43], v[168:171]
    buffer_load_dwordx4 v18, s[32:35], s43 offen lds
    v_mfma_f32_16x16x32_bf16 v[172:175], v[72:75], v[44:47], v[172:175]
    s_waitcnt lgkmcnt(8)
    v_mfma_f32_16x16x32_bf16 v[176:179], v[76:79], v[32:35], v[176:179]
    ds_read_b64_tr_b16 v[72:73], v27 offset:192
    v_mfma_f32_16x16x32_bf16 v[180:183], v[76:79], v[36:39], v[180:183]
    ds_read_b64_tr_b16 v[74:75], v27 offset:7872
    s_add_u32 m0, s42, 12288
    v_mfma_f32_16x16x32_bf16 v[184:187], v[76:79], v[40:43], v[184:187]
    buffer_load_dwordx4 v19, s[32:35], s43 offen lds
    v_mfma_f32_16x16x32_bf16 v[188:191], v[76:79], v[44:47], v[188:191]
    v_mfma_f32_16x16x32_bf16 v[112:115], v[76:79], v[28:31], v[112:115]
    s_waitcnt lgkmcnt(4)
    v_mfma_f32_16x16x32_bf16 v[192:195], v[64:67], v[32:35], v[192:195]
    ds_read_b64_tr_b16 v[76:77], v27 offset:224
    v_mfma_f32_16x16x32_bf16 v[196:199], v[64:67], v[36:39], v[196:199]
    ds_read_b64_tr_b16 v[78:79], v27 offset:7904
    s_add_u32 m0, s42, 16384
    v_mfma_f32_16x16x32_bf16 v[200:203], v[64:67], v[40:43], v[200:203]
    buffer_load_dwordx4 v20, s[32:35], s43 offen lds
    v_mfma_f32_16x16x32_bf16 v[204:207], v[64:67], v[44:47], v[204:207]
    s_waitcnt lgkmcnt(4)
    v_mfma_f32_16x16x32_bf16 v[208:211], v[32:35], v[68:71], v[208:211]
    ds_read_b64_tr_b16 v[64:65], v27 offset:15360
    v_mfma_f32_16x16x32_bf16 v[212:215], v[36:39], v[68:71], v[212:215]
    ds_read_b64_tr_b16 v[66:67], v27 offset:23040
    s_add_u32 m0, s42, 20480
    v_mfma_f32_16x16x32_bf16 v[216:219], v[40:43], v[68:71], v[216:219]
    buffer_load_dwordx4 v21, s[32:35], s43 offen lds
    v_mfma_f32_16x16x32_bf16 v[220:223], v[44:47], v[68:71], v[220:223]
    v_mfma_f32_16x16x32_bf16 v[116:119], v[68:71], v[28:31], v[116:119]
    s_waitcnt lgkmcnt(4)
    v_mfma_f32_16x16x32_bf16 v[224:227], v[32:35], v[72:75], v[224:227]
    ds_read_b64_tr_b16 v[68:69], v27 offset:15392
    v_mfma_f32_16x16x32_bf16 v[228:231], v[36:39], v[72:75], v[228:231]
    ds_read_b64_tr_b16 v[70:71], v27 offset:23072
    s_add_u32 m0, s42, 24576
    v_mfma_f32_16x16x32_bf16 v[232:235], v[40:43], v[72:75], v[232:235]
    buffer_load_dwordx4 v22, s[32:35], s43 offen lds
    v_mfma_f32_16x16x32_bf16 v[236:239], v[44:47], v[72:75], v[236:239]
    s_waitcnt lgkmcnt(4)
    v_mfma_f32_16x16x32_bf16 v[240:243], v[32:35], v[76:79], v[240:243]
    ds_read_b64_tr_b16 v[72:73], v27 offset:15424
    v_mfma_f32_16x16x32_bf16 v[244:247], v[36:39], v[76:79], v[244:247]
    ds_read_b64_tr_b16 v[74:75], v27 offset:23104
    s_add_u32 m0, s73, 0
    v_mfma_f32_16x16x32_bf16 v[248:251], v[40:43], v[76:79], v[248:251]
    buffer_load_dwordx4 v8, s[28:31], s44 offen lds
    v_mfma_f32_16x16x32_bf16 v[252:255], v[44:47], v[76:79], v[252:255]
    v_mfma_f32_16x16x32_bf16 v[120:123], v[76:79], v[28:31], v[120:123]
    s_waitcnt lgkmcnt(4)
    v_mfma_f32_16x16x32_bf16 v[128:131], v[64:67], v[48:51], v[128:131]
    ds_read_b64_tr_b16 v[76:77], v27 offset:15456
    v_mfma_f32_16x16x32_bf16 v[132:135], v[64:67], v[52:55], v[132:135]
    ds_read_b64_tr_b16 v[78:79], v27 offset:23136
    s_add_u32 m0, s73, 1024
    v_mfma_f32_16x16x32_bf16 v[136:139], v[64:67], v[56:59], v[136:139]
    buffer_load_dwordx4 v9, s[28:31], s44 offen lds
    v_mfma_f32_16x16x32_bf16 v[140:143], v[64:67], v[60:63], v[140:143]
    v_mfma_f32_16x16x32_bf16 v[92:95], v[28:31], v[48:51], v[92:95]
    s_waitcnt lgkmcnt(4)
    v_mfma_f32_16x16x32_bf16 v[144:147], v[68:71], v[48:51], v[144:147]
    ds_read_b64_tr_b16 v[64:65], v27 offset:15488
    v_mfma_f32_16x16x32_bf16 v[148:151], v[68:71], v[52:55], v[148:151]
    ds_read_b64_tr_b16 v[66:67], v27 offset:23168
    s_add_u32 m0, s73, 2048
    v_mfma_f32_16x16x32_bf16 v[152:155], v[68:71], v[56:59], v[152:155]
    buffer_load_dwordx4 v10, s[28:31], s44 offen lds
    v_mfma_f32_16x16x32_bf16 v[156:159], v[68:71], v[60:63], v[156:159]
    v_mfma_f32_16x16x32_bf16 v[108:111], v[68:71], v[28:31], v[108:111]
    v_mfma_f32_16x16x32_bf16 v[96:99], v[28:31], v[52:55], v[96:99]
    s_waitcnt lgkmcnt(4)
    v_mfma_f32_16x16x32_bf16 v[160:163], v[72:75], v[48:51], v[160:163]
    ds_read_b64_tr_b16 v[68:69], v27 offset:15520
    v_mfma_f32_16x16x32_bf16 v[164:167], v[72:75], v[52:55], v[164:167]
    ds_read_b64_tr_b16 v[70:71], v27 offset:23200
    s_add_u32 m0, s73, 3072
    v_mfma_f32_16x16x32_bf16 v[168:171], v[72:75], v[56:59], v[168:171]
    buffer_load_dwordx4 v11, s[28:31], s44 offen lds
    s_cmp_lg_u32 s45, 2
    s_cbranch_scc1 K1_T_10
    buffer_load_dword v124, v126, s[28:31], 0 offen
    buffer_load_dword v125, v127, s[32:35], 0 offen
K1_T_10:
    v_mfma_f32_16x16x32_bf16 v[172:175], v[72:75], v[60:63], v[172:175]
    s_waitcnt lgkmcnt(4)
    v_mfma_f32_16x16x32_bf16 v[176:179], v[76:79], v[48:51], v[176:179]
    ds_read_b64_tr_b16 v[72:73], v27 offset:15552
    v_mfma_f32_16x16x32_bf16 v[180:183], v[76:79], v[52:55], v[180:183]
    ds_read_b64_tr_b16 v[74:75], v27 offset:23232
    v_mfma_f32_16x16x32_bf16 v[184:187], v[76:79], v[56:59], v[184:187]
    v_mfma_f32_16x16x32_bf16 v[188:191], v[76:79], v[60:63], v[188:191]
    v_mfma_f32_16x16x32_bf16 v[112:115], v[76:79], v[28:31], v[112:115]
    s_waitcnt lgkmcnt(4)
    v_mfma_f32_16x16x32_bf16 v[192:195], v[64:67], v[48:51], v[192:195]
    ds_read_b64_tr_b16 v[76:77], v27 offset:15584
    v_mfma_f32_16x16x32_bf16 v[196:199], v[64:67], v[52:55], v[196:199]
    ds_read_b64_tr_b16 v[78:79], v27 offset:23264
    v_mfma_f32_16x16x32_bf16 v[200:203], v[64:67], v[56:59], v[200:203]
    v_mfma_f32_16x16x32_bf16 v[204:207], v[64:67], v[60:63], v[204:207]
    s_waitcnt lgkmcnt(4)
    v_mfma_f32_16x16x32_bf16 v[208:211], v[48:51], v[68:71], v[208:211]
    v_mfma_f32_16x16x32_bf16 v[212:215], v[52:55], v[68:71], v[212:215]
    v_mfma_f32_16x16x32_bf16 v[216:219], v[56:59], v[68:71], v[216:219]
    v_mfma_f32_16x16x32_bf16 v[220:223], v[60:63], v[68:71], v[220:223]
    v_mfma_f32_16x16x32_bf16 v[116:119], v[68:71], v[28:31], v[116:119]
    s_waitcnt vmcnt(11) lgkmcnt(0)
    s_barrier
    ds_read_b128 v[32:35], v15 offset:0
    ds_read_b128 v[36:39], v15 offset:2048
    ds_read_b128 v[40:43], v15 offset:4096
    ds_read_b128 v[44:47], v15 offset:6144
    v_mfma_f32_16x16x32_bf16 v[224:227], v[48:51], v[72:75], v[224:227]
    ds_read_b64_tr_b16 v[64:65], v12 offset:0
    ds_read_b64_tr_b16 v[66:67], v12 offset:7680
    v_mfma_f32_16x16x32_bf16 v[228:231], v[52:55], v[72:75], v[228:231]
    ds_read_b64_tr_b16 v[68:69], v12 offset:32
    ds_read_b64_tr_b16 v[70:71], v12 offset:7712
    v_mfma_f32_16x16x32_bf16 v[232:235], v[56:59], v[72:75], v[232:235]
    v_mfma_f32_16x16x32_bf16 v[236:239], v[60:63], v[72:75], v[236:239]
    v_mfma_f32_16x16x32_bf16 v[240:243], v[48:51], v[76:79], v[240:243]
    ds_read_b64_tr_b16 v[72:73], v12 offset:64
    v_mfma_f32_16x16x32_bf16 v[244:247], v[52:55], v[76:79], v[244:247]
    ds_read_b64_tr_b16 v[74:75], v12 offset:7744
    v_mfma_f32_16x16x32_bf16 v[248:251], v[56:59], v[76:79], v[248:251]
    v_mfma_f32_16x16x32_bf16 v[252:255], v[60:63], v[76:79], v[252:255]
    v_mfma_f32_16x16x32_bf16 v[120:123], v[76:79], v[28:31], v[120:123]
    s_add_u32 s43, s43, s47
    s_add_u32 s44, s44, 128
    s_min_u32 s44, s44, 1152
    s_mov_b32 s75, s70
    s_mov_b32 s70, s71
    s_mov_b32 s71, s72
    s_mov_b32 s72, s75
    v_add_u32 v27, s70, v26
    v_add_u32 v12, s71, v26
    v_add_u32 v13, s70, v24
    v_add_u32 v14, s70, v25
    v_add_u32 v15, s71, v24
    s_add_u32 s45, s45, 1
    s_cmp_lt_u32 s45, 10
    s_cbranch_scc1 K1_LB2
    s_waitcnt lgkmcnt(0)
    s_nop 9
    v_and_b32 v2, 15, v1
    v_lshrrev_b32 v3, 4, v1
    v_lshlrev_b32 v4, 4, v3
    v_add_u32 v4, 141312, v4
    v_cmp_eq_u32 vcc, 0, v2
    s_and_saveexec_b64 s[56:57], vcc
    ds_write_b128 v4, v[108:111] offset:64
    ds_write_b128 v4, v[112:115] offset:192
    ds_write_b128 v4, v[116:119] offset:320
    ds_write_b128 v4, v[120:123] offset:448
    s_mov_b64 exec, s[56:57]
    v_lshlrev_b32 v7, 3, v2
    v_add_u32 v7, 142848, v7
    v_cmp_eq_u32 vcc, 0, v3
    s_and_saveexec_b64 s[56:57], vcc
    ds_write_b32 v7, v92 offset:0
    ds_write_b32 v7, v96 offset:128
    s_mov_b64 exec, s[56:57]
    s_waitcnt vmcnt(0) lgkmcnt(0)
    s_barrier
    s_branch K1_EB
K1_VB_W3:
    s_mov_b32 s70, 0
    s_mov_b32 s71, 47104
    s_mov_b32 s72, 94208
    v_add_u32 v27, s70, v26
    v_add_u32 v12, s71, v26
    v_add_u32 v13, s70, v24
    v_add_u32 v14, s70, v25
    v_add_u32 v15, s71, v24
    s_waitcnt vmcnt(11)
    s_barrier
    ds_read_b128 v[32:35], v13 offset:0
    ds_read_b128 v[36:39], v13 offset:2048
    ds_read_b128 v[40:43], v13 offset:4096
    ds_read_b128 v[44:47], v13 offset:6144
    ds_read_b64_tr_b16 v[64:65], v27 offset:0
    ds_read_b64_tr_b16 v[66:67], v27 offset:7680
    ds_read_b64_tr_b16 v[68:69], v27 offset:32
    ds_read_b64_tr_b16 v[70:71], v27 offset:7712
    ds_read_b64_tr_b16 v[72:73], v27 offset:64
    ds_read_b64_tr_b16 v[74:75], v27 offset:7744
    s_mov_b32 s45, 0
K1_LB3:
    s_add_u32 s42, s72, s41
    s_add_u32 s73, s72, s74
    s_waitcnt lgkmcnt(4)
    v_mfma_f32_16x16x32_bf16 v[128:131], v[32:35], v[64:67], v[128:131]
    ds_read_b64_tr_b16 v[76:77], v27 offset:96
    v_mfma_f32_16x16x32_bf16 v[132:135], v[36:39], v[64:67], v[132:135]
    ds_read_b64_tr_b16 v[78:79], v27 offset:7776
    s_add_u32 m0, s42, 0
    v_mfma_f32_16x16x32_bf16 v[136:139], v[40:43], v[64:67], v[136:139]
    buffer_load_dwordx4 v16, s[32:35], s43 offen lds
    v_mfma_f32_16x16x32_bf16 v[140:143], v[44:47], v[64:67], v[140:143]
    v_mfma_f32_16x16x32_bf16 v[92:95], v[32:35], v[32:35], v[92:95]
    ds_read_b128 v[48:51], v14 offset:0
    ds_read_b128 v[52:55], v14 offset:2048
    ds_read_b128 v[56:59], v14 offset:4096
    ds_read_b128 v[60:63], v14 offset:6144
    s_waitcnt lgkmcnt(8)
    v_mfma_f32_16x16x32_bf16 v[144:147], v[32:35], v[68:71], v[144:147]
    ds_read_b64_tr_b16 v[80:81], v27 offset:128
    v_mfma_f32_16x16x32_bf16 v[148:151], v[36:39], v[68:71], v[148:151]
    ds_read_b64_tr_b16 v[82:83], v27 offset:7808
    s_add_u32 m0, s42, 4096
    v_mfma_f32_16x16x32_bf16 v[152:155], v[40:43], v[68:71], v[152:155]
    buffer_load_dwordx4 v17, s[32:35], s43 offen lds
    v_mfma_f32_16x16x32_bf16 v[156:159], v[44:47], v[68:71], v[156:159]
    v_mfma_f32_16x16x32_bf16 v[108:111], v[68:71], v[28:31], v[108:111]
    v_mfma_f32_16x16x32_bf16 v[96:99], v[36:39], v[36:39], v[96:99]
    s_waitcnt lgkmcnt(8)
    v_mfma_f32_16x16x32_bf16 v[160:163], v[32:35], v[72:75], v[160:163]
    ds_read_b64_tr_b16 v[84:85], v27 offset:160
    v_mfma_f32_16x16x32_bf16 v[164:167], v[36:39], v[72:75], v[164:167]
    ds_read_b64_tr_b16 v[86:87], v27 offset:7840
    s_add_u32 m0, s42, 8192
    v_mfma_f32_16x16x32_bf16 v[168:171], v[40:43], v[72:75], v[168:171]
    buffer_load_dwordx4 v18, s[32:35], s43 offen lds
    v_mfma_f32_16x16x32_bf16 v[172:175], v[44:47], v[72:75], v[172:175]
    v_mfma_f32_16x16x32_bf16 v[100:103], v[40:43], v[40:43], v[100:103]
    s_waitcnt lgkmcnt(8)
    v_mfma_f32_16x16x32_bf16 v[176:179], v[32:35], v[76:79], v[176:179]
    ds_read_b64_tr_b16 v[88:89], v27 offset:192
    v_mfma_f32_16x16x32_bf16 v[180:183], v[36:39], v[76:79], v[180:183]
    ds_read_b64_tr_b16 v[90:91], v27 offset:7872
    s_add_u32 m0, s42, 12288
    v_mfma_f32_16x16x32_bf16 v[184:187], v[40:43], v[76:79], v[184:187]
    buffer_load_dwordx4 v19, s[32:35], s43 offen lds
    v_mfma_f32_16x16x32_bf16 v[188:191], v[44:47], v[76:79], v[188:191]
    v_mfma_f32_16x16x32_bf16 v[112:115], v[76:79], v[28:31], v[112:115]
    v_mfma_f32_16x16x32_bf16 v[104:107], v[44:47], v[44:47], v[104:107]
    s_waitcnt lgkmcnt(4)
    v_mfma_f32_16x16x32_bf16 v[192:195], v[32:35], v[80:83], v[192:195]
    ds_read_b64_tr_b16 v[64:65], v27 offset:15360
    v_mfma_f32_16x16x32_bf16 v[196:199], v[36:39], v[80:83], v[196:199]
    ds_read_b64_tr_b16 v[66:67], v27 offset:23040
    s_add_u32 m0, s42, 16384
    v_mfma_f32_16x16x32_bf16 v[200:203], v[40:43], v[80:83], v[200:203]
    buffer_load_dwordx4 v20, s[32:35], s43 offen lds
    v_mfma_f32_16x16x32_bf16 v[204:207], v[44:47], v[80:83], v[204:207]
    v_mfma_f32_16x16x32_bf16 v[240:243], v[28:31], v[40:43], v[240:243]
    s_waitcnt lgkmcnt(4)
    v_mfma_f32_16x16x32_bf16 v[208:211], v[32:35], v[84:87], v[208:211]
    ds_read_b64_tr_b16 v[68:69], v27 offset:15392
    v_mfma_f32_16x16x32_bf16 v[212:215], v[36:39], v[84:87], v[212:215]
    ds_read_b64_tr_b16 v[70:71], v27 offset:23072
    s_add_u32 m0, s42, 20480
    v_mfma_f32_16x16x32_bf16 v[216:219], v[40:43], v[84:87], v[216:219]
    buffer_load_dwordx4 v21, s[32:35], s43 offen lds
    v_mfma_f32_16x16x32_bf16 v[220:223], v[44:47], v[84:87], v[220:223]
    v_mfma_f32_16x16x32_bf16 v[116:119], v[84:87], v[28:31], v[116:119]
    v_mfma_f32_16x16x32_bf16 v[244:247], v[28:31], v[44:47], v[244:247]
    s_waitcnt lgkmcnt(4)
    v_mfma_f32_16x16x32_bf16 v[224:227], v[32:35], v[88:91], v[224:227]
    ds_read_b64_tr_b16 v[72:73], v27 offset:15424
    v_mfma_f32_16x16x32_bf16 v[228:231], v[36:39], v[88:91], v[228:231]
    ds_read_b64_tr_b16 v[74:75], v27 offset:23104
    s_add_u32 m0, s42, 24576
    v_mfma_f32_16x16x32_bf16 v[232:235], v[40:43], v[88:91], v[232:235]
    buffer_load_dwordx4 v22, s[32:35], s43 offen lds
    v_mfma_f32_16x16x32_bf16 v[236:239], v[44:47], v[88:91], v[236:239]
    s_waitcnt lgkmcnt(4)
    v_mfma_f32_16x16x32_bf16 v[128:131], v[48:51], v[64:67], v[128:131]
    ds_read_b64_tr_b16 v[76:77], v27 offset:15456
    v_mfma_f32_16x16x32_bf16 v[132:135], v[52:55], v[64:67], v[132:135]
    ds_read_b64_tr_b16 v[78:79], v27 offset:23136
    s_add_u32 m0, s73, 0
    v_mfma_f32_16x16x32_bf16 v[136:139], v[56:59], v[64:67], v[136:139]
    buffer_load_dwordx4 v8, s[28:31], s44 offen lds
    v_mfma_f32_16x16x32_bf16 v[140:143], v[60:63], v[64:67], v[140:143]
    v_mfma_f32_16x16x32_bf16 v[92:95], v[48:51], v[48:51], v[92:95]
    s_waitcnt lgkmcnt(4)
    v_mfma_f32_16x16x32_bf16 v[144:147], v[48:51], v[68:71], v[144:147]
    ds_read_b64_tr_b16 v[80:81], v27 offset:15488
    v_mfma_f32_16x16x32_bf16 v[148:151], v[52:55], v[68:71], v[148:151]
    ds_read_b64_tr_b16 v[82:83], v27 offset:23168
    s_add_u32 m0, s73, 1024
    v_mfma_f32_16x16x32_bf16 v[152:155], v[56:59], v[68:71], v[152:155]
    buffer_load_dwordx4 v9, s[28:31], s44 offen lds
    v_mfma_f32_16x16x32_bf16 v[156:159], v[60:63], v[68:71], v[156:159]
    v_mfma_f32_16x16x32_bf16 v[108:111], v[68:71], v[28:31], v[108:111]
    v_mfma_f32_16x16x32_bf16 v[96:99], v[52:55], v[52:55], v[96:99]
    s_waitcnt lgkmcnt(4)
    v_mfma_f32_16x16x32_bf16 v[160:163], v[48:51], v[72:75], v[160:163]
    ds_read_b64_tr_b16 v[84:85], v27 offset:15520
    v_mfma_f32_16x16x32_bf16 v[164:167], v[52:55], v[72:75], v[164:167]
    ds_read_b64_tr_b16 v[86:87], v27 offset:23200
    s_add_u32 m0, s73, 2048
    v_mfma_f32_16x16x32_bf16 v[168:171], v[56:59], v[72:75], v[168:171]
    buffer_load_dwordx4 v10, s[28:31], s44 offen lds
    v_mfma_f32_16x16x32_bf16 v[172:175], v[60:63], v[72:75], v[172:175]
    v_mfma_f32_16x16x32_bf16 v[100:103], v[56:59], v[56:59], v[100:103]
    s_waitcnt lgkmcnt(4)
    v_mfma_f32_16x16x32_bf16 v[176:179], v[48:51], v[76:79], v[176:179]
    ds_read_b64_tr_b16 v[88:89], v27 offset:15552
    v_mfma_f32_16x16x32_bf16 v[180:183], v[52:55], v[76:79], v[180:183]
    ds_read_b64_tr_b16 v[90:91], v27 offset:23232
    s_add_u32 m0, s73, 3072
    v_mfma_f32_16x16x32_bf16 v[184:187], v[56:59], v[76:79], v[184:187]
    buffer_load_dwordx4 v11, s[28:31], s44 offen lds
    s_cmp_lg_u32 s45, 4
    s_cbranch_scc1 K1_T_11
    buffer_load_dword v124, v126, s[28:31], 0 offen
    buffer_load_dword v125, v127, s[32:35], 0 offen
K1_T_11:
    v_mfma_f32_16x16x32_bf16 v[188:191], v[60:63], v[76:79], v[188:191]
    v_mfma_f32_16x16x32_bf16 v[112:115], v[76:79], v[28:31], v[112:115]
    v_mfma_f32_16x16x32_bf16 v[104:107], v[60:63], v[60:63], v[104:107]
    s_waitcnt lgkmcnt(4)
    v_mfma_f32_16x16x32_bf16 v[192:195], v[48:51], v[80:83], v[192:195]
    v_mfma_f32_16x16x32_bf16 v[196:199], v[52:55], v[80:83], v[196:199]
    v_mfma_f32_16x16x32_bf16 v[200:203], v[56:59], v[80:83], v[200:203]
    v_mfma_f32_16x16x32_bf16 v[204:207], v[60:63], v[80:83], v[204:207]
    v_mfma_f32_16x16x32_bf16 v[240:243], v[28:31], v[56:59], v[240:243]
    s_waitcnt vmcnt(11) lgkmcnt(0)
    s_barrier
    ds_read_b128 v[32:35], v15 offset:0
    ds_read_b128 v[36:39], v15 offset:2048
    ds_read_b128 v[40:43], v15 offset:4096
    ds_read_b128 v[44:47], v15 offset:6144
    v_mfma_f32_16x16x32_bf16 v[208:211], v[48:51], v[84:87], v[208:211]
    ds_read_b64_tr_b16 v[64:65], v12 offset:0
    ds_read_b64_tr_b16 v[66:67], v12 offset:7680
    v_mfma_f32_16x16x32_bf16 v[212:215], v[52:55], v[84:87], v[212:215]
    ds_read_b64_tr_b16 v[68:69], v12 offset:32
    ds_read_b64_tr_b16 v[70:71], v12 offset:7712
    v_mfma_f32_16x16x32_bf16 v[216:219], v[56:59], v[84:87], v[216:219]
    v_mfma_f32_16x16x32_bf16 v[220:223], v[60:63], v[84:87], v[220:223]
    v_mfma_f32_16x16x32_bf16 v[116:119], v[84:87], v[28:31], v[116:119]
    v_mfma_f32_16x16x32_bf16 v[244:247], v[28:31], v[60:63], v[244:247]
    v_mfma_f32_16x16x32_bf16 v[224:227], v[48:51], v[88:91], v[224:227]
    ds_read_b64_tr_b16 v[72:73], v12 offset:64
    v_mfma_f32_16x16x32_bf16 v[228:231], v[52:55], v[88:91], v[228:231]
    ds_read_b64_tr_b16 v[74:75], v12 offset:7744
    v_mfma_f32_16x16x32_bf16 v[232:235], v[56:59], v[88:91], v[232:235]
    v_mfma_f32_16x16x32_bf16 v[236:239], v[60:63], v[88:91], v[236:239]
    s_add_u32 s43, s43, s47
    s_add_u32 s44, s44, 128
    s_min_u32 s44, s44, 1152
    s_mov_b32 s75, s70
    s_mov_b32 s70, s71
    s_mov_b32 s71, s72
    s_mov_b32 s72, s75
    v_add_u32 v27, s70, v26
    v_add_u32 v12, s71, v26
    v_add_u32 v13, s70, v24
    v_add_u32 v14, s70, v25
    v_add_u32 v15, s71, v24
    s_add_u32 s45, s45, 1
    s_cmp_lt_u32 s45, 10
    s_cbranch_scc1 K1_LB3
    s_waitcnt lgkmcnt(0)
    s_nop 9
    v_and_b32 v2, 15, v1
    v_lshrrev_b32 v3, 4, v1
    v_lshlrev_b32 v4, 4, v3
    v_add_u32 v4, 141312, v4
    v_cmp_eq_u32 vcc, 0, v2
    s_and_saveexec_b64 s[56:57], vcc
    ds_write_b128 v4, v[108:111] offset:576
    ds_write_b128 v4, v[112:115] offset:704
    ds_write_b128 v4, v[116:119] offset:832
    s_mov_b64 exec, s[56:57]
    v_lshlrev_b32 v7, 3, v2
    v_add_u32 v7, 142848, v7
    v_cmp_eq_u32 vcc, 0, v3
    s_and_saveexec_b64 s[56:57], vcc
    ds_write_b32 v7, v240 offset:256
    ds_write_b32 v7, v244 offset:384
    s_mov_b64 exec, s[56:57]
    v_and_b32 v5, 3, v2
    v_lshrrev_b32 v6, 2, v2
    v_cmp_eq_u32 s[62:63], 1, v5
    v_cmp_eq_u32 s[64:65], 2, v5
    v_cmp_eq_u32 s[66:67], 3, v5
    v_cmp_eq_u32 vcc, v6, v3
    s_and_saveexec_b64 s[56:57], vcc
    v_mov_b32 v8, v92
    v_cndmask_b32 v8, v8, v93, s[62:63]
    v_cndmask_b32 v8, v8, v94, s[64:65]
    v_cndmask_b32 v8, v8, v95, s[66:67]
    ds_write_b32 v7, v8 offset:4
    s_nop 0
    v_mov_b32 v8, v96
    v_cndmask_b32 v8, v8, v97, s[62:63]
    v_cndmask_b32 v8, v8, v98, s[64:65]
    v_cndmask_b32 v8, v8, v99, s[66:67]
    ds_write_b32 v7, v8 offset:132
    s_nop 0
    v_mov_b32 v8, v100
    v_cndmask_b32 v8, v8, v101, s[62:63]
    v_cndmask_b32 v8, v8, v102, s[64:65]
    v_cndmask_b32 v8, v8, v103, s[66:67]
    ds_write_b32 v7, v8 offset:260
    s_nop 0
    v_mov_b32 v8, v104
    v_cndmask_b32 v8, v8, v105, s[62:63]
    v_cndmask_b32 v8, v8, v106, s[64:65]
    v_cndmask_b32 v8, v8, v107, s[66:67]
    ds_write_b32 v7, v8 offset:388
    s_nop 0
    s_mov_b64 exec, s[56:57]
    s_waitcnt vmcnt(0) lgkmcnt(0)
    s_barrier
    s_branch K1_EB
K1_EB:
    v_and_b32 v2, 15, v1
    v_lshrrev_b32 v3, 4, v1
    s_cmp_ge_u32 s26, 2
    s_cbranch_scc1 K1_S2_12
    s_lshl_b32 s3, s26, 9
    s_add_u32 s3, s3, 142336
    v_lshlrev_b32 v7, 3, v1
    v_add_u32 v7, s3, v7
    ds_read_b64 v[8:9], v7
    s_waitcnt lgkmcnt(0)
    v_mul_f32 v9, 0x3acccccd, v9
    v_mul_f32 v8, 0x3acccccd, v8
    v_fma_f32 v9, -v8, v8, v9
    v_max_f32 v9, 0, v9
    v_add_f32 v9, 0x3727c5ac, v9
    v_rsq_f32 v10, v9
    s_nop 5
    v_mul_f32 v11, v8, v10
    v_sub_f32 v11, 0, v11
    ds_write_b64 v7, v[10:11]
    s_waitcnt lgkmcnt(0)
K1_S2_12:
    s_barrier
    s_lshr_b32 s58, s26, 1
    s_lshl_b32 s58, s58, 9
    s_add_u32 s58, s58, 142336
    s_and_b32 s57, s26, 1
    s_cmp_eq_u32 s57, 1
    s_cbranch_scc1 K1_EB1
    v_lshlrev_b32 v7, 3, v2
    v_add_u32 v7, s58, v7
    ds_read_b64 v[32:33], v7 offset:0
    ds_read_b64 v[34:35], v7 offset:128
    ds_read_b64 v[36:37], v7 offset:256
    ds_read_b64 v[38:39], v7 offset:384
    v_lshlrev_b32 v7, 5, v3
    v_add_u32 v7, s58, v7
    ds_read_b128 v[40:43], v7 offset:0
    ds_read_b128 v[44:47], v7 offset:16
    ds_read_b128 v[48:51], v7 offset:128
    ds_read_b128 v[52:55], v7 offset:144
    ds_read_b128 v[56:59], v7 offset:256
    ds_read_b128 v[60:63], v7 offset:272
    ds_read_b128 v[64:67], v7 offset:384
    ds_read_b128 v[68:71], v7 offset:400
    v_lshlrev_b32 v4, 4, v3
    v_add_u32 v4, 141312, v4
    v_lshlrev_b32 v5, 2, v2
    v_add_u32 v5, 141312, v5
    ds_read_b128 v[72:75], v4 offset:0
    ds_read_b128 v[76:79], v4 offset:64
    ds_read_b128 v[80:83], v4 offset:128
    ds_read_b128 v[84:87], v4 offset:192
    ds_read_b128 v[88:91], v4 offset:256
    ds_read_b32 v92, v5 offset:320
    ds_read_b32 v96, v5 offset:384
    ds_read_b32 v100, v5 offset:448
    s_lshr_b32 s60, s26, 1
    s_mul_i32 s61, s60, 2560
    s_lshl_b32 s62, s60, 12
    v_add_u32 v8, 0, v3
    v_mul_u32_u24 v9, 205, v8
    v_lshrrev_b32 v9, 10, v9
    v_mul_u32_u24 v10, 5, v9
    v_sub_u32 v10, v8, v10
    v_lshrrev_b32 v11, 1, v10
    v_lshlrev_b32 v11, 9, v11
    v_cmp_eq_u32 vcc, 4, v10
    v_and_b32 v10, 1, v10
    v_lshl_or_b32 v11, v10, 3, v11
    v_lshl_add_u32 v11, v2, 4, v11
    v_lshlrev_b32 v10, 3, v2
    v_add_u32 v10, 0x400, v10
    v_cndmask_b32 v11, v11, v10, vcc
    v_lshl_add_u32 v11, v9, 13, v11
    v_add_u32 v104, s61, v11
    v_add_u32 v112, 0x100, v104
    v_add_u32 v8, 4, v3
    v_mul_u32_u24 v9, 205, v8
    v_lshrrev_b32 v9, 10, v9
    v_mul_u32_u24 v10, 5, v9
    v_sub_u32 v10, v8, v10
    v_lshrrev_b32 v11, 1, v10
    v_lshlrev_b32 v11, 9, v11
    v_cmp_eq_u32 vcc, 4, v10
    v_and_b32 v10, 1, v10
    v_lshl_or_b32 v11, v10, 3, v11
    v_lshl_add_u32 v11, v2, 4, v11
    v_lshlrev_b32 v10, 3, v2
    v_add_u32 v10, 0x400, v10
    v_cndmask_b32 v11, v11, v10, vcc
    v_lshl_add_u32 v11, v9, 13, v11
    v_add_u32 v105, s61, v11
    v_mov_b32 v10, 0x100
    v_mov_b32 v8, 0x80
    v_cndmask_b32 v10, v10, v8, vcc
    v_add_u32 v113, v10, v105
    v_add_u32 v8, 8, v3
    v_mul_u32_u24 v9, 205, v8
    v_lshrrev_b32 v9, 10, v9
    v_mul_u32_u24 v10, 5, v9
    v_sub_u32 v10, v8, v10
    v_lshrrev_b32 v11, 1, v10
    v_lshlrev_b32 v11, 9, v11
    v_cmp_eq_u32 vcc, 4, v10
    v_and_b32 v10, 1, v10
    v_lshl_or_b32 v11, v10, 3, v11
    v_lshl_add_u32 v11, v2, 4, v11
    v_lshlrev_b32 v10, 3, v2
    v_add_u32 v10, 0x400, v10
    v_cndmask_b32 v11, v11, v10, vcc
    v_lshl_add_u32 v11, v9, 13, v11
    v_add_u32 v106, s61, v11
    v_mov_b32 v10, 0x100
    v_mov_b32 v8, 0x80
    v_cndmask_b32 v10, v10, v8, vcc
    v_add_u32 v114, v10, v106
    v_add_u32 v8, 12, v3
    v_mul_u32_u24 v9, 205, v8
    v_lshrrev_b32 v9, 10, v9
    v_mul_u32_u24 v10, 5, v9
    v_sub_u32 v10, v8, v10
    v_lshrrev_b32 v11, 1, v10
    v_lshlrev_b32 v11, 9, v11
    v_cmp_eq_u32 vcc, 4, v10
    v_and_b32 v10, 1, v10
    v_lshl_or_b32 v11, v10, 3, v11
    v_lshl_add_u32 v11, v2, 4, v11
    v_lshlrev_b32 v10, 3, v2
    v_add_u32 v10, 0x400, v10
    v_cndmask_b32 v11, v11, v10, vcc
    v_lshl_add_u32 v11, v9, 13, v11
    v_add_u32 v107, s61, v11
    v_mov_b32 v10, 0x100
    v_mov_b32 v8, 0x80
    v_cndmask_b32 v10, v10, v8, vcc
    v_add_u32 v115, v10, v107
    v_add_u32 v8, 16, v3
    v_mul_u32_u24 v9, 205, v8
    v_lshrrev_b32 v9, 10, v9
    v_mul_u32_u24 v10, 5, v9
    v_sub_u32 v10, v8, v10
    v_lshrrev_b32 v11, 1, v10
    v_lshlrev_b32 v11, 9, v11
    v_cmp_eq_u32 vcc, 4, v10
    v_and_b32 v10, 1, v10
    v_lshl_or_b32 v11, v10, 3, v11
    v_lshl_add_u32 v11, v2, 4, v11
    v_lshlrev_b32 v10, 3, v2
    v_add_u32 v10, 0x400, v10
    v_cndmask_b32 v11, v11, v10, vcc
    v_lshl_add_u32 v11, v9, 13, v11
    v_add_u32 v108, s61, v11
    v_mov_b32 v10, 0x100
    v_mov_b32 v8, 0x80
    v_cndmask_b32 v10, v10, v8, vcc
    v_add_u32 v116, v10, v108
    v_add_u32 v8, 80, v2
    v_mul_u32_u24 v9, 3277, v8
    v_lshrrev_b32 v9, 16, v9
    v_mul_u32_u24 v10, 20, v9
    v_sub_u32 v10, v8, v10
    v_and_b32 v11, 1, v3
    v_lshl_add_u32 v11, v11, 5, v10
    v_lshlrev_b32 v11, 4, v11
    v_lshrrev_b32 v10, 1, v3
    v_lshl_add_u32 v11, v10, 3, v11
    v_lshl_add_u32 v11, v9, 13, v11
    v_add_u32 v109, s62, v11
    v_add_u32 v8, 96, v2
    v_mul_u32_u24 v9, 3277, v8
    v_lshrrev_b32 v9, 16, v9
    v_mul_u32_u24 v10, 20, v9
    v_sub_u32 v10, v8, v10
    v_and_b32 v11, 1, v3
    v_lshl_add_u32 v11, v11, 5, v10
    v_lshlrev_b32 v11, 4, v11
    v_lshrrev_b32 v10, 1, v3
    v_lshl_add_u32 v11, v10, 3, v11
    v_lshl_add_u32 v11, v9, 13, v11
    v_add_u32 v110, s62, v11
    v_add_u32 v8, 112, v2
    v_mul_u32_u24 v9, 3277, v8
    v_lshrrev_b32 v9, 16, v9
    v_mul_u32_u24 v10, 20, v9
    v_sub_u32 v10, v8, v10
    v_and_b32 v11, 1, v3
    v_lshl_add_u32 v11, v11, 5, v10
    v_lshlrev_b32 v11, 4, v11
    v_lshrrev_b32 v10, 1, v3
    v_lshl_add_u32 v11, v10, 3, v11
    v_lshl_add_u32 v11, v9, 13, v11
    v_add_u32 v111, s62, v11
    s_waitcnt lgkmcnt(0)
    v_mul_f32 v8, v33, v72
    v_mul_f32 v9, v33, v73
    v_mul_f32 v10, v33, v74
    v_mul_f32 v11, v33, v75
    v_fma_f32 v8, v128, v32, v8
    v_fma_f32 v9, v129, v32, v9
    v_fma_f32 v10, v130, v32, v10
    v_fma_f32 v11, v131, v32, v11
    v_cvt_pk_bf16_f32 v12, v8, v9
    v_cvt_pk_bf16_f32 v13, v10, v11
    ds_write_b64 v104, v[12:13] offset:0
    v_mul_f32 v16, v35, v72
    v_mul_f32 v17, v35, v73
    v_mul_f32 v18, v35, v74
    v_mul_f32 v19, v35, v75
    v_fma_f32 v16, v132, v34, v16
    v_fma_f32 v17, v133, v34, v17
    v_fma_f32 v18, v134, v34, v18
    v_fma_f32 v19, v135, v34, v19
    v_cvt_pk_bf16_f32 v20, v16, v17
    v_cvt_pk_bf16_f32 v21, v18, v19
    ds_write_b64 v112, v[20:21] offset:0
    v_mul_f32 v8, v37, v72
    v_mul_f32 v9, v37, v73
    v_mul_f32 v10, v37, v74
    v_mul_f32 v11, v37, v75
    v_fma_f32 v8, v136, v36, v8
    v_fma_f32 v9, v137, v36, v9
    v_fma_f32 v10, v138, v36, v10
    v_fma_f32 v11, v139, v36, v11
    v_cvt_pk_bf16_f32 v12, v8, v9
    v_cvt_pk_bf16_f32 v13, v10, v11
    ds_write_b64 v104, v[12:13] offset:1280
    v_mul_f32 v16, v39, v72
    v_mul_f32 v17, v39, v73
    v_mul_f32 v18, v39, v74
    v_mul_f32 v19, v39, v75
    v_fma_f32 v16, v140, v38, v16
    v_fma_f32 v17, v141, v38, v17
    v_fma_f32 v18, v142, v38, v18
    v_fma_f32 v19, v143, v38, v19
    v_cvt_pk_bf16_f32 v20, v16, v17
    v_cvt_pk_bf16_f32 v21, v18, v19
    ds_write_b64 v112, v[20:21] offset:1280
    v_mul_f32 v8, v33, v76
    v_mul_f32 v9, v33, v77
    v_mul_f32 v10, v33, v78
    v_mul_f32 v11, v33, v79
    v_fma_f32 v8, v144, v32, v8
    v_fma_f32 v9, v145, v32, v9
    v_fma_f32 v10, v146, v32, v10
    v_fma_f32 v11, v147, v32, v11
    v_cvt_pk_bf16_f32 v12, v8, v9
    v_cvt_pk_bf16_f32 v13, v10, v11
    ds_write_b64 v105, v[12:13] offset:0
    v_mul_f32 v16, v35, v76
    v_mul_f32 v17, v35, v77
    v_mul_f32 v18, v35, v78
    v_mul_f32 v19, v35, v79
    v_fma_f32 v16, v148, v34, v16
    v_fma_f32 v17, v149, v34, v17
    v_fma_f32 v18, v150, v34, v18
    v_fma_f32 v19, v151, v34, v19
    v_cvt_pk_bf16_f32 v20, v16, v17
    v_cvt_pk_bf16_f32 v21, v18, v19
    ds_write_b64 v113, v[20:21] offset:0
    v_mul_f32 v8, v37, v76
    v_mul_f32 v9, v37, v77
    v_mul_f32 v10, v37, v78
    v_mul_f32 v11, v37, v79
    v_fma_f32 v8, v152, v36, v8
    v_fma_f32 v9, v153, v36, v9
    v_fma_f32 v10, v154, v36, v10
    v_fma_f32 v11, v155, v36, v11
    v_cvt_pk_bf16_f32 v12, v8, v9
    v_cvt_pk_bf16_f32 v13, v10, v11
    ds_write_b64 v105, v[12:13] offset:1280
    v_mul_f32 v16, v39, v76
    v_mul_f32 v17, v39, v77
    v_mul_f32 v18, v39, v78
    v_mul_f32 v19, v39, v79
    v_fma_f32 v16, v156, v38, v16
    v_fma_f32 v17, v157, v38, v17
    v_fma_f32 v18, v158, v38, v18
    v_fma_f32 v19, v159, v38, v19
    v_cvt_pk_bf16_f32 v20, v16, v17
    v_cvt_pk_bf16_f32 v21, v18, v19
    ds_write_b64 v113, v[20:21] offset:1280
    v_mul_f32 v8, v33, v80
    v_mul_f32 v9, v33, v81
    v_mul_f32 v10, v33, v82
    v_mul_f32 v11, v33, v83
    v_fma_f32 v8, v160, v32, v8
    v_fma_f32 v9, v161, v32, v9
    v_fma_f32 v10, v162, v32, v10
    v_fma_f32 v11, v163, v32, v11
    v_cvt_pk_bf16_f32 v12, v8, v9
    v_cvt_pk_bf16_f32 v13, v10, v11
    ds_write_b64 v106, v[12:13] offset:0
    v_mul_f32 v16, v35, v80
    v_mul_f32 v17, v35, v81
    v_mul_f32 v18, v35, v82
    v_mul_f32 v19, v35, v83
    v_fma_f32 v16, v164, v34, v16
    v_fma_f32 v17, v165, v34, v17
    v_fma_f32 v18, v166, v34, v18
    v_fma_f32 v19, v167, v34, v19
    v_cvt_pk_bf16_f32 v20, v16, v17
    v_cvt_pk_bf16_f32 v21, v18, v19
    ds_write_b64 v114, v[20:21] offset:0
    v_mul_f32 v8, v37, v80
    v_mul_f32 v9, v37, v81
    v_mul_f32 v10, v37, v82
    v_mul_f32 v11, v37, v83
    v_fma_f32 v8, v168, v36, v8
    v_fma_f32 v9, v169, v36, v9
    v_fma_f32 v10, v170, v36, v10
    v_fma_f32 v11, v171, v36, v11
    v_cvt_pk_bf16_f32 v12, v8, v9
    v_cvt_pk_bf16_f32 v13, v10, v11
    ds_write_b64 v106, v[12:13] offset:1280
    v_mul_f32 v16, v39, v80
    v_mul_f32 v17, v39, v81
    v_mul_f32 v18, v39, v82
    v_mul_f32 v19, v39, v83
    v_fma_f32 v16, v172, v38, v16
    v_fma_f32 v17, v173, v38, v17
    v_fma_f32 v18, v174, v38, v18
    v_fma_f32 v19, v175, v38, v19
    v_cvt_pk_bf16_f32 v20, v16, v17
    v_cvt_pk_bf16_f32 v21, v18, v19
    ds_write_b64 v114, v[20:21] offset:1280
    v_mul_f32 v8, v33, v84
    v_mul_f32 v9, v33, v85
    v_mul_f32 v10, v33, v86
    v_mul_f32 v11, v33, v87
    v_fma_f32 v8, v176, v32, v8
    v_fma_f32 v9, v177, v32, v9
    v_fma_f32 v10, v178, v32, v10
    v_fma_f32 v11, v179, v32, v11
    v_cvt_pk_bf16_f32 v12, v8, v9
    v_cvt_pk_bf16_f32 v13, v10, v11
    ds_write_b64 v107, v[12:13] offset:0
    v_mul_f32 v16, v35, v84
    v_mul_f32 v17, v35, v85
    v_mul_f32 v18, v35, v86
    v_mul_f32 v19, v35, v87
    v_fma_f32 v16, v180, v34, v16
    v_fma_f32 v17, v181, v34, v17
    v_fma_f32 v18, v182, v34, v18
    v_fma_f32 v19, v183, v34, v19
    v_cvt_pk_bf16_f32 v20, v16, v17
    v_cvt_pk_bf16_f32 v21, v18, v19
    ds_write_b64 v115, v[20:21] offset:0
    v_mul_f32 v8, v37, v84
    v_mul_f32 v9, v37, v85
    v_mul_f32 v10, v37, v86
    v_mul_f32 v11, v37, v87
    v_fma_f32 v8, v184, v36, v8
    v_fma_f32 v9, v185, v36, v9
    v_fma_f32 v10, v186, v36, v10
    v_fma_f32 v11, v187, v36, v11
    v_cvt_pk_bf16_f32 v12, v8, v9
    v_cvt_pk_bf16_f32 v13, v10, v11
    ds_write_b64 v107, v[12:13] offset:1280
    v_mul_f32 v16, v39, v84
    v_mul_f32 v17, v39, v85
    v_mul_f32 v18, v39, v86
    v_mul_f32 v19, v39, v87
    v_fma_f32 v16, v188, v38, v16
    v_fma_f32 v17, v189, v38, v17
    v_fma_f32 v18, v190, v38, v18
    v_fma_f32 v19, v191, v38, v19
    v_cvt_pk_bf16_f32 v20, v16, v17
    v_cvt_pk_bf16_f32 v21, v18, v19
    ds_write_b64 v115, v[20:21] offset:1280
    v_mul_f32 v8, v33, v88
    v_mul_f32 v9, v33, v89
    v_mul_f32 v10, v33, v90
    v_mul_f32 v11, v33, v91
    v_fma_f32 v8, v192, v32, v8
    v_fma_f32 v9, v193, v32, v9
    v_fma_f32 v10, v194, v32, v10
    v_fma_f32 v11, v195, v32, v11
    v_cvt_pk_bf16_f32 v12, v8, v9
    v_cvt_pk_bf16_f32 v13, v10, v11
    ds_write_b64 v108, v[12:13] offset:0
    v_mul_f32 v16, v35, v88
    v_mul_f32 v17, v35, v89
    v_mul_f32 v18, v35, v90
    v_mul_f32 v19, v35, v91
    v_fma_f32 v16, v196, v34, v16
    v_fma_f32 v17, v197, v34, v17
    v_fma_f32 v18, v198, v34, v18
    v_fma_f32 v19, v199, v34, v19
    v_cvt_pk_bf16_f32 v20, v16, v17
    v_cvt_pk_bf16_f32 v21, v18, v19
    ds_write_b64 v116, v[20:21] offset:0
    v_mul_f32 v8, v37, v88
    v_mul_f32 v9, v37, v89
    v_mul_f32 v10, v37, v90
    v_mul_f32 v11, v37, v91
    v_fma_f32 v8, v200, v36, v8
    v_fma_f32 v9, v201, v36, v9
    v_fma_f32 v10, v202, v36, v10
    v_fma_f32 v11, v203, v36, v11
    v_cvt_pk_bf16_f32 v12, v8, v9
    v_cvt_pk_bf16_f32 v13, v10, v11
    ds_write_b64 v108, v[12:13] offset:1280
    v_mul_f32 v16, v39, v88
    v_mul_f32 v17, v39, v89
    v_mul_f32 v18, v39, v90
    v_mul_f32 v19, v39, v91
    v_fma_f32 v16, v204, v38, v16
    v_fma_f32 v17, v205, v38, v17
    v_fma_f32 v18, v206, v38, v18
    v_fma_f32 v19, v207, v38, v19
    v_cvt_pk_bf16_f32 v20, v16, v17
    v_cvt_pk_bf16_f32 v21, v18, v19
    ds_write_b64 v116, v[20:21] offset:1280
    v_mul_f32 v8, v41, v92
    v_mul_f32 v9, v43, v92
    v_mul_f32 v10, v45, v92
    v_mul_f32 v11, v47, v92
    v_fma_f32 v8, v208, v40, v8
    v_fma_f32 v9, v209, v42, v9
    v_fma_f32 v10, v210, v44, v10
    v_fma_f32 v11, v211, v46, v11
    v_cvt_pk_bf16_f32 v12, v8, v9
    v_cvt_pk_bf16_f32 v13, v10, v11
    ds_write_b64 v109, v[12:13] offset:0
    v_mul_f32 v16, v49, v92
    v_mul_f32 v17, v51, v92
    v_mul_f32 v18, v53, v92
    v_mul_f32 v19, v55, v92
    v_fma_f32 v16, v212, v48, v16
    v_fma_f32 v17, v213, v50, v17
    v_fma_f32 v18, v214, v52, v18
    v_fma_f32 v19, v215, v54, v19
    v_cvt_pk_bf16_f32 v20, v16, v17
    v_cvt_pk_bf16_f32 v21, v18, v19
    ds_write_b64 v109, v[20:21] offset:1024
    v_mul_f32 v8, v57, v92
    v_mul_f32 v9, v59, v92
    v_mul_f32 v10, v61, v92
    v_mul_f32 v11, v63, v92
    v_fma_f32 v8, v216, v56, v8
    v_fma_f32 v9, v217, v58, v9
    v_fma_f32 v10, v218, v60, v10
    v_fma_f32 v11, v219, v62, v11
    v_cvt_pk_bf16_f32 v12, v8, v9
    v_cvt_pk_bf16_f32 v13, v10, v11
    ds_write_b64 v109, v[12:13] offset:2048
    v_mul_f32 v16, v65, v92
    v_mul_f32 v17, v67, v92
    v_mul_f32 v18, v69, v92
    v_mul_f32 v19, v71, v92
    v_fma_f32 v16, v220, v64, v16
    v_fma_f32 v17, v221, v66, v17
    v_fma_f32 v18, v222, v68, v18
    v_fma_f32 v19, v223, v70, v19
    v_cvt_pk_bf16_f32 v20, v16, v17
    v_cvt_pk_bf16_f32 v21, v18, v19
    ds_write_b64 v109, v[20:21] offset:3072
    v_mul_f32 v8, v41, v96
    v_mul_f32 v9, v43, v96
    v_mul_f32 v10, v45, v96
    v_mul_f32 v11, v47, v96
    v_fma_f32 v8, v224, v40, v8
    v_fma_f32 v9, v225, v42, v9
    v_fma_f32 v10, v226, v44, v10
    v_fma_f32 v11, v227, v46, v11
    v_cvt_pk_bf16_f32 v12, v8, v9
    v_cvt_pk_bf16_f32 v13, v10, v11
    ds_write_b64 v110, v[12:13] offset:0
    v_mul_f32 v16, v49, v96
    v_mul_f32 v17, v51, v96
    v_mul_f32 v18, v53, v96
    v_mul_f32 v19, v55, v96
    v_fma_f32 v16, v228, v48, v16
    v_fma_f32 v17, v229, v50, v17
    v_fma_f32 v18, v230, v52, v18
    v_fma_f32 v19, v231, v54, v19
    v_cvt_pk_bf16_f32 v20, v16, v17
    v_cvt_pk_bf16_f32 v21, v18, v19
    ds_write_b64 v110, v[20:21] offset:1024
    v_mul_f32 v8, v57, v96
    v_mul_f32 v9, v59, v96
    v_mul_f32 v10, v61, v96
    v_mul_f32 v11, v63, v96
    v_fma_f32 v8, v232, v56, v8
    v_fma_f32 v9, v233, v58, v9
    v_fma_f32 v10, v234, v60, v10
    v_fma_f32 v11, v235, v62, v11
    v_cvt_pk_bf16_f32 v12, v8, v9
    v_cvt_pk_bf16_f32 v13, v10, v11
    ds_write_b64 v110, v[12:13] offset:2048
    v_mul_f32 v16, v65, v96
    v_mul_f32 v17, v67, v96
    v_mul_f32 v18, v69, v96
    v_mul_f32 v19, v71, v96
    v_fma_f32 v16, v236, v64, v16
    v_fma_f32 v17, v237, v66, v17
    v_fma_f32 v18, v238, v68, v18
    v_fma_f32 v19, v239, v70, v19
    v_cvt_pk_bf16_f32 v20, v16, v17
    v_cvt_pk_bf16_f32 v21, v18, v19
    ds_write_b64 v110, v[20:21] offset:3072
    v_mul_f32 v8, v41, v100
    v_mul_f32 v9, v43, v100
    v_mul_f32 v10, v45, v100
    v_mul_f32 v11, v47, v100
    v_fma_f32 v8, v240, v40, v8
    v_fma_f32 v9, v241, v42, v9
    v_fma_f32 v10, v242, v44, v10
    v_fma_f32 v11, v243, v46, v11
    v_cvt_pk_bf16_f32 v12, v8, v9
    v_cvt_pk_bf16_f32 v13, v10, v11
    ds_write_b64 v111, v[12:13] offset:0
    v_mul_f32 v16, v49, v100
    v_mul_f32 v17, v51, v100
    v_mul_f32 v18, v53, v100
    v_mul_f32 v19, v55, v100
    v_fma_f32 v16, v244, v48, v16
    v_fma_f32 v17, v245, v50, v17
    v_fma_f32 v18, v246, v52, v18
    v_fma_f32 v19, v247, v54, v19
    v_cvt_pk_bf16_f32 v20, v16, v17
    v_cvt_pk_bf16_f32 v21, v18, v19
    ds_write_b64 v111, v[20:21] offset:1024
    v_mul_f32 v8, v57, v100
    v_mul_f32 v9, v59, v100
    v_mul_f32 v10, v61, v100
    v_mul_f32 v11, v63, v100
    v_fma_f32 v8, v248, v56, v8
    v_fma_f32 v9, v249, v58, v9
    v_fma_f32 v10, v250, v60, v10
    v_fma_f32 v11, v251, v62, v11
    v_cvt_pk_bf16_f32 v12, v8, v9
    v_cvt_pk_bf16_f32 v13, v10, v11
    ds_write_b64 v111, v[12:13] offset:2048
    v_mul_f32 v16, v65, v100
    v_mul_f32 v17, v67, v100
    v_mul_f32 v18, v69, v100
    v_mul_f32 v19, v71, v100
    v_fma_f32 v16, v252, v64, v16
    v_fma_f32 v17, v253, v66, v17
    v_fma_f32 v18, v254, v68, v18
    v_fma_f32 v19, v255, v70, v19
    v_cvt_pk_bf16_f32 v20, v16, v17
    v_cvt_pk_bf16_f32 v21, v18, v19
    ds_write_b64 v111, v[20:21] offset:3072
    s_branch K1_FB
K1_EB1:
    v_lshlrev_b32 v7, 5, v3
    v_add_u32 v7, s58, v7
    ds_read_b128 v[40:43], v7 offset:0
    ds_read_b128 v[44:47], v7 offset:16
    ds_read_b128 v[48:51], v7 offset:128
    ds_read_b128 v[52:55], v7 offset:144
    ds_read_b128 v[56:59], v7 offset:256
    ds_read_b128 v[60:63], v7 offset:272
    ds_read_b128 v[64:67], v7 offset:384
    ds_read_b128 v[68:71], v7 offset:400
    v_lshlrev_b32 v4, 4, v3
    v_add_u32 v4, 141312, v4
    v_lshlrev_b32 v5, 2, v2
    v_add_u32 v5, 141312, v5
    ds_read_b32 v72, v5 offset:512
    ds_read_b32 v76, v5 offset:576
    ds_read_b32 v80, v5 offset:640
    ds_read_b32 v84, v5 offset:704
    ds_read_b32 v88, v5 offset:768
    ds_read_b32 v92, v5 offset:832
    ds_read_b32 v96, v5 offset:896
    s_lshr_b32 s60, s26, 1
    s_mul_i32 s61, s60, 2560
    s_lshl_b32 s62, s60, 12
    v_add_u32 v8, 128, v2
    v_mul_u32_u24 v9, 3277, v8
    v_lshrrev_b32 v9, 16, v9
    v_mul_u32_u24 v10, 20, v9
    v_sub_u32 v10, v8, v10
    v_and_b32 v11, 1, v3
    v_lshl_add_u32 v11, v11, 5, v10
    v_lshlrev_b32 v11, 4, v11
    v_lshrrev_b32 v10, 1, v3
    v_lshl_add_u32 v11, v10, 3, v11
    v_lshl_add_u32 v11, v9, 13, v11
    v_add_u32 v104, s62, v11
    v_add_u32 v8, 144, v2
    v_mul_u32_u24 v9, 3277, v8
    v_lshrrev_b32 v9, 16, v9
    v_mul_u32_u24 v10, 20, v9
    v_sub_u32 v10, v8, v10
    v_and_b32 v11, 1, v3
    v_lshl_add_u32 v11, v11, 5, v10
    v_lshlrev_b32 v11, 4, v11
    v_lshrrev_b32 v10, 1, v3
    v_lshl_add_u32 v11, v10, 3, v11
    v_lshl_add_u32 v11, v9, 13, v11
    v_add_u32 v105, s62, v11
    v_add_u32 v8, 160, v2
    v_mul_u32_u24 v9, 3277, v8
    v_lshrrev_b32 v9, 16, v9
    v_mul_u32_u24 v10, 20, v9
    v_sub_u32 v10, v8, v10
    v_and_b32 v11, 1, v3
    v_lshl_add_u32 v11, v11, 5, v10
    v_lshlrev_b32 v11, 4, v11
    v_lshrrev_b32 v10, 1, v3
    v_lshl_add_u32 v11, v10, 3, v11
    v_lshl_add_u32 v11, v9, 13, v11
    v_add_u32 v106, s62, v11
    v_add_u32 v8, 176, v2
    v_mul_u32_u24 v9, 3277, v8
    v_lshrrev_b32 v9, 16, v9
    v_mul_u32_u24 v10, 20, v9
    v_sub_u32 v10, v8, v10
    v_and_b32 v11, 1, v3
    v_lshl_add_u32 v11, v11, 5, v10
    v_lshlrev_b32 v11, 4, v11
    v_lshrrev_b32 v10, 1, v3
    v_lshl_add_u32 v11, v10, 3, v11
    v_lshl_add_u32 v11, v9, 13, v11
    v_add_u32 v107, s62, v11
    v_add_u32 v8, 192, v2
    v_mul_u32_u24 v9, 3277, v8
    v_lshrrev_b32 v9, 16, v9
    v_mul_u32_u24 v10, 20, v9
    v_sub_u32 v10, v8, v10
    v_and_b32 v11, 1, v3
    v_lshl_add_u32 v11, v11, 5, v10
    v_lshlrev_b32 v11, 4, v11
    v_lshrrev_b32 v10, 1, v3
    v_lshl_add_u32 v11, v10, 3, v11
    v_lshl_add_u32 v11, v9, 13, v11
    v_add_u32 v108, s62, v11
    v_add_u32 v8, 208, v2
    v_mul_u32_u24 v9, 3277, v8
    v_lshrrev_b32 v9, 16, v9
    v_mul_u32_u24 v10, 20, v9
    v_sub_u32 v10, v8, v10
    v_and_b32 v11, 1, v3
    v_lshl_add_u32 v11, v11, 5, v10
    v_lshlrev_b32 v11, 4, v11
    v_lshrrev_b32 v10, 1, v3
    v_lshl_add_u32 v11, v10, 3, v11
    v_lshl_add_u32 v11, v9, 13, v11
    v_add_u32 v109, s62, v11
    v_add_u32 v8, 224, v2
    v_mul_u32_u24 v9, 3277, v8
    v_lshrrev_b32 v9, 16, v9
    v_mul_u32_u24 v10, 20, v9
    v_sub_u32 v10, v8, v10
    v_and_b32 v11, 1, v3
    v_lshl_add_u32 v11, v11, 5, v10
    v_lshlrev_b32 v11, 4, v11
    v_lshrrev_b32 v10, 1, v3
    v_lshl_add_u32 v11, v10, 3, v11
    v_lshl_add_u32 v11, v9, 13, v11
    v_add_u32 v110, s62, v11
    s_waitcnt lgkmcnt(0)
    v_mul_f32 v8, v41, v72
    v_mul_f32 v9, v43, v72
    v_mul_f32 v10, v45, v72
    v_mul_f32 v11, v47, v72
    v_fma_f32 v8, v128, v40, v8
    v_fma_f32 v9, v129, v42, v9
    v_fma_f32 v10, v130, v44, v10
    v_fma_f32 v11, v131, v46, v11
    v_cvt_pk_bf16_f32 v12, v8, v9
    v_cvt_pk_bf16_f32 v13, v10, v11
    ds_write_b64 v104, v[12:13] offset:0
    v_mul_f32 v16, v49, v72
    v_mul_f32 v17, v51, v72
    v_mul_f32 v18, v53, v72
    v_mul_f32 v19, v55, v72
    v_fma_f32 v16, v132, v48, v16
    v_fma_f32 v17, v133, v50, v17
    v_fma_f32 v18, v134, v52, v18
    v_fma_f32 v19, v135, v54, v19
    v_cvt_pk_bf16_f32 v20, v16, v17
    v_cvt_pk_bf16_f32 v21, v18, v19
    ds_write_b64 v104, v[20:21] offset:1024
    v_mul_f32 v8, v57, v72
    v_mul_f32 v9, v59, v72
    v_mul_f32 v10, v61, v72
    v_mul_f32 v11, v63, v72
    v_fma_f32 v8, v136, v56, v8
    v_fma_f32 v9, v137, v58, v9
    v_fma_f32 v10, v138, v60, v10
    v_fma_f32 v11, v139, v62, v11
    v_cvt_pk_bf16_f32 v12, v8, v9
    v_cvt_pk_bf16_f32 v13, v10, v11
    ds_write_b64 v104, v[12:13] offset:2048
    v_mul_f32 v16, v65, v72
    v_mul_f32 v17, v67, v72
    v_mul_f32 v18, v69, v72
    v_mul_f32 v19, v71, v72
    v_fma_f32 v16, v140, v64, v16
    v_fma_f32 v17, v141, v66, v17
    v_fma_f32 v18, v142, v68, v18
    v_fma_f32 v19, v143, v70, v19
    v_cvt_pk_bf16_f32 v20, v16, v17
    v_cvt_pk_bf16_f32 v21, v18, v19
    ds_write_b64 v104, v[20:21] offset:3072
    v_mul_f32 v8, v41, v76
    v_mul_f32 v9, v43, v76
    v_mul_f32 v10, v45, v76
    v_mul_f32 v11, v47, v76
    v_fma_f32 v8, v144, v40, v8
    v_fma_f32 v9, v145, v42, v9
    v_fma_f32 v10, v146, v44, v10
    v_fma_f32 v11, v147, v46, v11
    v_cvt_pk_bf16_f32 v12, v8, v9
    v_cvt_pk_bf16_f32 v13, v10, v11
    ds_write_b64 v105, v[12:13] offset:0
    v_mul_f32 v16, v49, v76
    v_mul_f32 v17, v51, v76
    v_mul_f32 v18, v53, v76
    v_mul_f32 v19, v55, v76
    v_fma_f32 v16, v148, v48, v16
    v_fma_f32 v17, v149, v50, v17
    v_fma_f32 v18, v150, v52, v18
    v_fma_f32 v19, v151, v54, v19
    v_cvt_pk_bf16_f32 v20, v16, v17
    v_cvt_pk_bf16_f32 v21, v18, v19
    ds_write_b64 v105, v[20:21] offset:1024
    v_mul_f32 v8, v57, v76
    v_mul_f32 v9, v59, v76
    v_mul_f32 v10, v61, v76
    v_mul_f32 v11, v63, v76
    v_fma_f32 v8, v152, v56, v8
    v_fma_f32 v9, v153, v58, v9
    v_fma_f32 v10, v154, v60, v10
    v_fma_f32 v11, v155, v62, v11
    v_cvt_pk_bf16_f32 v12, v8, v9
    v_cvt_pk_bf16_f32 v13, v10, v11
    ds_write_b64 v105, v[12:13] offset:2048
    v_mul_f32 v16, v65, v76
    v_mul_f32 v17, v67, v76
    v_mul_f32 v18, v69, v76
    v_mul_f32 v19, v71, v76
    v_fma_f32 v16, v156, v64, v16
    v_fma_f32 v17, v157, v66, v17
    v_fma_f32 v18, v158, v68, v18
    v_fma_f32 v19, v159, v70, v19
    v_cvt_pk_bf16_f32 v20, v16, v17
    v_cvt_pk_bf16_f32 v21, v18, v19
    ds_write_b64 v105, v[20:21] offset:3072
    v_mul_f32 v8, v41, v80
    v_mul_f32 v9, v43, v80
    v_mul_f32 v10, v45, v80
    v_mul_f32 v11, v47, v80
    v_fma_f32 v8, v160, v40, v8
    v_fma_f32 v9, v161, v42, v9
    v_fma_f32 v10, v162, v44, v10
    v_fma_f32 v11, v163, v46, v11
    v_cvt_pk_bf16_f32 v12, v8, v9
    v_cvt_pk_bf16_f32 v13, v10, v11
    ds_write_b64 v106, v[12:13] offset:0
    v_mul_f32 v16, v49, v80
    v_mul_f32 v17, v51, v80
    v_mul_f32 v18, v53, v80
    v_mul_f32 v19, v55, v80
    v_fma_f32 v16, v164, v48, v16
    v_fma_f32 v17, v165, v50, v17
    v_fma_f32 v18, v166, v52, v18
    v_fma_f32 v19, v167, v54, v19
    v_cvt_pk_bf16_f32 v20, v16, v17
    v_cvt_pk_bf16_f32 v21, v18, v19
    ds_write_b64 v106, v[20:21] offset:1024
    v_mul_f32 v8, v57, v80
    v_mul_f32 v9, v59, v80
    v_mul_f32 v10, v61, v80
    v_mul_f32 v11, v63, v80
    v_fma_f32 v8, v168, v56, v8
    v_fma_f32 v9, v169, v58, v9
    v_fma_f32 v10, v170, v60, v10
    v_fma_f32 v11, v171, v62, v11
    v_cvt_pk_bf16_f32 v12, v8, v9
    v_cvt_pk_bf16_f32 v13, v10, v11
    ds_write_b64 v106, v[12:13] offset:2048
    v_mul_f32 v16, v65, v80
    v_mul_f32 v17, v67, v80
    v_mul_f32 v18, v69, v80
    v_mul_f32 v19, v71, v80
    v_fma_f32 v16, v172, v64, v16
    v_fma_f32 v17, v173, v66, v17
    v_fma_f32 v18, v174, v68, v18
    v_fma_f32 v19, v175, v70, v19
    v_cvt_pk_bf16_f32 v20, v16, v17
    v_cvt_pk_bf16_f32 v21, v18, v19
    ds_write_b64 v106, v[20:21] offset:3072
    v_mul_f32 v8, v41, v84
    v_mul_f32 v9, v43, v84
    v_mul_f32 v10, v45, v84
    v_mul_f32 v11, v47, v84
    v_fma_f32 v8, v176, v40, v8
    v_fma_f32 v9, v177, v42, v9
    v_fma_f32 v10, v178, v44, v10
    v_fma_f32 v11, v179, v46, v11
    v_cvt_pk_bf16_f32 v12, v8, v9
    v_cvt_pk_bf16_f32 v13, v10, v11
    ds_write_b64 v107, v[12:13] offset:0
    v_mul_f32 v16, v49, v84
    v_mul_f32 v17, v51, v84
    v_mul_f32 v18, v53, v84
    v_mul_f32 v19, v55, v84
    v_fma_f32 v16, v180, v48, v16
    v_fma_f32 v17, v181, v50, v17
    v_fma_f32 v18, v182, v52, v18
    v_fma_f32 v19, v183, v54, v19
    v_cvt_pk_bf16_f32 v20, v16, v17
    v_cvt_pk_bf16_f32 v21, v18, v19
    ds_write_b64 v107, v[20:21] offset:1024
    v_mul_f32 v8, v57, v84
    v_mul_f32 v9, v59, v84
    v_mul_f32 v10, v61, v84
    v_mul_f32 v11, v63, v84
    v_fma_f32 v8, v184, v56, v8
    v_fma_f32 v9, v185, v58, v9
    v_fma_f32 v10, v186, v60, v10
    v_fma_f32 v11, v187, v62, v11
    v_cvt_pk_bf16_f32 v12, v8, v9
    v_cvt_pk_bf16_f32 v13, v10, v11
    ds_write_b64 v107, v[12:13] offset:2048
    v_mul_f32 v16, v65, v84
    v_mul_f32 v17, v67, v84
    v_mul_f32 v18, v69, v84
    v_mul_f32 v19, v71, v84
    v_fma_f32 v16, v188, v64, v16
    v_fma_f32 v17, v189, v66, v17
    v_fma_f32 v18, v190, v68, v18
    v_fma_f32 v19, v191, v70, v19
    v_cvt_pk_bf16_f32 v20, v16, v17
    v_cvt_pk_bf16_f32 v21, v18, v19
    ds_write_b64 v107, v[20:21] offset:3072
    v_mul_f32 v8, v41, v88
    v_mul_f32 v9, v43, v88
    v_mul_f32 v10, v45, v88
    v_mul_f32 v11, v47, v88
    v_fma_f32 v8, v192, v40, v8
    v_fma_f32 v9, v193, v42, v9
    v_fma_f32 v10, v194, v44, v10
    v_fma_f32 v11, v195, v46, v11
    v_cvt_pk_bf16_f32 v12, v8, v9
    v_cvt_pk_bf16_f32 v13, v10, v11
    ds_write_b64 v108, v[12:13] offset:0
    v_mul_f32 v16, v49, v88
    v_mul_f32 v17, v51, v88
    v_mul_f32 v18, v53, v88
    v_mul_f32 v19, v55, v88
    v_fma_f32 v16, v196, v48, v16
    v_fma_f32 v17, v197, v50, v17
    v_fma_f32 v18, v198, v52, v18
    v_fma_f32 v19, v199, v54, v19
    v_cvt_pk_bf16_f32 v20, v16, v17
    v_cvt_pk_bf16_f32 v21, v18, v19
    ds_write_b64 v108, v[20:21] offset:1024
    v_mul_f32 v8, v57, v88
    v_mul_f32 v9, v59, v88
    v_mul_f32 v10, v61, v88
    v_mul_f32 v11, v63, v88
    v_fma_f32 v8, v200, v56, v8
    v_fma_f32 v9, v201, v58, v9
    v_fma_f32 v10, v202, v60, v10
    v_fma_f32 v11, v203, v62, v11
    v_cvt_pk_bf16_f32 v12, v8, v9
    v_cvt_pk_bf16_f32 v13, v10, v11
    ds_write_b64 v108, v[12:13] offset:2048
    v_mul_f32 v16, v65, v88
    v_mul_f32 v17, v67, v88
    v_mul_f32 v18, v69, v88
    v_mul_f32 v19, v71, v88
    v_fma_f32 v16, v204, v64, v16
    v_fma_f32 v17, v205, v66, v17
    v_fma_f32 v18, v206, v68, v18
    v_fma_f32 v19, v207, v70, v19
    v_cvt_pk_bf16_f32 v20, v16, v17
    v_cvt_pk_bf16_f32 v21, v18, v19
    ds_write_b64 v108, v[20:21] offset:3072
    v_mul_f32 v8, v41, v92
    v_mul_f32 v9, v43, v92
    v_mul_f32 v10, v45, v92
    v_mul_f32 v11, v47, v92
    v_fma_f32 v8, v208, v40, v8
    v_fma_f32 v9, v209, v42, v9
    v_fma_f32 v10, v210, v44, v10
    v_fma_f32 v11, v211, v46, v11
    v_cvt_pk_bf16_f32 v12, v8, v9
    v_cvt_pk_bf16_f32 v13, v10, v11
    ds_write_b64 v109, v[12:13] offset:0
    v_mul_f32 v16, v49, v92
    v_mul_f32 v17, v51, v92
    v_mul_f32 v18, v53, v92
    v_mul_f32 v19, v55, v92
    v_fma_f32 v16, v212, v48, v16
    v_fma_f32 v17, v213, v50, v17
    v_fma_f32 v18, v214, v52, v18
    v_fma_f32 v19, v215, v54, v19
    v_cvt_pk_bf16_f32 v20, v16, v17
    v_cvt_pk_bf16_f32 v21, v18, v19
    ds_write_b64 v109, v[20:21] offset:1024
    v_mul_f32 v8, v57, v92
    v_mul_f32 v9, v59, v92
    v_mul_f32 v10, v61, v92
    v_mul_f32 v11, v63, v92
    v_fma_f32 v8, v216, v56, v8
    v_fma_f32 v9, v217, v58, v9
    v_fma_f32 v10, v218, v60, v10
    v_fma_f32 v11, v219, v62, v11
    v_cvt_pk_bf16_f32 v12, v8, v9
    v_cvt_pk_bf16_f32 v13, v10, v11
    ds_write_b64 v109, v[12:13] offset:2048
    v_mul_f32 v16, v65, v92
    v_mul_f32 v17, v67, v92
    v_mul_f32 v18, v69, v92
    v_mul_f32 v19, v71, v92
    v_fma_f32 v16, v220, v64, v16
    v_fma_f32 v17, v221, v66, v17
    v_fma_f32 v18, v222, v68, v18
    v_fma_f32 v19, v223, v70, v19
    v_cvt_pk_bf16_f32 v20, v16, v17
    v_cvt_pk_bf16_f32 v21, v18, v19
    ds_write_b64 v109, v[20:21] offset:3072
    v_mul_f32 v8, v41, v96
    v_mul_f32 v9, v43, v96
    v_mul_f32 v10, v45, v96
    v_mul_f32 v11, v47, v96
    v_fma_f32 v8, v224, v40, v8
    v_fma_f32 v9, v225, v42, v9
    v_fma_f32 v10, v226, v44, v10
    v_fma_f32 v11, v227, v46, v11
    v_cvt_pk_bf16_f32 v12, v8, v9
    v_cvt_pk_bf16_f32 v13, v10, v11
    ds_write_b64 v110, v[12:13] offset:0
    v_mul_f32 v16, v49, v96
    v_mul_f32 v17, v51, v96
    v_mul_f32 v18, v53, v96
    v_mul_f32 v19, v55, v96
    v_fma_f32 v16, v228, v48, v16
    v_fma_f32 v17, v229, v50, v17
    v_fma_f32 v18, v230, v52, v18
    v_fma_f32 v19, v231, v54, v19
    v_cvt_pk_bf16_f32 v20, v16, v17
    v_cvt_pk_bf16_f32 v21, v18, v19
    ds_write_b64 v110, v[20:21] offset:1024
    v_mul_f32 v8, v57, v96
    v_mul_f32 v9, v59, v96
    v_mul_f32 v10, v61, v96
    v_mul_f32 v11, v63, v96
    v_fma_f32 v8, v232, v56, v8
    v_fma_f32 v9, v233, v58, v9
    v_fma_f32 v10, v234, v60, v10
    v_fma_f32 v11, v235, v62, v11
    v_cvt_pk_bf16_f32 v12, v8, v9
    v_cvt_pk_bf16_f32 v13, v10, v11
    ds_write_b64 v110, v[12:13] offset:2048
    v_mul_f32 v16, v65, v96
    v_mul_f32 v17, v67, v96
    v_mul_f32 v18, v69, v96
    v_mul_f32 v19, v71, v96
    v_fma_f32 v16, v236, v64, v16
    v_fma_f32 v17, v237, v66, v17
    v_fma_f32 v18, v238, v68, v18
    v_fma_f32 v19, v239, v70, v19
    v_cvt_pk_bf16_f32 v20, v16, v17
    v_cvt_pk_bf16_f32 v21, v18, v19
    ds_write_b64 v110, v[20:21] offset:3072
K1_FB:
    v_lshrrev_b32 v6, 1, v1
    v_lshlrev_b32 v6, 10, v6
    v_and_b32 v7, 1, v1
    v_lshl_add_u32 v6, v7, 9, v6
    s_lshl_b32 s3, s26, 13
    s_add_u32 s3, s3, 320
    v_add_u32 v6, s3, v6
    v_add_u32 v7, 0x10000, v6
    v_mov_b32 v8, 0x3f803f80
    v_mov_b32 v9, 0x3f803f80
    v_mov_b32 v10, 0x3f803f80
    v_mov_b32 v11, 0x3f803f80
    v_cmp_gt_u32 vcc, 16, v1
    s_and_saveexec_b64 s[56:57], vcc
    ds_write_b128 v6, v[8:11] offset:32768
    ds_write_b128 v7, v[8:11] offset:0
    s_mov_b64 exec, s[56:57]
    s_waitcnt lgkmcnt(0)
    s_barrier
    v_lshlrev_b32 v6, 4, v1
    s_lshl_b32 s3, s26, 13
    v_add_u32 v7, s3, v6
    v_add_u32 v5, 0x1000, v6
    v_add_u32 v4, 0x10000, v7
    s_mul_i32 s60, s37, 12
    s_add_u32 s60, s60, s26
    s_add_u32 s61, s60, 0
    s_cmp_ge_u32 s61, 32
    s_cselect_b32 s62, 0x180000, 0
    s_mul_i32 s61, s61, 81920
    s_add_u32 s61, s61, s62
    s_mul_i32 s62, s36, 5120
    s_add_u32 s61, s61, s62
    ds_read_b128 v[32:35], v7 offset:0
    ds_read_b128 v[36:39], v7 offset:1024
    ds_read_b128 v[40:43], v7 offset:2048
    ds_read_b128 v[44:47], v7 offset:3072
    ds_read_b128 v[48:51], v7 offset:4096
    s_waitcnt lgkmcnt(4)
    buffer_store_dwordx4 v[32:35], v6, s[48:51], s61 offen offset:0 sc1
    s_waitcnt lgkmcnt(3)
    buffer_store_dwordx4 v[36:39], v6, s[48:51], s61 offen offset:1024 sc1
    s_waitcnt lgkmcnt(2)
    buffer_store_dwordx4 v[40:43], v6, s[48:51], s61 offen offset:2048 sc1
    s_waitcnt lgkmcnt(1)
    buffer_store_dwordx4 v[44:47], v6, s[48:51], s61 offen offset:3072 sc1
    s_waitcnt lgkmcnt(0)
    buffer_store_dwordx4 v[48:51], v5, s[48:51], s61 offen offset:0 sc1
    s_add_u32 s61, s60, 4
    s_sub_u32 s61, s61, 64
    s_lshl_b32 s61, s61, 17
    s_lshl_b32 s62, s36, 13
    s_add_u32 s61, s61, s62
    s_add_u32 s61, s61, 0x800000
    v_and_b32 v8, 31, v1
    v_cmp_gt_u32 vcc, 21, v8
    s_mov_b64 exec, vcc
    ds_read_b128 v[64:67], v7 offset:32768
    ds_read_b128 v[68:71], v7 offset:33792
    ds_read_b128 v[72:75], v7 offset:34816
    ds_read_b128 v[76:79], v7 offset:35840
    ds_read_b128 v[80:83], v7 offset:36864
    ds_read_b128 v[84:87], v7 offset:37888
    ds_read_b128 v[88:91], v7 offset:38912
    ds_read_b128 v[92:95], v7 offset:39936
    s_waitcnt lgkmcnt(7)
    buffer_store_dwordx4 v[64:67], v6, s[48:51], s61 offen offset:0 sc1
    s_waitcnt lgkmcnt(6)
    buffer_store_dwordx4 v[68:71], v6, s[48:51], s61 offen offset:1024 sc1
    s_waitcnt lgkmcnt(5)
    buffer_store_dwordx4 v[72:75], v6, s[48:51], s61 offen offset:2048 sc1
    s_waitcnt lgkmcnt(4)
    buffer_store_dwordx4 v[76:79], v6, s[48:51], s61 offen offset:3072 sc1
    s_waitcnt lgkmcnt(3)
    buffer_store_dwordx4 v[80:83], v5, s[48:51], s61 offen offset:0 sc1
    s_waitcnt lgkmcnt(2)
    buffer_store_dwordx4 v[84:87], v5, s[48:51], s61 offen offset:1024 sc1
    s_waitcnt lgkmcnt(1)
    buffer_store_dwordx4 v[88:91], v5, s[48:51], s61 offen offset:2048 sc1
    s_waitcnt lgkmcnt(0)
    buffer_store_dwordx4 v[92:95], v5, s[48:51], s61 offen offset:3072 sc1
    s_add_u32 s61, s60, 8
    s_sub_u32 s61, s61, 64
    s_lshl_b32 s61, s61, 17
    s_lshl_b32 s62, s36, 13
    s_add_u32 s61, s61, s62
    s_add_u32 s61, s61, 0x800000
    ds_read_b128 v[32:35], v4 offset:0
    ds_read_b128 v[36:39], v4 offset:1024
    ds_read_b128 v[40:43], v4 offset:2048
    ds_read_b128 v[44:47], v4 offset:3072
    ds_read_b128 v[48:51], v4 offset:4096
    ds_read_b128 v[52:55], v4 offset:5120
    ds_read_b128 v[56:59], v4 offset:6144
    ds_read_b128 v[60:63], v4 offset:7168
    s_waitcnt lgkmcnt(7)
    buffer_store_dwordx4 v[32:35], v6, s[48:51], s61 offen offset:0 sc1
    s_waitcnt lgkmcnt(6)
    buffer_store_dwordx4 v[36:39], v6, s[48:51], s61 offen offset:1024 sc1
    s_waitcnt lgkmcnt(5)
    buffer_store_dwordx4 v[40:43], v6, s[48:51], s61 offen offset:2048 sc1
    s_waitcnt lgkmcnt(4)
    buffer_store_dwordx4 v[44:47], v6, s[48:51], s61 offen offset:3072 sc1
    s_waitcnt lgkmcnt(3)
    buffer_store_dwordx4 v[48:51], v5, s[48:51], s61 offen offset:0 sc1
    s_waitcnt lgkmcnt(2)
    buffer_store_dwordx4 v[52:55], v5, s[48:51], s61 offen offset:1024 sc1
    s_waitcnt lgkmcnt(1)
    buffer_store_dwordx4 v[56:59], v5, s[48:51], s61 offen offset:2048 sc1
    s_waitcnt lgkmcnt(0)
    buffer_store_dwordx4 v[60:63], v5, s[48:51], s61 offen offset:3072 sc1
    s_mov_b64 exec, -1
    s_waitcnt vmcnt(0)
    s_endpgm
K1_VC:
    s_cmp_eq_u32 s26, 1
    s_cbranch_scc1 K1_VC_W1
    s_cmp_eq_u32 s26, 2
    s_cbranch_scc1 K1_VC_W2
    s_cmp_eq_u32 s26, 3
    s_cbranch_scc1 K1_VC_W3
K1_VC_W0:
    s_mov_b32 s70, 0
    s_mov_b32 s71, 47104
    s_mov_b32 s72, 94208
    v_add_u32 v27, s70, v26
    v_add_u32 v12, s71, v26
    v_add_u32 v13, s70, v24
    v_add_u32 v14, s70, v25
    v_add_u32 v15, s71, v24
    s_waitcnt vmcnt(14)
    s_barrier
    ds_read_b128 v[32:35], v13 offset:0
    ds_read_b128 v[36:39], v13 offset:2048
    ds_read_b128 v[40:43], v13 offset:4096
    ds_read_b128 v[44:47], v13 offset:6144
    ds_read_b64_tr_b16 v[64:65], v27 offset:0
    ds_read_b64_tr_b16 v[66:67], v27 offset:7680
    ds_read_b64_tr_b16 v[68:69], v27 offset:32
    ds_read_b64_tr_b16 v[70:71], v27 offset:7712
    ds_read_b64_tr_b16 v[72:73], v27 offset:64
    ds_read_b64_tr_b16 v[74:75], v27 offset:7744
    s_mov_b32 s45, 0
K1_LC0:
    s_add_u32 s42, s72, s41
    s_add_u32 s73, s72, s74
    s_waitcnt lgkmcnt(4)
    v_mfma_f32_16x16x32_bf16 v[128:131], v[32:35], v[64:67], v[128:131]
    ds_read_b64_tr_b16 v[76:77], v27 offset:96
    v_mfma_f32_16x16x32_bf16 v[132:135], v[36:39], v[64:67], v[132:135]
    ds_read_b64_tr_b16 v[78:79], v27 offset:7776
    s_add_u32 m0, s42, 0
    v_mfma_f32_16x16x32_bf16 v[136:139], v[40:43], v[64:67], v[136:139]
    buffer_load_dwordx4 v16, s[32:35], s43 offen lds
    v_mfma_f32_16x16x32_bf16 v[140:143], v[44:47], v[64:67], v[140:143]
    v_mfma_f32_16x16x32_bf16 v[108:111], v[64:67], v[28:31], v[108:111]
    v_mfma_f32_16x16x32_bf16 v[92:95], v[28:31], v[32:35], v[92:95]
    ds_read_b128 v[48:51], v14 offset:0
    ds_read_b128 v[52:55], v14 offset:2048
    ds_read_b128 v[56:59], v14 offset:4096
    ds_read_b128 v[60:63], v14 offset:6144
    s_waitcnt lgkmcnt(8)
    v_mfma_f32_16x16x32_bf16 v[144:147], v[32:35], v[68:71], v[144:147]
    ds_read_b64_tr_b16 v[64:65], v27 offset:128
    v_mfma_f32_16x16x32_bf16 v[148:151], v[36:39], v[68:71], v[148:151]
    ds_read_b64_tr_b16 v[66:67], v27 offset:7808
    s_add_u32 m0, s42, 4096
    v_mfma_f32_16x16x32_bf16 v[152:155], v[40:43], v[68:71], v[152:155]
    buffer_load_dwordx4 v17, s[32:35], s43 offen lds
    v_mfma_f32_16x16x32_bf16 v[156:159], v[44:47], v[68:71], v[156:159]
    v_mfma_f32_16x16x32_bf16 v[96:99], v[28:31], v[36:39], v[96:99]
    s_waitcnt lgkmcnt(8)
    v_mfma_f32_16x16x32_bf16 v[160:163], v[32:35], v[72:75], v[160:163]
    ds_read_b64_tr_b16 v[68:69], v27 offset:160
    v_mfma_f32_16x16x32_bf16 v[164:167], v[36:39], v[72:75], v[164:167]
    ds_read_b64_tr_b16 v[70:71], v27 offset:7840
    s_add_u32 m0, s42, 8192
    v_mfma_f32_16x16x32_bf16 v[168:171], v[40:43], v[72:75], v[168:171]
    buffer_load_dwordx4 v18, s[32:35], s43 offen lds
    v_mfma_f32_16x16x32_bf16 v[172:175], v[44:47], v[72:75], v[172:175]
    v_mfma_f32_16x16x32_bf16 v[112:115], v[72:75], v[28:31], v[112:115]
    s_waitcnt lgkmcnt(8)
    v_mfma_f32_16x16x32_bf16 v[176:179], v[32:35], v[76:79], v[176:179]
    ds_read_b64_tr_b16 v[72:73], v27 offset:192
    v_mfma_f32_16x16x32_bf16 v[180:183], v[36:39], v[76:79], v[180:183]
    ds_read_b64_tr_b16 v[74:75], v27 offset:7872
    s_add_u32 m0, s42, 12288
    v_mfma_f32_16x16x32_bf16 v[184:187], v[40:43], v[76:79], v[184:187]
    buffer_load_dwordx4 v19, s[32:35], s43 offen lds
    v_mfma_f32_16x16x32_bf16 v[188:191], v[44:47], v[76:79], v[188:191]
    s_waitcnt lgkmcnt(4)
    v_mfma_f32_16x16x32_bf16 v[192:195], v[32:35], v[64:67], v[192:195]
    ds_read_b64_tr_b16 v[76:77], v27 offset:224
    v_mfma_f32_16x16x32_bf16 v[196:199], v[36:39], v[64:67], v[196:199]
    ds_read_b64_tr_b16 v[78:79], v27 offset:7904
    s_add_u32 m0, s42, 16384
    v_mfma_f32_16x16x32_bf16 v[200:203], v[40:43], v[64:67], v[200:203]
    buffer_load_dwordx4 v20, s[32:35], s43 offen lds
    v_mfma_f32_16x16x32_bf16 v[204:207], v[44:47], v[64:67], v[204:207]
    v_mfma_f32_16x16x32_bf16 v[116:119], v[64:67], v[28:31], v[116:119]
    s_waitcnt lgkmcnt(4)
    v_mfma_f32_16x16x32_bf16 v[208:211], v[32:35], v[68:71], v[208:211]
    ds_read_b64_tr_b16 v[64:65], v27 offset:15360
    v_mfma_f32_16x16x32_bf16 v[212:215], v[36:39], v[68:71], v[212:215]
    ds_read_b64_tr_b16 v[66:67], v27 offset:23040
    s_add_u32 m0, s42, 20480
    v_mfma_f32_16x16x32_bf16 v[216:219], v[40:43], v[68:71], v[216:219]
    buffer_load_dwordx4 v21, s[32:35], s43 offen lds
    v_mfma_f32_16x16x32_bf16 v[220:223], v[44:47], v[68:71], v[220:223]
    s_waitcnt lgkmcnt(4)
    v_mfma_f32_16x16x32_bf16 v[224:227], v[32:35], v[72:75], v[224:227]
    ds_read_b64_tr_b16 v[68:69], v27 offset:15392
    v_mfma_f32_16x16x32_bf16 v[228:231], v[36:39], v[72:75], v[228:231]
    ds_read_b64_tr_b16 v[70:71], v27 offset:23072
    s_add_u32 m0, s42, 24576
    v_mfma_f32_16x16x32_bf16 v[232:235], v[40:43], v[72:75], v[232:235]
    buffer_load_dwordx4 v22, s[32:35], s43 offen lds
    v_mfma_f32_16x16x32_bf16 v[236:239], v[44:47], v[72:75], v[236:239]
    v_mfma_f32_16x16x32_bf16 v[120:123], v[72:75], v[28:31], v[120:123]
    s_waitcnt lgkmcnt(4)
    v_mfma_f32_16x16x32_bf16 v[240:243], v[32:35], v[76:79], v[240:243]
    ds_read_b64_tr_b16 v[72:73], v27 offset:15424
    v_mfma_f32_16x16x32_bf16 v[244:247], v[36:39], v[76:79], v[244:247]
    ds_read_b64_tr_b16 v[74:75], v27 offset:23104
    s_add_u32 m0, s42, 28672
    v_mfma_f32_16x16x32_bf16 v[248:251], v[40:43], v[76:79], v[248:251]
    buffer_load_dwordx4 v23, s[32:35], s43 offen lds
    v_mfma_f32_16x16x32_bf16 v[252:255], v[44:47], v[76:79], v[252:255]
    s_waitcnt lgkmcnt(4)
    v_mfma_f32_16x16x32_bf16 v[128:131], v[48:51], v[64:67], v[128:131]
    ds_read_b64_tr_b16 v[76:77], v27 offset:15456
    v_mfma_f32_16x16x32_bf16 v[132:135], v[52:55], v[64:67], v[132:135]
    ds_read_b64_tr_b16 v[78:79], v27 offset:23136
    s_add_u32 m0, s73, 0
    v_mfma_f32_16x16x32_bf16 v[136:139], v[56:59], v[64:67], v[136:139]
    buffer_load_dwordx4 v8, s[28:31], s44 offen lds
    v_mfma_f32_16x16x32_bf16 v[140:143], v[60:63], v[64:67], v[140:143]
    v_mfma_f32_16x16x32_bf16 v[108:111], v[64:67], v[28:31], v[108:111]
    v_mfma_f32_16x16x32_bf16 v[92:95], v[28:31], v[48:51], v[92:95]
    s_waitcnt lgkmcnt(4)
    v_mfma_f32_16x16x32_bf16 v[144:147], v[48:51], v[68:71], v[144:147]
    ds_read_b64_tr_b16 v[64:65], v27 offset:15488
    v_mfma_f32_16x16x32_bf16 v[148:151], v[52:55], v[68:71], v[148:151]
    ds_read_b64_tr_b16 v[66:67], v27 offset:23168
    s_add_u32 m0, s73, 1024
    v_mfma_f32_16x16x32_bf16 v[152:155], v[56:59], v[68:71], v[152:155]
    buffer_load_dwordx4 v9, s[28:31], s44 offen lds
    v_mfma_f32_16x16x32_bf16 v[156:159], v[60:63], v[68:71], v[156:159]
    v_mfma_f32_16x16x32_bf16 v[96:99], v[28:31], v[52:55], v[96:99]
    s_waitcnt lgkmcnt(4)
    v_mfma_f32_16x16x32_bf16 v[160:163], v[48:51], v[72:75], v[160:163]
    ds_read_b64_tr_b16 v[68:69], v27 offset:15520
    v_mfma_f32_16x16x32_bf16 v[164:167], v[52:55], v[72:75], v[164:167]
    ds_read_b64_tr_b16 v[70:71], v27 offset:23200
    s_add_u32 m0, s73, 2048
    v_mfma_f32_16x16x32_bf16 v[168:171], v[56:59], v[72:75], v[168:171]
    buffer_load_dwordx4 v10, s[28:31], s44 offen lds
    v_mfma_f32_16x16x32_bf16 v[172:175], v[60:63], v[72:75], v[172:175]
    v_mfma_f32_16x16x32_bf16 v[112:115], v[72:75], v[28:31], v[112:115]
    s_waitcnt lgkmcnt(4)
    v_mfma_f32_16x16x32_bf16 v[176:179], v[48:51], v[76:79], v[176:179]
    ds_read_b64_tr_b16 v[72:73], v27 offset:15552
    v_mfma_f32_16x16x32_bf16 v[180:183], v[52:55], v[76:79], v[180:183]
    ds_read_b64_tr_b16 v[74:75], v27 offset:23232
    s_add_u32 m0, s73, 3072
    v_mfma_f32_16x16x32_bf16 v[184:187], v[56:59], v[76:79], v[184:187]
    buffer_load_dwordx4 v11, s[28:31], s44 offen lds
    v_mfma_f32_16x16x32_bf16 v[188:191], v[60:63], v[76:79], v[188:191]
    s_waitcnt lgkmcnt(4)
    v_mfma_f32_16x16x32_bf16 v[192:195], v[48:51], v[64:67], v[192:195]
    ds_read_b64_tr_b16 v[76:77], v27 offset:15584
    v_mfma_f32_16x16x32_bf16 v[196:199], v[52:55], v[64:67], v[196:199]
    ds_read_b64_tr_b16 v[78:79], v27 offset:23264
    v_mfma_f32_16x16x32_bf16 v[200:203], v[56:59], v[64:67], v[200:203]
    v_mfma_f32_16x16x32_bf16 v[204:207], v[60:63], v[64:67], v[204:207]
    v_mfma_f32_16x16x32_bf16 v[116:119], v[64:67], v[28:31], v[116:119]
    s_waitcnt lgkmcnt(4)
    v_mfma_f32_16x16x32_bf16 v[208:211], v[48:51], v[68:71], v[208:211]
    v_mfma_f32_16x16x32_bf16 v[212:215], v[52:55], v[68:71], v[212:215]
    v_mfma_f32_16x16x32_bf16 v[216:219], v[56:59], v[68:71], v[216:219]
    v_mfma_f32_16x16x32_bf16 v[220:223], v[60:63], v[68:71], v[220:223]
    s_waitcnt vmcnt(12) lgkmcnt(0)
    s_barrier
    ds_read_b128 v[32:35], v15 offset:0
    ds_read_b128 v[36:39], v15 offset:2048
    ds_read_b128 v[40:43], v15 offset:4096
    ds_read_b128 v[44:47], v15 offset:6144
    v_mfma_f32_16x16x32_bf16 v[224:227], v[48:51], v[72:75], v[224:227]
    ds_read_b64_tr_b16 v[64:65], v12 offset:0
    ds_read_b64_tr_b16 v[66:67], v12 offset:7680
    v_mfma_f32_16x16x32_bf16 v[228:231], v[52:55], v[72:75], v[228:231]
    ds_read_b64_tr_b16 v[68:69], v12 offset:32
    ds_read_b64_tr_b16 v[70:71], v12 offset:7712
    v_mfma_f32_16x16x32_bf16 v[232:235], v[56:59], v[72:75], v[232:235]
    v_mfma_f32_16x16x32_bf16 v[236:239], v[60:63], v[72:75], v[236:239]
    v_mfma_f32_16x16x32_bf16 v[120:123], v[72:75], v[28:31], v[120:123]
    v_mfma_f32_16x16x32_bf16 v[240:243], v[48:51], v[76:79], v[240:243]
    ds_read_b64_tr_b16 v[72:73], v12 offset:64
    v_mfma_f32_16x16x32_bf16 v[244:247], v[52:55], v[76:79], v[244:247]
    ds_read_b64_tr_b16 v[74:75], v12 offset:7744
    v_mfma_f32_16x16x32_bf16 v[248:251], v[56:59], v[76:79], v[248:251]
    v_mfma_f32_16x16x32_bf16 v[252:255], v[60:63], v[76:79], v[252:255]
    s_add_u32 s43, s43, s47
    s_add_u32 s44, s44, 128
    s_min_u32 s44, s44, 1152
    s_mov_b32 s75, s70
    s_mov_b32 s70, s71
    s_mov_b32 s71, s72
    s_mov_b32 s72, s75
    v_add_u32 v27, s70, v26
    v_add_u32 v12, s71, v26
    v_add_u32 v13, s70, v24
    v_add_u32 v14, s70, v25
    v_add_u32 v15, s71, v24
    s_add_u32 s45, s45, 1
    s_cmp_lt_u32 s45, 10
    s_cbranch_scc1 K1_LC0
    s_waitcnt lgkmcnt(0)
    s_nop 9
    v_and_b32 v2, 15, v1
    v_lshrrev_b32 v3, 4, v1
    v_lshlrev_b32 v4, 4, v3
    v_add_u32 v4, 141312, v4
    v_cmp_eq_u32 vcc, 0, v2
    s_and_saveexec_b64 s[56:57], vcc
    ds_write_b128 v4, v[108:111] offset:0
    ds_write_b128 v4, v[112:115] offset:128
    ds_write_b128 v4, v[116:119] offset:256
    ds_write_b128 v4, v[120:123] offset:384
    s_mov_b64 exec, s[56:57]
    v_lshlrev_b32 v7, 3, v2
    v_add_u32 v7, 142336, v7
    v_cmp_eq_u32 vcc, 0, v3
    s_and_saveexec_b64 s[56:57], vcc
    ds_write_b32 v7, v92 offset:0
    ds_write_b32 v7, v96 offset:128
    s_mov_b64 exec, s[56:57]
    s_waitcnt vmcnt(0) lgkmcnt(0)
    s_barrier
    s_branch K1_EC
K1_VC_W1:
    s_mov_b32 s70, 0
    s_mov_b32 s71, 47104
    s_mov_b32 s72, 94208
    v_add_u32 v27, s70, v26
    v_add_u32 v12, s71, v26
    v_add_u32 v13, s70, v24
    v_add_u32 v14, s70, v25
    v_add_u32 v15, s71, v24
    s_waitcnt vmcnt(12)
    s_barrier
    ds_read_b128 v[32:35], v13 offset:0
    ds_read_b128 v[36:39], v13 offset:2048
    ds_read_b128 v[40:43], v13 offset:4096
    ds_read_b128 v[44:47], v13 offset:6144
    ds_read_b64_tr_b16 v[64:65], v27 offset:0
    ds_read_b64_tr_b16 v[66:67], v27 offset:7680
    ds_read_b64_tr_b16 v[68:69], v27 offset:32
    ds_read_b64_tr_b16 v[70:71], v27 offset:7712
    ds_read_b64_tr_b16 v[72:73], v27 offset:64
    ds_read_b64_tr_b16 v[74:75], v27 offset:7744
    s_mov_b32 s45, 0
K1_LC1:
    s_add_u32 s42, s72, s41
    s_add_u32 s73, s72, s74
    s_waitcnt lgkmcnt(4)
    v_mfma_f32_16x16x32_bf16 v[128:131], v[32:35], v[64:67], v[128:131]
    ds_read_b64_tr_b16 v[76:77], v27 offset:96
    v_mfma_f32_16x16x32_bf16 v[132:135], v[36:39], v[64:67], v[132:135]
    ds_read_b64_tr_b16 v[78:79], v27 offset:7776
    s_add_u32 m0, s42, 0
    v_mfma_f32_16x16x32_bf16 v[136:139], v[40:43], v[64:67], v[136:139]
    buffer_load_dwordx4 v16, s[32:35], s43 offen lds
    v_mfma_f32_16x16x32_bf16 v[140:143], v[44:47], v[64:67], v[140:143]
    v_mfma_f32_16x16x32_bf16 v[108:111], v[64:67], v[28:31], v[108:111]
    v_mfma_f32_16x16x32_bf16 v[92:95], v[32:35], v[32:35], v[92:95]
    ds_read_b128 v[48:51], v14 offset:0
    ds_read_b128 v[52:55], v14 offset:2048
    ds_read_b128 v[56:59], v14 offset:4096
    ds_read_b128 v[60:63], v14 offset:6144
    s_waitcnt lgkmcnt(8)
    v_mfma_f32_16x16x32_bf16 v[144:147], v[32:35], v[68:71], v[144:147]
    ds_read_b64_tr_b16 v[80:81], v27 offset:128
    v_mfma_f32_16x16x32_bf16 v[148:151], v[36:39], v[68:71], v[148:151]
    ds_read_b64_tr_b16 v[82:83], v27 offset:7808
    s_add_u32 m0, s42, 4096
    v_mfma_f32_16x16x32_bf16 v[152:155], v[40:43], v[68:71], v[152:155]
    buffer_load_dwordx4 v17, s[32:35], s43 offen lds
    v_mfma_f32_16x16x32_bf16 v[156:159], v[44:47], v[68:71], v[156:159]
    v_mfma_f32_16x16x32_bf16 v[96:99], v[36:39], v[36:39], v[96:99]
    s_waitcnt lgkmcnt(8)
    v_mfma_f32_16x16x32_bf16 v[160:163], v[32:35], v[72:75], v[160:163]
    ds_read_b64_tr_b16 v[84:85], v27 offset:160
    v_mfma_f32_16x16x32_bf16 v[164:167], v[36:39], v[72:75], v[164:167]
    ds_read_b64_tr_b16 v[86:87], v27 offset:7840
    s_add_u32 m0, s42, 8192
    v_mfma_f32_16x16x32_bf16 v[168:171], v[40:43], v[72:75], v[168:171]
    buffer_load_dwordx4 v18, s[32:35], s43 offen lds
    v_mfma_f32_16x16x32_bf16 v[172:175], v[44:47], v[72:75], v[172:175]
    v_mfma_f32_16x16x32_bf16 v[112:115], v[72:75], v[28:31], v[112:115]
    v_mfma_f32_16x16x32_bf16 v[100:103], v[40:43], v[40:43], v[100:103]
    s_waitcnt lgkmcnt(8)
    v_mfma_f32_16x16x32_bf16 v[176:179], v[32:35], v[76:79], v[176:179]
    ds_read_b64_tr_b16 v[88:89], v27 offset:192
    v_mfma_f32_16x16x32_bf16 v[180:183], v[36:39], v[76:79], v[180:183]
    ds_read_b64_tr_b16 v[90:91], v27 offset:7872
    s_add_u32 m0, s42, 12288
    v_mfma_f32_16x16x32_bf16 v[184:187], v[40:43], v[76:79], v[184:187]
    buffer_load_dwordx4 v19, s[32:35], s43 offen lds
    v_mfma_f32_16x16x32_bf16 v[188:191], v[44:47], v[76:79], v[188:191]
    v_mfma_f32_16x16x32_bf16 v[104:107], v[44:47], v[44:47], v[104:107]
    s_waitcnt lgkmcnt(4)
    v_mfma_f32_16x16x32_bf16 v[192:195], v[32:35], v[80:83], v[192:195]
    ds_read_b64_tr_b16 v[64:65], v27 offset:15360
    v_mfma_f32_16x16x32_bf16 v[196:199], v[36:39], v[80:83], v[196:199]
    ds_read_b64_tr_b16 v[66:67], v27 offset:23040
    s_add_u32 m0, s42, 16384
    v_mfma_f32_16x16x32_bf16 v[200:203], v[40:43], v[80:83], v[200:203]
    buffer_load_dwordx4 v20, s[32:35], s43 offen lds
    v_mfma_f32_16x16x32_bf16 v[204:207], v[44:47], v[80:83], v[204:207]
    v_mfma_f32_16x16x32_bf16 v[116:119], v[80:83], v[28:31], v[116:119]
    v_mfma_f32_16x16x32_bf16 v[240:243], v[28:31], v[40:43], v[240:243]
    s_waitcnt lgkmcnt(4)
    v_mfma_f32_16x16x32_bf16 v[208:211], v[32:35], v[84:87], v[208:211]
    ds_read_b64_tr_b16 v[68:69], v27 offset:15392
    v_mfma_f32_16x16x32_bf16 v[212:215], v[36:39], v[84:87], v[212:215]
    ds_read_b64_tr_b16 v[70:71], v27 offset:23072
    s_add_u32 m0, s42, 20480
    v_mfma_f32_16x16x32_bf16 v[216:219], v[40:43], v[84:87], v[216:219]
    buffer_load_dwordx4 v21, s[32:35], s43 offen lds
    v_mfma_f32_16x16x32_bf16 v[220:223], v[44:47], v[84:87], v[220:223]
    v_mfma_f32_16x16x32_bf16 v[244:247], v[28:31], v[44:47], v[244:247]
    s_waitcnt lgkmcnt(4)
    v_mfma_f32_16x16x32_bf16 v[224:227], v[32:35], v[88:91], v[224:227]
    ds_read_b64_tr_b16 v[72:73], v27 offset:15424
    v_mfma_f32_16x16x32_bf16 v[228:231], v[36:39], v[88:91], v[228:231]
    ds_read_b64_tr_b16 v[74:75], v27 offset:23104
    s_add_u32 m0, s42, 24576
    v_mfma_f32_16x16x32_bf16 v[232:235], v[40:43], v[88:91], v[232:235]
    buffer_load_dwordx4 v22, s[32:35], s43 offen lds
    v_mfma_f32_16x16x32_bf16 v[236:239], v[44:47], v[88:91], v[236:239]
    v_mfma_f32_16x16x32_bf16 v[120:123], v[88:91], v[28:31], v[120:123]
    s_waitcnt lgkmcnt(4)
    v_mfma_f32_16x16x32_bf16 v[128:131], v[48:51], v[64:67], v[128:131]
    ds_read_b64_tr_b16 v[76:77], v27 offset:15456
    v_mfma_f32_16x16x32_bf16 v[132:135], v[52:55], v[64:67], v[132:135]
    ds_read_b64_tr_b16 v[78:79], v27 offset:23136
    s_add_u32 m0, s42, 28672
    v_mfma_f32_16x16x32_bf16 v[136:139], v[56:59], v[64:67], v[136:139]
    buffer_load_dwordx4 v23, s[32:35], s43 offen lds
    v_mfma_f32_16x16x32_bf16 v[140:143], v[60:63], v[64:67], v[140:143]
    v_mfma_f32_16x16x32_bf16 v[108:111], v[64:67], v[28:31], v[108:111]
    v_mfma_f32_16x16x32_bf16 v[92:95], v[48:51], v[48:51], v[92:95]
    s_waitcnt lgkmcnt(4)
    v_mfma_f32_16x16x32_bf16 v[144:147], v[48:51], v[68:71], v[144:147]
    ds_read_b64_tr_b16 v[80:81], v27 offset:15488
    v_mfma_f32_16x16x32_bf16 v[148:151], v[52:55], v[68:71], v[148:151]
    ds_read_b64_tr_b16 v[82:83], v27 offset:23168
    s_add_u32 m0, s73, 0
    v_mfma_f32_16x16x32_bf16 v[152:155], v[56:59], v[68:71], v[152:155]
    buffer_load_dwordx4 v8, s[28:31], s44 offen lds
    v_mfma_f32_16x16x32_bf16 v[156:159], v[60:63], v[68:71], v[156:159]
    v_mfma_f32_16x16x32_bf16 v[96:99], v[52:55], v[52:55], v[96:99]
    s_waitcnt lgkmcnt(4)
    v_mfma_f32_16x16x32_bf16 v[160:163], v[48:51], v[72:75], v[160:163]
    ds_read_b64_tr_b16 v[84:85], v27 offset:15520
    v_mfma_f32_16x16x32_bf16 v[164:167], v[52:55], v[72:75], v[164:167]
    ds_read_b64_tr_b16 v[86:87], v27 offset:23200
    s_add_u32 m0, s73, 1024
    v_mfma_f32_16x16x32_bf16 v[168:171], v[56:59], v[72:75], v[168:171]
    buffer_load_dwordx4 v9, s[28:31], s44 offen lds
    v_mfma_f32_16x16x32_bf16 v[172:175], v[60:63], v[72:75], v[172:175]
    v_mfma_f32_16x16x32_bf16 v[112:115], v[72:75], v[28:31], v[112:115]
    v_mfma_f32_16x16x32_bf16 v[100:103], v[56:59], v[56:59], v[100:103]
    s_waitcnt lgkmcnt(4)
    v_mfma_f32_16x16x32_bf16 v[176:179], v[48:51], v[76:79], v[176:179]
    ds_read_b64_tr_b16 v[88:89], v27 offset:15552
    v_mfma_f32_16x16x32_bf16 v[180:183], v[52:55], v[76:79], v[180:183]
    ds_read_b64_tr_b16 v[90:91], v27 offset:23232
    s_add_u32 m0, s73, 2048
    v_mfma_f32_16x16x32_bf16 v[184:187], v[56:59], v[76:79], v[184:187]
    buffer_load_dwordx4 v10, s[28:31], s44 offen lds
    v_mfma_f32_16x16x32_bf16 v[188:191], v[60:63], v[76:79], v[188:191]
    v_mfma_f32_16x16x32_bf16 v[104:107], v[60:63], v[60:63], v[104:107]
    s_waitcnt lgkmcnt(4)
    v_mfma_f32_16x16x32_bf16 v[192:195], v[48:51], v[80:83], v[192:195]
    v_mfma_f32_16x16x32_bf16 v[196:199], v[52:55], v[80:83], v[196:199]
    s_add_u32 m0, s73, 3072
    v_mfma_f32_16x16x32_bf16 v[200:203], v[56:59], v[80:83], v[200:203]
    buffer_load_dwordx4 v11, s[28:31], s44 offen lds
    s_cmp_lg_u32 s45, 0
    s_cbranch_scc1 K1_T_13
    buffer_load_dword v124, v126, s[28:31], 0 offen
    buffer_load_dword v125, v127, s[32:35], 0 offen
K1_T_13:
    v_mfma_f32_16x16x32_bf16 v[204:207], v[60:63], v[80:83], v[204:207]
    v_mfma_f32_16x16x32_bf16 v[116:119], v[80:83], v[28:31], v[116:119]
    v_mfma_f32_16x16x32_bf16 v[240:243], v[28:31], v[56:59], v[240:243]
    s_waitcnt vmcnt(12) lgkmcnt(0)
    s_barrier
    ds_read_b128 v[32:35], v15 offset:0
    ds_read_b128 v[36:39], v15 offset:2048
    ds_read_b128 v[40:43], v15 offset:4096
    ds_read_b128 v[44:47], v15 offset:6144
    v_mfma_f32_16x16x32_bf16 v[208:211], v[48:51], v[84:87], v[208:211]
    ds_read_b64_tr_b16 v[64:65], v12 offset:0
    ds_read_b64_tr_b16 v[66:67], v12 offset:7680
    v_mfma_f32_16x16x32_bf16 v[212:215], v[52:55], v[84:87], v[212:215]
    ds_read_b64_tr_b16 v[68:69], v12 offset:32
    ds_read_b64_tr_b16 v[70:71], v12 offset:7712
    v_mfma_f32_16x16x32_bf16 v[216:219], v[56:59], v[84:87], v[216:219]
    v_mfma_f32_16x16x32_bf16 v[220:223], v[60:63], v[84:87], v[220:223]
    v_mfma_f32_16x16x32_bf16 v[244:247], v[28:31], v[60:63], v[244:247]
    v_mfma_f32_16x16x32_bf16 v[224:227], v[48:51], v[88:91], v[224:227]
    ds_read_b64_tr_b16 v[72:73], v12 offset:64
    v_mfma_f32_16x16x32_bf16 v[228:231], v[52:55], v[88:91], v[228:231]
    ds_read_b64_tr_b16 v[74:75], v12 offset:7744
    v_mfma_f32_16x16x32_bf16 v[232:235], v[56:59], v[88:91], v[232:235]
    v_mfma_f32_16x16x32_bf16 v[236:239], v[60:63], v[88:91], v[236:239]
    v_mfma_f32_16x16x32_bf16 v[120:123], v[88:91], v[28:31], v[120:123]
    s_add_u32 s43, s43, s47
    s_add_u32 s44, s44, 128
    s_min_u32 s44, s44, 1152
    s_mov_b32 s75, s70
    s_mov_b32 s70, s71
    s_mov_b32 s71, s72
    s_mov_b32 s72, s75
    v_add_u32 v27, s70, v26
    v_add_u32 v12, s71, v26
    v_add_u32 v13, s70, v24
    v_add_u32 v14, s70, v25
    v_add_u32 v15, s71, v24
    s_add_u32 s45, s45, 1
    s_cmp_lt_u32 s45, 10
    s_cbranch_scc1 K1_LC1
    s_waitcnt lgkmcnt(0)
    s_nop 9
    v_and_b32 v2, 15, v1
    v_lshrrev_b32 v3, 4, v1
    v_lshlrev_b32 v4, 4, v3
    v_add_u32 v4, 141312, v4
    v_cmp_eq_u32 vcc, 0, v2
    s_and_saveexec_b64 s[56:57], vcc
    ds_write_b128 v4, v[108:111] offset:512
    ds_write_b128 v4, v[112:115] offset:640
    ds_write_b128 v4, v[116:119] offset:768
    ds_write_b128 v4, v[120:123] offset:896
    s_mov_b64 exec, s[56:57]
    v_lshlrev_b32 v7, 3, v2
    v_add_u32 v7, 142336, v7
    v_cmp_eq_u32 vcc, 0, v3
    s_and_saveexec_b64 s[56:57], vcc
    ds_write_b32 v7, v240 offset:256
    ds_write_b32 v7, v244 offset:384
    s_mov_b64 exec, s[56:57]
    v_and_b32 v5, 3, v2
    v_lshrrev_b32 v6, 2, v2
    v_cmp_eq_u32 s[62:63], 1, v5
    v_cmp_eq_u32 s[64:65], 2, v5
    v_cmp_eq_u32 s[66:67], 3, v5
    v_cmp_eq_u32 vcc, v6, v3
    s_and_saveexec_b64 s[56:57], vcc
    v_mov_b32 v8, v92
    v_cndmask_b32 v8, v8, v93, s[62:63]
    v_cndmask_b32 v8, v8, v94, s[64:65]
    v_cndmask_b32 v8, v8, v95, s[66:67]
    ds_write_b32 v7, v8 offset:4
    s_nop 0
    v_mov_b32 v8, v96
    v_cndmask_b32 v8, v8, v97, s[62:63]
    v_cndmask_b32 v8, v8, v98, s[64:65]
    v_cndmask_b32 v8, v8, v99, s[66:67]
    ds_write_b32 v7, v8 offset:132
    s_nop 0
    v_mov_b32 v8, v100
    v_cndmask_b32 v8, v8, v101, s[62:63]
    v_cndmask_b32 v8, v8, v102, s[64:65]
    v_cndmask_b32 v8, v8, v103, s[66:67]
    ds_write_b32 v7, v8 offset:260
    s_nop 0
    v_mov_b32 v8, v104
    v_cndmask_b32 v8, v8, v105, s[62:63]
    v_cndmask_b32 v8, v8, v106, s[64:65]
    v_cndmask_b32 v8, v8, v107, s[66:67]
    ds_write_b32 v7, v8 offset:388
    s_nop 0
    s_mov_b64 exec, s[56:57]
    s_waitcnt vmcnt(0) lgkmcnt(0)
    s_barrier
    s_branch K1_EC
K1_VC_W2:
    s_mov_b32 s70, 0
    s_mov_b32 s71, 47104
    s_mov_b32 s72, 94208
    v_add_u32 v27, s70, v26
    v_add_u32 v12, s71, v26
    v_add_u32 v13, s70, v24
    v_add_u32 v14, s70, v25
    v_add_u32 v15, s71, v24
    s_waitcnt vmcnt(11)
    s_barrier
    ds_read_b128 v[32:35], v13 offset:0
    ds_read_b128 v[36:39], v13 offset:2048
    ds_read_b128 v[40:43], v13 offset:4096
    ds_read_b128 v[44:47], v13 offset:6144
    ds_read_b64_tr_b16 v[64:65], v27 offset:0
    ds_read_b64_tr_b16 v[66:67], v27 offset:7680
    ds_read_b64_tr_b16 v[68:69], v27 offset:32
    ds_read_b64_tr_b16 v[70:71], v27 offset:7712
    ds_read_b64_tr_b16 v[72:73], v27 offset:64
    ds_read_b64_tr_b16 v[74:75], v27 offset:7744
    s_mov_b32 s45, 0
K1_LC2:
    s_add_u32 s42, s72, s41
    s_add_u32 s73, s72, s74
    s_waitcnt lgkmcnt(4)
    v_mfma_f32_16x16x32_bf16 v[128:131], v[32:35], v[64:67], v[128:131]
    ds_read_b64_tr_b16 v[76:77], v27 offset:96
    v_mfma_f32_16x16x32_bf16 v[132:135], v[36:39], v[64:67], v[132:135]
    ds_read_b64_tr_b16 v[78:79], v27 offset:7776
    s_add_u32 m0, s42, 0
    v_mfma_f32_16x16x32_bf16 v[136:139], v[40:43], v[64:67], v[136:139]
    buffer_load_dwordx4 v16, s[32:35], s43 offen lds
    v_mfma_f32_16x16x32_bf16 v[140:143], v[44:47], v[64:67], v[140:143]
    v_mfma_f32_16x16x32_bf16 v[92:95], v[28:31], v[32:35], v[92:95]
    ds_read_b128 v[48:51], v14 offset:0
    ds_read_b128 v[52:55], v14 offset:2048
    ds_read_b128 v[56:59], v14 offset:4096
    ds_read_b128 v[60:63], v14 offset:6144
    s_waitcnt lgkmcnt(8)
    v_mfma_f32_16x16x32_bf16 v[144:147], v[32:35], v[68:71], v[144:147]
    ds_read_b64_tr_b16 v[64:65], v27 offset:128
    v_mfma_f32_16x16x32_bf16 v[148:151], v[36:39], v[68:71], v[148:151]
    ds_read_b64_tr_b16 v[66:67], v27 offset:7808
    s_add_u32 m0, s42, 4096
    v_mfma_f32_16x16x32_bf16 v[152:155], v[40:43], v[68:71], v[152:155]
    buffer_load_dwordx4 v17, s[32:35], s43 offen lds
    v_mfma_f32_16x16x32_bf16 v[156:159], v[44:47], v[68:71], v[156:159]
    v_mfma_f32_16x16x32_bf16 v[108:111], v[68:71], v[28:31], v[108:111]
    v_mfma_f32_16x16x32_bf16 v[96:99], v[28:31], v[36:39], v[96:99]
    s_waitcnt lgkmcnt(8)
    v_mfma_f32_16x16x32_bf16 v[160:163], v[32:35], v[72:75], v[160:163]
    ds_read_b64_tr_b16 v[68:69], v27 offset:160
    v_mfma_f32_16x16x32_bf16 v[164:167], v[36:39], v[72:75], v[164:167]
    ds_read_b64_tr_b16 v[70:71], v27 offset:7840
    s_add_u32 m0, s42, 8192
    v_mfma_f32_16x16x32_bf16 v[168:171], v[40:43], v[72:75], v[168:171]
    buffer_load_dwordx4 v18, s[32:35], s43 offen lds
    v_mfma_f32_16x16x32_bf16 v[172:175], v[44:47], v[72:75], v[172:175]
    s_waitcnt lgkmcnt(8)
    v_mfma_f32_16x16x32_bf16 v[176:179], v[32:35], v[76:79], v[176:179]
    ds_read_b64_tr_b16 v[72:73], v27 offset:192
    v_mfma_f32_16x16x32_bf16 v[180:183], v[36:39], v[76:79], v[180:183]
    ds_read_b64_tr_b16 v[74:75], v27 offset:7872
    s_add_u32 m0, s42, 12288
    v_mfma_f32_16x16x32_bf16 v[184:187], v[40:43], v[76:79], v[184:187]
    buffer_load_dwordx4 v19, s[32:35], s43 offen lds
    v_mfma_f32_16x16x32_bf16 v[188:191], v[44:47], v[76:79], v[188:191]
    v_mfma_f32_16x16x32_bf16 v[112:115], v[76:79], v[28:31], v[112:115]
    s_waitcnt lgkmcnt(4)
    v_mfma_f32_16x16x32_bf16 v[192:195], v[32:35], v[64:67], v[192:195]
    ds_read_b64_tr_b16 v[76:77], v27 offset:224
    v_mfma_f32_16x16x32_bf16 v[196:199], v[36:39], v[64:67], v[196:199]
    ds_read_b64_tr_b16 v[78:79], v27 offset:7904
    s_add_u32 m0, s42, 16384
    v_mfma_f32_16x16x32_bf16 v[200:203], v[40:43], v[64:67], v[200:203]
    buffer_load_dwordx4 v20, s[32:35], s43 offen lds
    v_mfma_f32_16x16x32_bf16 v[204:207], v[44:47], v[64:67], v[204:207]
    s_waitcnt lgkmcnt(4)
    v_mfma_f32_16x16x32_bf16 v[208:211], v[32:35], v[68:71], v[208:211]
    ds_read_b64_tr_b16 v[64:65], v27 offset:15360
    v_mfma_f32_16x16x32_bf16 v[212:215], v[36:39], v[68:71], v[212:215]
    ds_read_b64_tr_b16 v[66:67], v27 offset:23040
    s_add_u32 m0, s42, 20480
    v_mfma_f32_16x16x32_bf16 v[216:219], v[40:43], v[68:71], v[216:219]
    buffer_load_dwordx4 v21, s[32:35], s43 offen lds
    v_mfma_f32_16x16x32_bf16 v[220:223], v[44:47], v[68:71], v[220:223]
    v_mfma_f32_16x16x32_bf16 v[116:119], v[68:71], v[28:31], v[116:119]
    s_waitcnt lgkmcnt(4)
    v_mfma_f32_16x16x32_bf16 v[224:227], v[32:35], v[72:75], v[224:227]
    ds_read_b64_tr_b16 v[68:69], v27 offset:15392
    v_mfma_f32_16x16x32_bf16 v[228:231], v[36:39], v[72:75], v[228:231]
    ds_read_b64_tr_b16 v[70:71], v27 offset:23072
    s_add_u32 m0, s42, 24576
    v_mfma_f32_16x16x32_bf16 v[232:235], v[40:43], v[72:75], v[232:235]
    buffer_load_dwordx4 v22, s[32:35], s43 offen lds
    v_mfma_f32_16x16x32_bf16 v[236:239], v[44:47], v[72:75], v[236:239]
    s_waitcnt lgkmcnt(4)
    v_mfma_f32_16x16x32_bf16 v[240:243], v[32:35], v[76:79], v[240:243]
    ds_read_b64_tr_b16 v[72:73], v27 offset:15424
    v_mfma_f32_16x16x32_bf16 v[244:247], v[36:39], v[76:79], v[244:247]
    ds_read_b64_tr_b16 v[74:75], v27 offset:23104
    s_add_u32 m0, s73, 0
    v_mfma_f32_16x16x32_bf16 v[248:251], v[40:43], v[76:79], v[248:251]
    buffer_load_dwordx4 v8, s[28:31], s44 offen lds
    v_mfma_f32_16x16x32_bf16 v[252:255], v[44:47], v[76:79], v[252:255]
    v_mfma_f32_16x16x32_bf16 v[120:123], v[76:79], v[28:31], v[120:123]
    s_waitcnt lgkmcnt(4)
    v_mfma_f32_16x16x32_bf16 v[128:131], v[48:51], v[64:67], v[128:131]
    ds_read_b64_tr_b16 v[76:77], v27 offset:15456
    v_mfma_f32_16x16x32_bf16 v[132:135], v[52:55], v[64:67], v[132:135]
    ds_read_b64_tr_b16 v[78:79], v27 offset:23136
    s_add_u32 m0, s73, 1024
    v_mfma_f32_16x16x32_bf16 v[136:139], v[56:59], v[64:67], v[136:139]
    buffer_load_dwordx4 v9, s[28:31], s44 offen lds
    v_mfma_f32_16x16x32_bf16 v[140:143], v[60:63], v[64:67], v[140:143]
    v_mfma_f32_16x16x32_bf16 v[92:95], v[28:31], v[48:51], v[92:95]
    s_waitcnt lgkmcnt(4)
    v_mfma_f32_16x16x32_bf16 v[144:147], v[48:51], v[68:71], v[144:147]
    ds_read_b64_tr_b16 v[64:65], v27 offset:15488
    v_mfma_f32_16x16x32_bf16 v[148:151], v[52:55], v[68:71], v[148:151]
    ds_read_b64_tr_b16 v[66:67], v27 offset:23168
    s_add_u32 m0, s73, 2048
    v_mfma_f32_16x16x32_bf16 v[152:155], v[56:59], v[68:71], v[152:155]
    buffer_load_dwordx4 v10, s[28:31], s44 offen lds
    v_mfma_f32_16x16x32_bf16 v[156:159], v[60:63], v[68:71], v[156:159]
    v_mfma_f32_16x16x32_bf16 v[108:111], v[68:71], v[28:31], v[108:111]
    v_mfma_f32_16x16x32_bf16 v[96:99], v[28:31], v[52:55], v[96:99]
    s_waitcnt lgkmcnt(4)
    v_mfma_f32_16x16x32_bf16 v[160:163], v[48:51], v[72:75], v[160:163]
    ds_read_b64_tr_b16 v[68:69], v27 offset:15520
    v_mfma_f32_16x16x32_bf16 v[164:167], v[52:55], v[72:75], v[164:167]
    ds_read_b64_tr_b16 v[70:71], v27 offset:23200
    s_add_u32 m0, s73, 3072
    v_mfma_f32_16x16x32_bf16 v[168:171], v[56:59], v[72:75], v[168:171]
    buffer_load_dwordx4 v11, s[28:31], s44 offen lds
    s_cmp_lg_u32 s45, 2
    s_cbranch_scc1 K1_T_14
    buffer_load_dword v124, v126, s[28:31], 0 offen
    buffer_load_dword v125, v127, s[32:35], 0 offen
K1_T_14:
    v_mfma_f32_16x16x32_bf16 v[172:175], v[60:63], v[72:75], v[172:175]
    s_waitcnt lgkmcnt(4)
    v_mfma_f32_16x16x32_bf16 v[176:179], v[48:51], v[76:79], v[176:179]
    ds_read_b64_tr_b16 v[72:73], v27 offset:15552
    v_mfma_f32_16x16x32_bf16 v[180:183], v[52:55], v[76:79], v[180:183]
    ds_read_b64_tr_b16 v[74:75], v27 offset:23232
    v_mfma_f32_16x16x32_bf16 v[184:187], v[56:59], v[76:79], v[184:187]
    v_mfma_f32_16x16x32_bf16 v[188:191], v[60:63], v[76:79], v[188:191]
    v_mfma_f32_16x16x32_bf16 v[112:115], v[76:79], v[28:31], v[112:115]
    s_waitcnt lgkmcnt(4)
    v_mfma_f32_16x16x32_bf16 v[192:195], v[48:51], v[64:67], v[192:195]
    ds_read_b64_tr_b16 v[76:77], v27 offset:15584
    v_mfma_f32_16x16x32_bf16 v[196:199], v[52:55], v[64:67], v[196:199]
    ds_read_b64_tr_b16 v[78:79], v27 offset:23264
    v_mfma_f32_16x16x32_bf16 v[200:203], v[56:59], v[64:67], v[200:203]
    v_mfma_f32_16x16x32_bf16 v[204:207], v[60:63], v[64:67], v[204:207]
    s_waitcnt lgkmcnt(4)
    v_mfma_f32_16x16x32_bf16 v[208:211], v[48:51], v[68:71], v[208:211]
    v_mfma_f32_16x16x32_bf16 v[212:215], v[52:55], v[68:71], v[212:215]
    v_mfma_f32_16x16x32_bf16 v[216:219], v[56:59], v[68:71], v[216:219]
    v_mfma_f32_16x16x32_bf16 v[220:223], v[60:63], v[68:71], v[220:223]
    v_mfma_f32_16x16x32_bf16 v[116:119], v[68:71], v[28:31], v[116:119]
    s_waitcnt vmcnt(11) lgkmcnt(0)
    s_barrier
    ds_read_b128 v[32:35], v15 offset:0
    ds_read_b128 v[36:39], v15 offset:2048
    ds_read_b128 v[40:43], v15 offset:4096
    ds_read_b128 v[44:47], v15 offset:6144
    v_mfma_f32_16x16x32_bf16 v[224:227], v[48:51], v[72:75], v[224:227]
    ds_read_b64_tr_b16 v[64:65], v12 offset:0
    ds_read_b64_tr_b16 v[66:67], v12 offset:7680
    v_mfma_f32_16x16x32_bf16 v[228:231], v[52:55], v[72:75], v[228:231]
    ds_read_b64_tr_b16 v[68:69], v12 offset:32
    ds_read_b64_tr_b16 v[70:71], v12 offset:7712
    v_mfma_f32_16x16x32_bf16 v[232:235], v[56:59], v[72:75], v[232:235]
    v_mfma_f32_16x16x32_bf16 v[236:239], v[60:63], v[72:75], v[236:239]
    v_mfma_f32_16x16x32_bf16 v[240:243], v[48:51], v[76:79], v[240:243]
    ds_read_b64_tr_b16 v[72:73], v12 offset:64
    v_mfma_f32_16x16x32_bf16 v[244:247], v[52:55], v[76:79], v[244:247]
    ds_read_b64_tr_b16 v[74:75], v12 offset:7744
    v_mfma_f32_16x16x32_bf16 v[248:251], v[56:59], v[76:79], v[248:251]
    v_mfma_f32_16x16x32_bf16 v[252:255], v[60:63], v[76:79], v[252:255]
    v_mfma_f32_16x16x32_bf16 v[120:123], v[76:79], v[28:31], v[120:123]
    s_add_u32 s43, s43, s47
    s_add_u32 s44, s44, 128
    s_min_u32 s44, s44, 1152
    s_mov_b32 s75, s70
    s_mov_b32 s70, s71
    s_mov_b32 s71, s72
    s_mov_b32 s72, s75
    v_add_u32 v27, s70, v26
    v_add_u32 v12, s71, v26
    v_add_u32 v13, s70, v24
    v_add_u32 v14, s70, v25
    v_add_u32 v15, s71, v24
    s_add_u32 s45, s45, 1
    s_cmp_lt_u32 s45, 10
    s_cbranch_scc1 K1_LC2
    s_waitcnt lgkmcnt(0)
    s_nop 9
    v_and_b32 v2, 15, v1
    v_lshrrev_b32 v3, 4, v1
    v_lshlrev_b32 v4, 4, v3
    v_add_u32 v4, 141312, v4
    v_cmp_eq_u32 vcc, 0, v2
    s_and_saveexec_b64 s[56:57], vcc
    ds_write_b128 v4, v[108:111] offset:64
    ds_write_b128 v4, v[112:115] offset:192
    ds_write_b128 v4, v[116:119] offset:320
    ds_write_b128 v4, v[120:123] offset:448
    s_mov_b64 exec, s[56:57]
    v_lshlrev_b32 v7, 3, v2
    v_add_u32 v7, 142848, v7
    v_cmp_eq_u32 vcc, 0, v3
    s_and_saveexec_b64 s[56:57], vcc
    ds_write_b32 v7, v92 offset:0
    ds_write_b32 v7, v96 offset:128
    s_mov_b64 exec, s[56:57]
    s_waitcnt vmcnt(0) lgkmcnt(0)
    s_barrier
    s_branch K1_EC
K1_VC_W3:
    s_mov_b32 s70, 0
    s_mov_b32 s71, 47104
    s_mov_b32 s72, 94208
    v_add_u32 v27, s70, v26
    v_add_u32 v12, s71, v26
    v_add_u32 v13, s70, v24
    v_add_u32 v14, s70, v25
    v_add_u32 v15, s71, v24
    s_waitcnt vmcnt(11)
    s_barrier
    ds_read_b128 v[32:35], v13 offset:0
    ds_read_b128 v[36:39], v13 offset:2048
    ds_read_b128 v[40:43], v13 offset:4096
    ds_read_b128 v[44:47], v13 offset:6144
    ds_read_b64_tr_b16 v[64:65], v27 offset:0
    ds_read_b64_tr_b16 v[66:67], v27 offset:7680
    ds_read_b64_tr_b16 v[68:69], v27 offset:32
    ds_read_b64_tr_b16 v[70:71], v27 offset:7712
    ds_read_b64_tr_b16 v[72:73], v27 offset:64
    ds_read_b64_tr_b16 v[74:75], v27 offset:7744
    s_mov_b32 s45, 0
K1_LC3:
    s_add_u32 s42, s72, s41
    s_add_u32 s73, s72, s74
    s_waitcnt lgkmcnt(4)
    v_mfma_f32_16x16x32_bf16 v[128:131], v[32:35], v[64:67], v[128:131]
    ds_read_b64_tr_b16 v[76:77], v27 offset:96
    v_mfma_f32_16x16x32_bf16 v[132:135], v[36:39], v[64:67], v[132:135]
    ds_read_b64_tr_b16 v[78:79], v27 offset:7776
    s_add_u32 m0, s42, 0
    v_mfma_f32_16x16x32_bf16 v[136:139], v[40:43], v[64:67], v[136:139]
    buffer_load_dwordx4 v16, s[32:35], s43 offen lds
    v_mfma_f32_16x16x32_bf16 v[140:143], v[44:47], v[64:67], v[140:143]
    v_mfma_f32_16x16x32_bf16 v[92:95], v[32:35], v[32:35], v[92:95]
    ds_read_b128 v[48:51], v14 offset:0
    ds_read_b128 v[52:55], v14 offset:2048
    ds_read_b128 v[56:59], v14 offset:4096
    ds_read_b128 v[60:63], v14 offset:6144
    s_waitcnt lgkmcnt(8)
    v_mfma_f32_16x16x32_bf16 v[144:147], v[32:35], v[68:71], v[144:147]
    ds_read_b64_tr_b16 v[80:81], v27 offset:128
    v_mfma_f32_16x16x32_bf16 v[148:151], v[36:39], v[68:71], v[148:151]
    ds_read_b64_tr_b16 v[82:83], v27 offset:7808
    s_add_u32 m0, s42, 4096
    v_mfma_f32_16x16x32_bf16 v[152:155], v[40:43], v[68:71], v[152:155]
    buffer_load_dwordx4 v17, s[32:35], s43 offen lds
    v_mfma_f32_16x16x32_bf16 v[156:159], v[44:47], v[68:71], v[156:159]
    v_mfma_f32_16x16x32_bf16 v[108:111], v[68:71], v[28:31], v[108:111]
    v_mfma_f32_16x16x32_bf16 v[96:99], v[36:39], v[36:39], v[96:99]
    s_waitcnt lgkmcnt(8)
    v_mfma_f32_16x16x32_bf16 v[160:163], v[32:35], v[72:75], v[160:163]
    ds_read_b64_tr_b16 v[84:85], v27 offset:160
    v_mfma_f32_16x16x32_bf16 v[164:167], v[36:39], v[72:75], v[164:167]
    ds_read_b64_tr_b16 v[86:87], v27 offset:7840
    s_add_u32 m0, s42, 8192
    v_mfma_f32_16x16x32_bf16 v[168:171], v[40:43], v[72:75], v[168:171]
    buffer_load_dwordx4 v18, s[32:35], s43 offen lds
    v_mfma_f32_16x16x32_bf16 v[172:175], v[44:47], v[72:75], v[172:175]
    v_mfma_f32_16x16x32_bf16 v[100:103], v[40:43], v[40:43], v[100:103]
    s_waitcnt lgkmcnt(8)
    v_mfma_f32_16x16x32_bf16 v[176:179], v[32:35], v[76:79], v[176:179]
    ds_read_b64_tr_b16 v[88:89], v27 offset:192
    v_mfma_f32_16x16x32_bf16 v[180:183], v[36:39], v[76:79], v[180:183]
    ds_read_b64_tr_b16 v[90:91], v27 offset:7872
    s_add_u32 m0, s42, 12288
    v_mfma_f32_16x16x32_bf16 v[184:187], v[40:43], v[76:79], v[184:187]
    buffer_load_dwordx4 v19, s[32:35], s43 offen lds
    v_mfma_f32_16x16x32_bf16 v[188:191], v[44:47], v[76:79], v[188:191]
    v_mfma_f32_16x16x32_bf16 v[112:115], v[76:79], v[28:31], v[112:115]
    v_mfma_f32_16x16x32_bf16 v[104:107], v[44:47], v[44:47], v[104:107]
    s_waitcnt lgkmcnt(4)
    v_mfma_f32_16x16x32_bf16 v[192:195], v[32:35], v[80:83], v[192:195]
    ds_read_b64_tr_b16 v[64:65], v27 offset:15360
    v_mfma_f32_16x16x32_bf16 v[196:199], v[36:39], v[80:83], v[196:199]
    ds_read_b64_tr_b16 v[66:67], v27 offset:23040
    s_add_u32 m0, s42, 16384
    v_mfma_f32_16x16x32_bf16 v[200:203], v[40:43], v[80:83], v[200:203]
    buffer_load_dwordx4 v20, s[32:35], s43 offen lds
    v_mfma_f32_16x16x32_bf16 v[204:207], v[44:47], v[80:83], v[204:207]
    v_mfma_f32_16x16x32_bf16 v[240:243], v[28:31], v[40:43], v[240:243]
    s_waitcnt lgkmcnt(4)
    v_mfma_f32_16x16x32_bf16 v[208:211], v[32:35], v[84:87], v[208:211]
    ds_read_b64_tr_b16 v[68:69], v27 offset:15392
    v_mfma_f32_16x16x32_bf16 v[212:215], v[36:39], v[84:87], v[212:215]
    ds_read_b64_tr_b16 v[70:71], v27 offset:23072
    s_add_u32 m0, s42, 20480
    v_mfma_f32_16x16x32_bf16 v[216:219], v[40:43], v[84:87], v[216:219]
    buffer_load_dwordx4 v21, s[32:35], s43 offen lds
    v_mfma_f32_16x16x32_bf16 v[220:223], v[44:47], v[84:87], v[220:223]
    v_mfma_f32_16x16x32_bf16 v[116:119], v[84:87], v[28:31], v[116:119]
    v_mfma_f32_16x16x32_bf16 v[244:247], v[28:31], v[44:47], v[244:247]
    s_waitcnt lgkmcnt(4)
    v_mfma_f32_16x16x32_bf16 v[224:227], v[32:35], v[88:91], v[224:227]
    ds_read_b64_tr_b16 v[72:73], v27 offset:15424
    v_mfma_f32_16x16x32_bf16 v[228:231], v[36:39], v[88:91], v[228:231]
    ds_read_b64_tr_b16 v[74:75], v27 offset:23104
    s_add_u32 m0, s42, 24576
    v_mfma_f32_16x16x32_bf16 v[232:235], v[40:43], v[88:91], v[232:235]
    buffer_load_dwordx4 v22, s[32:35], s43 offen lds
    v_mfma_f32_16x16x32_bf16 v[236:239], v[44:47], v[88:91], v[236:239]
    s_waitcnt lgkmcnt(4)
    v_mfma_f32_16x16x32_bf16 v[128:131], v[48:51], v[64:67], v[128:131]
    ds_read_b64_tr_b16 v[76:77], v27 offset:15456
    v_mfma_f32_16x16x32_bf16 v[132:135], v[52:55], v[64:67], v[132:135]
    ds_read_b64_tr_b16 v[78:79], v27 offset:23136
    s_add_u32 m0, s73, 0
    v_mfma_f32_16x16x32_bf16 v[136:139], v[56:59], v[64:67], v[136:139]
    buffer_load_dwordx4 v8, s[28:31], s44 offen lds
    v_mfma_f32_16x16x32_bf16 v[140:143], v[60:63], v[64:67], v[140:143]
    v_mfma_f32_16x16x32_bf16 v[92:95], v[48:51], v[48:51], v[92:95]
    s_waitcnt lgkmcnt(4)
    v_mfma_f32_16x16x32_bf16 v[144:147], v[48:51], v[68:71], v[144:147]
    ds_read_b64_tr_b16 v[80:81], v27 offset:15488
    v_mfma_f32_16x16x32_bf16 v[148:151], v[52:55], v[68:71], v[148:151]
    ds_read_b64_tr_b16 v[82:83], v27 offset:23168
    s_add_u32 m0, s73, 1024
    v_mfma_f32_16x16x32_bf16 v[152:155], v[56:59], v[68:71], v[152:155]
    buffer_load_dwordx4 v9, s[28:31], s44 offen lds
    v_mfma_f32_16x16x32_bf16 v[156:159], v[60:63], v[68:71], v[156:159]
    v_mfma_f32_16x16x32_bf16 v[108:111], v[68:71], v[28:31], v[108:111]
    v_mfma_f32_16x16x32_bf16 v[96:99], v[52:55], v[52:55], v[96:99]
    s_waitcnt lgkmcnt(4)
    v_mfma_f32_16x16x32_bf16 v[160:163], v[48:51], v[72:75], v[160:163]
    ds_read_b64_tr_b16 v[84:85], v27 offset:15520
    v_mfma_f32_16x16x32_bf16 v[164:167], v[52:55], v[72:75], v[164:167]
    ds_read_b64_tr_b16 v[86:87], v27 offset:23200
    s_add_u32 m0, s73, 2048
    v_mfma_f32_16x16x32_bf16 v[168:171], v[56:59], v[72:75], v[168:171]
    buffer_load_dwordx4 v10, s[28:31], s44 offen lds
    v_mfma_f32_16x16x32_bf16 v[172:175], v[60:63], v[72:75], v[172:175]
    v_mfma_f32_16x16x32_bf16 v[100:103], v[56:59], v[56:59], v[100:103]
    s_waitcnt lgkmcnt(4)
    v_mfma_f32_16x16x32_bf16 v[176:179], v[48:51], v[76:79], v[176:179]
    ds_read_b64_tr_b16 v[88:89], v27 offset:15552
    v_mfma_f32_16x16x32_bf16 v[180:183], v[52:55], v[76:79], v[180:183]
    ds_read_b64_tr_b16 v[90:91], v27 offset:23232
    s_add_u32 m0, s73, 3072
    v_mfma_f32_16x16x32_bf16 v[184:187], v[56:59], v[76:79], v[184:187]
    buffer_load_dwordx4 v11, s[28:31], s44 offen lds
    s_cmp_lg_u32 s45, 4
    s_cbranch_scc1 K1_T_15
    buffer_load_dword v124, v126, s[28:31], 0 offen
    buffer_load_dword v125, v127, s[32:35], 0 offen
K1_T_15:
    v_mfma_f32_16x16x32_bf16 v[188:191], v[60:63], v[76:79], v[188:191]
    v_mfma_f32_16x16x32_bf16 v[112:115], v[76:79], v[28:31], v[112:115]
    v_mfma_f32_16x16x32_bf16 v[104:107], v[60:63], v[60:63], v[104:107]
    s_waitcnt lgkmcnt(4)
    v_mfma_f32_16x16x32_bf16 v[192:195], v[48:51], v[80:83], v[192:195]
    v_mfma_f32_16x16x32_bf16 v[196:199], v[52:55], v[80:83], v[196:199]
    v_mfma_f32_16x16x32_bf16 v[200:203], v[56:59], v[80:83], v[200:203]
    v_mfma_f32_16x16x32_bf16 v[204:207], v[60:63], v[80:83], v[204:207]
    v_mfma_f32_16x16x32_bf16 v[240:243], v[28:31], v[56:59], v[240:243]
    s_waitcnt vmcnt(11) lgkmcnt(0)
    s_barrier
    ds_read_b128 v[32:35], v15 offset:0
    ds_read_b128 v[36:39], v15 offset:2048
    ds_read_b128 v[40:43], v15 offset:4096
    ds_read_b128 v[44:47], v15 offset:6144
    v_mfma_f32_16x16x32_bf16 v[208:211], v[48:51], v[84:87], v[208:211]
    ds_read_b64_tr_b16 v[64:65], v12 offset:0
    ds_read_b64_tr_b16 v[66:67], v12 offset:7680
    v_mfma_f32_16x16x32_bf16 v[212:215], v[52:55], v[84:87], v[212:215]
    ds_read_b64_tr_b16 v[68:69], v12 offset:32
    ds_read_b64_tr_b16 v[70:71], v12 offset:7712
    v_mfma_f32_16x16x32_bf16 v[216:219], v[56:59], v[84:87], v[216:219]
    v_mfma_f32_16x16x32_bf16 v[220:223], v[60:63], v[84:87], v[220:223]
    v_mfma_f32_16x16x32_bf16 v[116:119], v[84:87], v[28:31], v[116:119]
    v_mfma_f32_16x16x32_bf16 v[244:247], v[28:31], v[60:63], v[244:247]
    v_mfma_f32_16x16x32_bf16 v[224:227], v[48:51], v[88:91], v[224:227]
    ds_read_b64_tr_b16 v[72:73], v12 offset:64
    v_mfma_f32_16x16x32_bf16 v[228:231], v[52:55], v[88:91], v[228:231]
    ds_read_b64_tr_b16 v[74:75], v12 offset:7744
    v_mfma_f32_16x16x32_bf16 v[232:235], v[56:59], v[88:91], v[232:235]
    v_mfma_f32_16x16x32_bf16 v[236:239], v[60:63], v[88:91], v[236:239]
    s_add_u32 s43, s43, s47
    s_add_u32 s44, s44, 128
    s_min_u32 s44, s44, 1152
    s_mov_b32 s75, s70
    s_mov_b32 s70, s71
    s_mov_b32 s71, s72
    s_mov_b32 s72, s75
    v_add_u32 v27, s70, v26
    v_add_u32 v12, s71, v26
    v_add_u32 v13, s70, v24
    v_add_u32 v14, s70, v25
    v_add_u32 v15, s71, v24
    s_add_u32 s45, s45, 1
    s_cmp_lt_u32 s45, 10
    s_cbranch_scc1 K1_LC3
    s_waitcnt lgkmcnt(0)
    s_nop 9
    v_and_b32 v2, 15, v1
    v_lshrrev_b32 v3, 4, v1
    v_lshlrev_b32 v4, 4, v3
    v_add_u32 v4, 141312, v4
    v_cmp_eq_u32 vcc, 0, v2
    s_and_saveexec_b64 s[56:57], vcc
    ds_write_b128 v4, v[108:111] offset:576
    ds_write_b128 v4, v[112:115] offset:704
    ds_write_b128 v4, v[116:119] offset:832
    s_mov_b64 exec, s[56:57]
    v_lshlrev_b32 v7, 3, v2
    v_add_u32 v7, 142848, v7
    v_cmp_eq_u32 vcc, 0, v3
    s_and_saveexec_b64 s[56:57], vcc
    ds_write_b32 v7, v240 offset:256
    ds_write_b32 v7, v244 offset:384
    s_mov_b64 exec, s[56:57]
    v_and_b32 v5, 3, v2
    v_lshrrev_b32 v6, 2, v2
    v_cmp_eq_u32 s[62:63], 1, v5
    v_cmp_eq_u32 s[64:65], 2, v5
    v_cmp_eq_u32 s[66:67], 3, v5
    v_cmp_eq_u32 vcc, v6, v3
    s_and_saveexec_b64 s[56:57], vcc
    v_mov_b32 v8, v92
    v_cndmask_b32 v8, v8, v93, s[62:63]
    v_cndmask_b32 v8, v8, v94, s[64:65]
    v_cndmask_b32 v8, v8, v95, s[66:67]
    ds_write_b32 v7, v8 offset:4
    s_nop 0
    v_mov_b32 v8, v96
    v_cndmask_b32 v8, v8, v97, s[62:63]
    v_cndmask_b32 v8, v8, v98, s[64:65]
    v_cndmask_b32 v8, v8, v99, s[66:67]
    ds_write_b32 v7, v8 offset:132
    s_nop 0
    v_mov_b32 v8, v100
    v_cndmask_b32 v8, v8, v101, s[62:63]
    v_cndmask_b32 v8, v8, v102, s[64:65]
    v_cndmask_b32 v8, v8, v103, s[66:67]
    ds_write_b32 v7, v8 offset:260
    s_nop 0
    v_mov_b32 v8, v104
    v_cndmask_b32 v8, v8, v105, s[62:63]
    v_cndmask_b32 v8, v8, v106, s[64:65]
    v_cndmask_b32 v8, v8, v107, s[66:67]
    ds_write_b32 v7, v8 offset:388
    s_nop 0
    s_mov_b64 exec, s[56:57]
    s_waitcnt vmcnt(0) lgkmcnt(0)
    s_barrier
    s_branch K1_EC
K1_EC:
    v_and_b32 v2, 15, v1
    v_lshrrev_b32 v3, 4, v1
    s_cmp_ge_u32 s26, 2
    s_cbranch_scc1 K1_S2_16
    s_lshl_b32 s3, s26, 9
    s_add_u32 s3, s3, 142336
    v_lshlrev_b32 v7, 3, v1
    v_add_u32 v7, s3, v7
    ds_read_b64 v[8:9], v7
    s_waitcnt lgkmcnt(0)
    v_mul_f32 v9, 0x3acccccd, v9
    v_mul_f32 v8, 0x3acccccd, v8
    v_fma_f32 v9, -v8, v8, v9
    v_max_f32 v9, 0, v9
    v_add_f32 v9, 0x3727c5ac, v9
    v_rsq_f32 v10, v9
    s_nop 5
    v_mul_f32 v11, v8, v10
    v_sub_f32 v11, 0, v11
    ds_write_b64 v7, v[10:11]
    s_waitcnt lgkmcnt(0)
K1_S2_16:
    s_barrier
    s_lshr_b32 s58, s26, 1
    s_lshl_b32 s58, s58, 9
    s_add_u32 s58, s58, 142336
    s_and_b32 s57, s26, 1
    s_cmp_eq_u32 s57, 1
    s_cbranch_scc1 K1_EC1
    v_lshlrev_b32 v7, 5, v3
    v_add_u32 v7, s58, v7
    ds_read_b128 v[40:43], v7 offset:0
    ds_read_b128 v[44:47], v7 offset:16
    ds_read_b128 v[48:51], v7 offset:128
    ds_read_b128 v[52:55], v7 offset:144
    ds_read_b128 v[56:59], v7 offset:256
    ds_read_b128 v[60:63], v7 offset:272
    ds_read_b128 v[64:67], v7 offset:384
    ds_read_b128 v[68:71], v7 offset:400
    v_lshlrev_b32 v4, 4, v3
    v_add_u32 v4, 141312, v4
    v_lshlrev_b32 v5, 2, v2
    v_add_u32 v5, 141312, v5
    ds_read_b32 v72, v5 offset:0
    ds_read_b32 v76, v5 offset:64
    ds_read_b32 v80, v5 offset:128
    ds_read_b32 v84, v5 offset:192
    ds_read_b32 v88, v5 offset:256
    ds_read_b32 v92, v5 offset:320
    ds_read_b32 v96, v5 offset:384
    ds_read_b32 v100, v5 offset:448
    s_lshr_b32 s60, s26, 1
    s_mul_i32 s61, s60, 2560
    s_lshl_b32 s62, s60, 12
    v_add_u32 v8, 0, v2
    v_mul_u32_u24 v9, 3277, v8
    v_lshrrev_b32 v9, 16, v9
    v_mul_u32_u24 v10, 20, v9
    v_sub_u32 v10, v8, v10
    v_and_b32 v11, 1, v3
    v_lshl_add_u32 v11, v11, 5, v10
    v_lshlrev_b32 v11, 4, v11
    v_lshrrev_b32 v10, 1, v3
    v_lshl_add_u32 v11, v10, 3, v11
    v_lshl_add_u32 v11, v9, 13, v11
    v_add_u32 v104, s62, v11
    v_add_u32 v8, 16, v2
    v_mul_u32_u24 v9, 3277, v8
    v_lshrrev_b32 v9, 16, v9
    v_mul_u32_u24 v10, 20, v9
    v_sub_u32 v10, v8, v10
    v_and_b32 v11, 1, v3
    v_lshl_add_u32 v11, v11, 5, v10
    v_lshlrev_b32 v11, 4, v11
    v_lshrrev_b32 v10, 1, v3
    v_lshl_add_u32 v11, v10, 3, v11
    v_lshl_add_u32 v11, v9, 13, v11
    v_add_u32 v105, s62, v11
    v_add_u32 v8, 32, v2
    v_mul_u32_u24 v9, 3277, v8
    v_lshrrev_b32 v9, 16, v9
    v_mul_u32_u24 v10, 20, v9
    v_sub_u32 v10, v8, v10
    v_and_b32 v11, 1, v3
    v_lshl_add_u32 v11, v11, 5, v10
    v_lshlrev_b32 v11, 4, v11
    v_lshrrev_b32 v10, 1, v3
    v_lshl_add_u32 v11, v10, 3, v11
    v_lshl_add_u32 v11, v9, 13, v11
    v_add_u32 v106, s62, v11
    v_add_u32 v8, 48, v2
    v_mul_u32_u24 v9, 3277, v8
    v_lshrrev_b32 v9, 16, v9
    v_mul_u32_u24 v10, 20, v9
    v_sub_u32 v10, v8, v10
    v_and_b32 v11, 1, v3
    v_lshl_add_u32 v11, v11, 5, v10
    v_lshlrev_b32 v11, 4, v11
    v_lshrrev_b32 v10, 1, v3
    v_lshl_add_u32 v11, v10, 3, v11
    v_lshl_add_u32 v11, v9, 13, v11
    v_add_u32 v107, s62, v11
    v_add_u32 v8, 64, v2
    v_mul_u32_u24 v9, 3277, v8
    v_lshrrev_b32 v9, 16, v9
    v_mul_u32_u24 v10, 20, v9
    v_sub_u32 v10, v8, v10
    v_and_b32 v11, 1, v3
    v_lshl_add_u32 v11, v11, 5, v10
    v_lshlrev_b32 v11, 4, v11
    v_lshrrev_b32 v10, 1, v3
    v_lshl_add_u32 v11, v10, 3, v11
    v_lshl_add_u32 v11, v9, 13, v11
    v_add_u32 v108, s62, v11
    v_add_u32 v8, 80, v2
    v_mul_u32_u24 v9, 3277, v8
    v_lshrrev_b32 v9, 16, v9
    v_mul_u32_u24 v10, 20, v9
    v_sub_u32 v10, v8, v10
    v_and_b32 v11, 1, v3
    v_lshl_add_u32 v11, v11, 5, v10
    v_lshlrev_b32 v11, 4, v11
    v_lshrrev_b32 v10, 1, v3
    v_lshl_add_u32 v11, v10, 3, v11
    v_lshl_add_u32 v11, v9, 13, v11
    v_add_u32 v109, s62, v11
    v_add_u32 v8, 96, v2
    v_mul_u32_u24 v9, 3277, v8
    v_lshrrev_b32 v9, 16, v9
    v_mul_u32_u24 v10, 20, v9
    v_sub_u32 v10, v8, v10
    v_and_b32 v11, 1, v3
    v_lshl_add_u32 v11, v11, 5, v10
    v_lshlrev_b32 v11, 4, v11
    v_lshrrev_b32 v10, 1, v3
    v_lshl_add_u32 v11, v10, 3, v11
    v_lshl_add_u32 v11, v9, 13, v11
    v_add_u32 v110, s62, v11
    v_add_u32 v8, 112, v2
    v_mul_u32_u24 v9, 3277, v8
    v_lshrrev_b32 v9, 16, v9
    v_mul_u32_u24 v10, 20, v9
    v_sub_u32 v10, v8, v10
    v_and_b32 v11, 1, v3
    v_lshl_add_u32 v11, v11, 5, v10
    v_lshlrev_b32 v11, 4, v11
    v_lshrrev_b32 v10, 1, v3
    v_lshl_add_u32 v11, v10, 3, v11
    v_lshl_add_u32 v11, v9, 13, v11
    v_add_u32 v111, s62, v11
    s_waitcnt lgkmcnt(0)
    v_mul_f32 v8, v41, v72
    v_mul_f32 v9, v43, v72
    v_mul_f32 v10, v45, v72
    v_mul_f32 v11, v47, v72
    v_fma_f32 v8, v128, v40, v8
    v_fma_f32 v9, v129, v42, v9
    v_fma_f32 v10, v130, v44, v10
    v_fma_f32 v11, v131, v46, v11
    v_cvt_pk_bf16_f32 v12, v8, v9
    v_cvt_pk_bf16_f32 v13, v10, v11
    ds_write_b64 v104, v[12:13] offset:0
    v_mul_f32 v16, v49, v72
    v_mul_f32 v17, v51, v72
    v_mul_f32 v18, v53, v72
    v_mul_f32 v19, v55, v72
    v_fma_f32 v16, v132, v48, v16
    v_fma_f32 v17, v133, v50, v17
    v_fma_f32 v18, v134, v52, v18
    v_fma_f32 v19, v135, v54, v19
    v_cvt_pk_bf16_f32 v20, v16, v17
    v_cvt_pk_bf16_f32 v21, v18, v19
    ds_write_b64 v104, v[20:21] offset:1024
    v_mul_f32 v8, v57, v72
    v_mul_f32 v9, v59, v72
    v_mul_f32 v10, v61, v72
    v_mul_f32 v11, v63, v72
    v_fma_f32 v8, v136, v56, v8
    v_fma_f32 v9, v137, v58, v9
    v_fma_f32 v10, v138, v60, v10
    v_fma_f32 v11, v139, v62, v11
    v_cvt_pk_bf16_f32 v12, v8, v9
    v_cvt_pk_bf16_f32 v13, v10, v11
    ds_write_b64 v104, v[12:13] offset:2048
    v_mul_f32 v16, v65, v72
    v_mul_f32 v17, v67, v72
    v_mul_f32 v18, v69, v72
    v_mul_f32 v19, v71, v72
    v_fma_f32 v16, v140, v64, v16
    v_fma_f32 v17, v141, v66, v17
    v_fma_f32 v18, v142, v68, v18
    v_fma_f32 v19, v143, v70, v19
    v_cvt_pk_bf16_f32 v20, v16, v17
    v_cvt_pk_bf16_f32 v21, v18, v19
    ds_write_b64 v104, v[20:21] offset:3072
    v_mul_f32 v8, v41, v76
    v_mul_f32 v9, v43, v76
    v_mul_f32 v10, v45, v76
    v_mul_f32 v11, v47, v76
    v_fma_f32 v8, v144, v40, v8
    v_fma_f32 v9, v145, v42, v9
    v_fma_f32 v10, v146, v44, v10
    v_fma_f32 v11, v147, v46, v11
    v_cvt_pk_bf16_f32 v12, v8, v9
    v_cvt_pk_bf16_f32 v13, v10, v11
    ds_write_b64 v105, v[12:13] offset:0
    v_mul_f32 v16, v49, v76
    v_mul_f32 v17, v51, v76
    v_mul_f32 v18, v53, v76
    v_mul_f32 v19, v55, v76
    v_fma_f32 v16, v148, v48, v16
    v_fma_f32 v17, v149, v50, v17
    v_fma_f32 v18, v150, v52, v18
    v_fma_f32 v19, v151, v54, v19
    v_cvt_pk_bf16_f32 v20, v16, v17
    v_cvt_pk_bf16_f32 v21, v18, v19
    ds_write_b64 v105, v[20:21] offset:1024
    v_mul_f32 v8, v57, v76
    v_mul_f32 v9, v59, v76
    v_mul_f32 v10, v61, v76
    v_mul_f32 v11, v63, v76
    v_fma_f32 v8, v152, v56, v8
    v_fma_f32 v9, v153, v58, v9
    v_fma_f32 v10, v154, v60, v10
    v_fma_f32 v11, v155, v62, v11
    v_cvt_pk_bf16_f32 v12, v8, v9
    v_cvt_pk_bf16_f32 v13, v10, v11
    ds_write_b64 v105, v[12:13] offset:2048
    v_mul_f32 v16, v65, v76
    v_mul_f32 v17, v67, v76
    v_mul_f32 v18, v69, v76
    v_mul_f32 v19, v71, v76
    v_fma_f32 v16, v156, v64, v16
    v_fma_f32 v17, v157, v66, v17
    v_fma_f32 v18, v158, v68, v18
    v_fma_f32 v19, v159, v70, v19
    v_cvt_pk_bf16_f32 v20, v16, v17
    v_cvt_pk_bf16_f32 v21, v18, v19
    ds_write_b64 v105, v[20:21] offset:3072
    v_mul_f32 v8, v41, v80
    v_mul_f32 v9, v43, v80
    v_mul_f32 v10, v45, v80
    v_mul_f32 v11, v47, v80
    v_fma_f32 v8, v160, v40, v8
    v_fma_f32 v9, v161, v42, v9
    v_fma_f32 v10, v162, v44, v10
    v_fma_f32 v11, v163, v46, v11
    v_cvt_pk_bf16_f32 v12, v8, v9
    v_cvt_pk_bf16_f32 v13, v10, v11
    ds_write_b64 v106, v[12:13] offset:0
    v_mul_f32 v16, v49, v80
    v_mul_f32 v17, v51, v80
    v_mul_f32 v18, v53, v80
    v_mul_f32 v19, v55, v80
    v_fma_f32 v16, v164, v48, v16
    v_fma_f32 v17, v165, v50, v17
    v_fma_f32 v18, v166, v52, v18
    v_fma_f32 v19, v167, v54, v19
    v_cvt_pk_bf16_f32 v20, v16, v17
    v_cvt_pk_bf16_f32 v21, v18, v19
    ds_write_b64 v106, v[20:21] offset:1024
    v_mul_f32 v8, v57, v80
    v_mul_f32 v9, v59, v80
    v_mul_f32 v10, v61, v80
    v_mul_f32 v11, v63, v80
    v_fma_f32 v8, v168, v56, v8
    v_fma_f32 v9, v169, v58, v9
    v_fma_f32 v10, v170, v60, v10
    v_fma_f32 v11, v171, v62, v11
    v_cvt_pk_bf16_f32 v12, v8, v9
    v_cvt_pk_bf16_f32 v13, v10, v11
    ds_write_b64 v106, v[12:13] offset:2048
    v_mul_f32 v16, v65, v80
    v_mul_f32 v17, v67, v80
    v_mul_f32 v18, v69, v80
    v_mul_f32 v19, v71, v80
    v_fma_f32 v16, v172, v64, v16
    v_fma_f32 v17, v173, v66, v17
    v_fma_f32 v18, v174, v68, v18
    v_fma_f32 v19, v175, v70, v19
    v_cvt_pk_bf16_f32 v20, v16, v17
    v_cvt_pk_bf16_f32 v21, v18, v19
    ds_write_b64 v106, v[20:21] offset:3072
    v_mul_f32 v8, v41, v84
    v_mul_f32 v9, v43, v84
    v_mul_f32 v10, v45, v84
    v_mul_f32 v11, v47, v84
    v_fma_f32 v8, v176, v40, v8
    v_fma_f32 v9, v177, v42, v9
    v_fma_f32 v10, v178, v44, v10
    v_fma_f32 v11, v179, v46, v11
    v_cvt_pk_bf16_f32 v12, v8, v9
    v_cvt_pk_bf16_f32 v13, v10, v11
    ds_write_b64 v107, v[12:13] offset:0
    v_mul_f32 v16, v49, v84
    v_mul_f32 v17, v51, v84
    v_mul_f32 v18, v53, v84
    v_mul_f32 v19, v55, v84
    v_fma_f32 v16, v180, v48, v16
    v_fma_f32 v17, v181, v50, v17
    v_fma_f32 v18, v182, v52, v18
    v_fma_f32 v19, v183, v54, v19
    v_cvt_pk_bf16_f32 v20, v16, v17
    v_cvt_pk_bf16_f32 v21, v18, v19
    ds_write_b64 v107, v[20:21] offset:1024
    v_mul_f32 v8, v57, v84
    v_mul_f32 v9, v59, v84
    v_mul_f32 v10, v61, v84
    v_mul_f32 v11, v63, v84
    v_fma_f32 v8, v184, v56, v8
    v_fma_f32 v9, v185, v58, v9
    v_fma_f32 v10, v186, v60, v10
    v_fma_f32 v11, v187, v62, v11
    v_cvt_pk_bf16_f32 v12, v8, v9
    v_cvt_pk_bf16_f32 v13, v10, v11
    ds_write_b64 v107, v[12:13] offset:2048
    v_mul_f32 v16, v65, v84
    v_mul_f32 v17, v67, v84
    v_mul_f32 v18, v69, v84
    v_mul_f32 v19, v71, v84
    v_fma_f32 v16, v188, v64, v16
    v_fma_f32 v17, v189, v66, v17
    v_fma_f32 v18, v190, v68, v18
    v_fma_f32 v19, v191, v70, v19
    v_cvt_pk_bf16_f32 v20, v16, v17
    v_cvt_pk_bf16_f32 v21, v18, v19
    ds_write_b64 v107, v[20:21] offset:3072
    v_mul_f32 v8, v41, v88
    v_mul_f32 v9, v43, v88
    v_mul_f32 v10, v45, v88
    v_mul_f32 v11, v47, v88
    v_fma_f32 v8, v192, v40, v8
    v_fma_f32 v9, v193, v42, v9
    v_fma_f32 v10, v194, v44, v10
    v_fma_f32 v11, v195, v46, v11
    v_cvt_pk_bf16_f32 v12, v8, v9
    v_cvt_pk_bf16_f32 v13, v10, v11
    ds_write_b64 v108, v[12:13] offset:0
    v_mul_f32 v16, v49, v88
    v_mul_f32 v17, v51, v88
    v_mul_f32 v18, v53, v88
    v_mul_f32 v19, v55, v88
    v_fma_f32 v16, v196, v48, v16
    v_fma_f32 v17, v197, v50, v17
    v_fma_f32 v18, v198, v52, v18
    v_fma_f32 v19, v199, v54, v19
    v_cvt_pk_bf16_f32 v20, v16, v17
    v_cvt_pk_bf16_f32 v21, v18, v19
    ds_write_b64 v108, v[20:21] offset:1024
    v_mul_f32 v8, v57, v88
    v_mul_f32 v9, v59, v88
    v_mul_f32 v10, v61, v88
    v_mul_f32 v11, v63, v88
    v_fma_f32 v8, v200, v56, v8
    v_fma_f32 v9, v201, v58, v9
    v_fma_f32 v10, v202, v60, v10
    v_fma_f32 v11, v203, v62, v11
    v_cvt_pk_bf16_f32 v12, v8, v9
    v_cvt_pk_bf16_f32 v13, v10, v11
    ds_write_b64 v108, v[12:13] offset:2048
    v_mul_f32 v16, v65, v88
    v_mul_f32 v17, v67, v88
    v_mul_f32 v18, v69, v88
    v_mul_f32 v19, v71, v88
    v_fma_f32 v16, v204, v64, v16
    v_fma_f32 v17, v205, v66, v17
    v_fma_f32 v18, v206, v68, v18
    v_fma_f32 v19, v207, v70, v19
    v_cvt_pk_bf16_f32 v20, v16, v17
    v_cvt_pk_bf16_f32 v21, v18, v19
    ds_write_b64 v108, v[20:21] offset:3072
    v_mul_f32 v8, v41, v92
    v_mul_f32 v9, v43, v92
    v_mul_f32 v10, v45, v92
    v_mul_f32 v11, v47, v92
    v_fma_f32 v8, v208, v40, v8
    v_fma_f32 v9, v209, v42, v9
    v_fma_f32 v10, v210, v44, v10
    v_fma_f32 v11, v211, v46, v11
    v_cvt_pk_bf16_f32 v12, v8, v9
    v_cvt_pk_bf16_f32 v13, v10, v11
    ds_write_b64 v109, v[12:13] offset:0
    v_mul_f32 v16, v49, v92
    v_mul_f32 v17, v51, v92
    v_mul_f32 v18, v53, v92
    v_mul_f32 v19, v55, v92
    v_fma_f32 v16, v212, v48, v16
    v_fma_f32 v17, v213, v50, v17
    v_fma_f32 v18, v214, v52, v18
    v_fma_f32 v19, v215, v54, v19
    v_cvt_pk_bf16_f32 v20, v16, v17
    v_cvt_pk_bf16_f32 v21, v18, v19
    ds_write_b64 v109, v[20:21] offset:1024
    v_mul_f32 v8, v57, v92
    v_mul_f32 v9, v59, v92
    v_mul_f32 v10, v61, v92
    v_mul_f32 v11, v63, v92
    v_fma_f32 v8, v216, v56, v8
    v_fma_f32 v9, v217, v58, v9
    v_fma_f32 v10, v218, v60, v10
    v_fma_f32 v11, v219, v62, v11
    v_cvt_pk_bf16_f32 v12, v8, v9
    v_cvt_pk_bf16_f32 v13, v10, v11
    ds_write_b64 v109, v[12:13] offset:2048
    v_mul_f32 v16, v65, v92
    v_mul_f32 v17, v67, v92
    v_mul_f32 v18, v69, v92
    v_mul_f32 v19, v71, v92
    v_fma_f32 v16, v220, v64, v16
    v_fma_f32 v17, v221, v66, v17
    v_fma_f32 v18, v222, v68, v18
    v_fma_f32 v19, v223, v70, v19
    v_cvt_pk_bf16_f32 v20, v16, v17
    v_cvt_pk_bf16_f32 v21, v18, v19
    ds_write_b64 v109, v[20:21] offset:3072
    v_mul_f32 v8, v41, v96
    v_mul_f32 v9, v43, v96
    v_mul_f32 v10, v45, v96
    v_mul_f32 v11, v47, v96
    v_fma_f32 v8, v224, v40, v8
    v_fma_f32 v9, v225, v42, v9
    v_fma_f32 v10, v226, v44, v10
    v_fma_f32 v11, v227, v46, v11
    v_cvt_pk_bf16_f32 v12, v8, v9
    v_cvt_pk_bf16_f32 v13, v10, v11
    ds_write_b64 v110, v[12:13] offset:0
    v_mul_f32 v16, v49, v96
    v_mul_f32 v17, v51, v96
    v_mul_f32 v18, v53, v96
    v_mul_f32 v19, v55, v96
    v_fma_f32 v16, v228, v48, v16
    v_fma_f32 v17, v229, v50, v17
    v_fma_f32 v18, v230, v52, v18
    v_fma_f32 v19, v231, v54, v19
    v_cvt_pk_bf16_f32 v20, v16, v17
    v_cvt_pk_bf16_f32 v21, v18, v19
    ds_write_b64 v110, v[20:21] offset:1024
    v_mul_f32 v8, v57, v96
    v_mul_f32 v9, v59, v96
    v_mul_f32 v10, v61, v96
    v_mul_f32 v11, v63, v96
    v_fma_f32 v8, v232, v56, v8
    v_fma_f32 v9, v233, v58, v9
    v_fma_f32 v10, v234, v60, v10
    v_fma_f32 v11, v235, v62, v11
    v_cvt_pk_bf16_f32 v12, v8, v9
    v_cvt_pk_bf16_f32 v13, v10, v11
    ds_write_b64 v110, v[12:13] offset:2048
    v_mul_f32 v16, v65, v96
    v_mul_f32 v17, v67, v96
    v_mul_f32 v18, v69, v96
    v_mul_f32 v19, v71, v96
    v_fma_f32 v16, v236, v64, v16
    v_fma_f32 v17, v237, v66, v17
    v_fma_f32 v18, v238, v68, v18
    v_fma_f32 v19, v239, v70, v19
    v_cvt_pk_bf16_f32 v20, v16, v17
    v_cvt_pk_bf16_f32 v21, v18, v19
    ds_write_b64 v110, v[20:21] offset:3072
    v_mul_f32 v8, v41, v100
    v_mul_f32 v9, v43, v100
    v_mul_f32 v10, v45, v100
    v_mul_f32 v11, v47, v100
    v_fma_f32 v8, v240, v40, v8
    v_fma_f32 v9, v241, v42, v9
    v_fma_f32 v10, v242, v44, v10
    v_fma_f32 v11, v243, v46, v11
    v_cvt_pk_bf16_f32 v12, v8, v9
    v_cvt_pk_bf16_f32 v13, v10, v11
    ds_write_b64 v111, v[12:13] offset:0
    v_mul_f32 v16, v49, v100
    v_mul_f32 v17, v51, v100
    v_mul_f32 v18, v53, v100
    v_mul_f32 v19, v55, v100
    v_fma_f32 v16, v244, v48, v16
    v_fma_f32 v17, v245, v50, v17
    v_fma_f32 v18, v246, v52, v18
    v_fma_f32 v19, v247, v54, v19
    v_cvt_pk_bf16_f32 v20, v16, v17
    v_cvt_pk_bf16_f32 v21, v18, v19
    ds_write_b64 v111, v[20:21] offset:1024
    v_mul_f32 v8, v57, v100
    v_mul_f32 v9, v59, v100
    v_mul_f32 v10, v61, v100
    v_mul_f32 v11, v63, v100
    v_fma_f32 v8, v248, v56, v8
    v_fma_f32 v9, v249, v58, v9
    v_fma_f32 v10, v250, v60, v10
    v_fma_f32 v11, v251, v62, v11
    v_cvt_pk_bf16_f32 v12, v8, v9
    v_cvt_pk_bf16_f32 v13, v10, v11
    ds_write_b64 v111, v[12:13] offset:2048
    v_mul_f32 v16, v65, v100
    v_mul_f32 v17, v67, v100
    v_mul_f32 v18, v69, v100
    v_mul_f32 v19, v71, v100
    v_fma_f32 v16, v252, v64, v16
    v_fma_f32 v17, v253, v66, v17
    v_fma_f32 v18, v254, v68, v18
    v_fma_f32 v19, v255, v70, v19
    v_cvt_pk_bf16_f32 v20, v16, v17
    v_cvt_pk_bf16_f32 v21, v18, v19
    ds_write_b64 v111, v[20:21] offset:3072
    s_branch K1_FC
K1_EC1:
    v_lshlrev_b32 v7, 5, v3
    v_add_u32 v7, s58, v7
    ds_read_b128 v[40:43], v7 offset:0
    ds_read_b128 v[44:47], v7 offset:16
    ds_read_b128 v[48:51], v7 offset:128
    ds_read_b128 v[52:55], v7 offset:144
    ds_read_b128 v[56:59], v7 offset:256
    ds_read_b128 v[60:63], v7 offset:272
    ds_read_b128 v[64:67], v7 offset:384
    ds_read_b128 v[68:71], v7 offset:400
    v_lshlrev_b32 v4, 4, v3
    v_add_u32 v4, 141312, v4
    v_lshlrev_b32 v5, 2, v2
    v_add_u32 v5, 141312, v5
    ds_read_b32 v72, v5 offset:512
    ds_read_b32 v76, v5 offset:576
    ds_read_b32 v80, v5 offset:640
    ds_read_b32 v84, v5 offset:704
    ds_read_b32 v88, v5 offset:768
    ds_read_b32 v92, v5 offset:832
    ds_read_b32 v96, v5 offset:896
    s_lshr_b32 s60, s26, 1
    s_mul_i32 s61, s60, 2560
    s_lshl_b32 s62, s60, 12
    v_add_u32 v8, 128, v2
    v_mul_u32_u24 v9, 3277, v8
    v_lshrrev_b32 v9, 16, v9
    v_mul_u32_u24 v10, 20, v9
    v_sub_u32 v10, v8, v10
    v_and_b32 v11, 1, v3
    v_lshl_add_u32 v11, v11, 5, v10
    v_lshlrev_b32 v11, 4, v11
    v_lshrrev_b32 v10, 1, v3
    v_lshl_add_u32 v11, v10, 3, v11
    v_lshl_add_u32 v11, v9, 13, v11
    v_add_u32 v104, s62, v11
    v_add_u32 v8, 144, v2
    v_mul_u32_u24 v9, 3277, v8
    v_lshrrev_b32 v9, 16, v9
    v_mul_u32_u24 v10, 20, v9
    v_sub_u32 v10, v8, v10
    v_and_b32 v11, 1, v3
    v_lshl_add_u32 v11, v11, 5, v10
    v_lshlrev_b32 v11, 4, v11
    v_lshrrev_b32 v10, 1, v3
    v_lshl_add_u32 v11, v10, 3, v11
    v_lshl_add_u32 v11, v9, 13, v11
    v_add_u32 v105, s62, v11
    v_add_u32 v8, 160, v2
    v_mul_u32_u24 v9, 3277, v8
    v_lshrrev_b32 v9, 16, v9
    v_mul_u32_u24 v10, 20, v9
    v_sub_u32 v10, v8, v10
    v_and_b32 v11, 1, v3
    v_lshl_add_u32 v11, v11, 5, v10
    v_lshlrev_b32 v11, 4, v11
    v_lshrrev_b32 v10, 1, v3
    v_lshl_add_u32 v11, v10, 3, v11
    v_lshl_add_u32 v11, v9, 13, v11
    v_add_u32 v106, s62, v11
    v_add_u32 v8, 176, v2
    v_mul_u32_u24 v9, 3277, v8
    v_lshrrev_b32 v9, 16, v9
    v_mul_u32_u24 v10, 20, v9
    v_sub_u32 v10, v8, v10
    v_and_b32 v11, 1, v3
    v_lshl_add_u32 v11, v11, 5, v10
    v_lshlrev_b32 v11, 4, v11
    v_lshrrev_b32 v10, 1, v3
    v_lshl_add_u32 v11, v10, 3, v11
    v_lshl_add_u32 v11, v9, 13, v11
    v_add_u32 v107, s62, v11
    v_add_u32 v8, 192, v2
    v_mul_u32_u24 v9, 3277, v8
    v_lshrrev_b32 v9, 16, v9
    v_mul_u32_u24 v10, 20, v9
    v_sub_u32 v10, v8, v10
    v_and_b32 v11, 1, v3
    v_lshl_add_u32 v11, v11, 5, v10
    v_lshlrev_b32 v11, 4, v11
    v_lshrrev_b32 v10, 1, v3
    v_lshl_add_u32 v11, v10, 3, v11
    v_lshl_add_u32 v11, v9, 13, v11
    v_add_u32 v108, s62, v11
    v_add_u32 v8, 208, v2
    v_mul_u32_u24 v9, 3277, v8
    v_lshrrev_b32 v9, 16, v9
    v_mul_u32_u24 v10, 20, v9
    v_sub_u32 v10, v8, v10
    v_and_b32 v11, 1, v3
    v_lshl_add_u32 v11, v11, 5, v10
    v_lshlrev_b32 v11, 4, v11
    v_lshrrev_b32 v10, 1, v3
    v_lshl_add_u32 v11, v10, 3, v11
    v_lshl_add_u32 v11, v9, 13, v11
    v_add_u32 v109, s62, v11
    v_add_u32 v8, 224, v2
    v_mul_u32_u24 v9, 3277, v8
    v_lshrrev_b32 v9, 16, v9
    v_mul_u32_u24 v10, 20, v9
    v_sub_u32 v10, v8, v10
    v_and_b32 v11, 1, v3
    v_lshl_add_u32 v11, v11, 5, v10
    v_lshlrev_b32 v11, 4, v11
    v_lshrrev_b32 v10, 1, v3
    v_lshl_add_u32 v11, v10, 3, v11
    v_lshl_add_u32 v11, v9, 13, v11
    v_add_u32 v110, s62, v11
    s_waitcnt lgkmcnt(0)
    v_mul_f32 v8, v41, v72
    v_mul_f32 v9, v43, v72
    v_mul_f32 v10, v45, v72
    v_mul_f32 v11, v47, v72
    v_fma_f32 v8, v128, v40, v8
    v_fma_f32 v9, v129, v42, v9
    v_fma_f32 v10, v130, v44, v10
    v_fma_f32 v11, v131, v46, v11
    v_cvt_pk_bf16_f32 v12, v8, v9
    v_cvt_pk_bf16_f32 v13, v10, v11
    ds_write_b64 v104, v[12:13] offset:0
    v_mul_f32 v16, v49, v72
    v_mul_f32 v17, v51, v72
    v_mul_f32 v18, v53, v72
    v_mul_f32 v19, v55, v72
    v_fma_f32 v16, v132, v48, v16
    v_fma_f32 v17, v133, v50, v17
    v_fma_f32 v18, v134, v52, v18
    v_fma_f32 v19, v135, v54, v19
    v_cvt_pk_bf16_f32 v20, v16, v17
    v_cvt_pk_bf16_f32 v21, v18, v19
    ds_write_b64 v104, v[20:21] offset:1024
    v_mul_f32 v8, v57, v72
    v_mul_f32 v9, v59, v72
    v_mul_f32 v10, v61, v72
    v_mul_f32 v11, v63, v72
    v_fma_f32 v8, v136, v56, v8
    v_fma_f32 v9, v137, v58, v9
    v_fma_f32 v10, v138, v60, v10
    v_fma_f32 v11, v139, v62, v11
    v_cvt_pk_bf16_f32 v12, v8, v9
    v_cvt_pk_bf16_f32 v13, v10, v11
    ds_write_b64 v104, v[12:13] offset:2048
    v_mul_f32 v16, v65, v72
    v_mul_f32 v17, v67, v72
    v_mul_f32 v18, v69, v72
    v_mul_f32 v19, v71, v72
    v_fma_f32 v16, v140, v64, v16
    v_fma_f32 v17, v141, v66, v17
    v_fma_f32 v18, v142, v68, v18
    v_fma_f32 v19, v143, v70, v19
    v_cvt_pk_bf16_f32 v20, v16, v17
    v_cvt_pk_bf16_f32 v21, v18, v19
    ds_write_b64 v104, v[20:21] offset:3072
    v_mul_f32 v8, v41, v76
    v_mul_f32 v9, v43, v76
    v_mul_f32 v10, v45, v76
    v_mul_f32 v11, v47, v76
    v_fma_f32 v8, v144, v40, v8
    v_fma_f32 v9, v145, v42, v9
    v_fma_f32 v10, v146, v44, v10
    v_fma_f32 v11, v147, v46, v11
    v_cvt_pk_bf16_f32 v12, v8, v9
    v_cvt_pk_bf16_f32 v13, v10, v11
    ds_write_b64 v105, v[12:13] offset:0
    v_mul_f32 v16, v49, v76
    v_mul_f32 v17, v51, v76
    v_mul_f32 v18, v53, v76
    v_mul_f32 v19, v55, v76
    v_fma_f32 v16, v148, v48, v16
    v_fma_f32 v17, v149, v50, v17
    v_fma_f32 v18, v150, v52, v18
    v_fma_f32 v19, v151, v54, v19
    v_cvt_pk_bf16_f32 v20, v16, v17
    v_cvt_pk_bf16_f32 v21, v18, v19
    ds_write_b64 v105, v[20:21] offset:1024
    v_mul_f32 v8, v57, v76
    v_mul_f32 v9, v59, v76
    v_mul_f32 v10, v61, v76
    v_mul_f32 v11, v63, v76
    v_fma_f32 v8, v152, v56, v8
    v_fma_f32 v9, v153, v58, v9
    v_fma_f32 v10, v154, v60, v10
    v_fma_f32 v11, v155, v62, v11
    v_cvt_pk_bf16_f32 v12, v8, v9
    v_cvt_pk_bf16_f32 v13, v10, v11
    ds_write_b64 v105, v[12:13] offset:2048
    v_mul_f32 v16, v65, v76
    v_mul_f32 v17, v67, v76
    v_mul_f32 v18, v69, v76
    v_mul_f32 v19, v71, v76
    v_fma_f32 v16, v156, v64, v16
    v_fma_f32 v17, v157, v66, v17
    v_fma_f32 v18, v158, v68, v18
    v_fma_f32 v19, v159, v70, v19
    v_cvt_pk_bf16_f32 v20, v16, v17
    v_cvt_pk_bf16_f32 v21, v18, v19
    ds_write_b64 v105, v[20:21] offset:3072
    v_mul_f32 v8, v41, v80
    v_mul_f32 v9, v43, v80
    v_mul_f32 v10, v45, v80
    v_mul_f32 v11, v47, v80
    v_fma_f32 v8, v160, v40, v8
    v_fma_f32 v9, v161, v42, v9
    v_fma_f32 v10, v162, v44, v10
    v_fma_f32 v11, v163, v46, v11
    v_cvt_pk_bf16_f32 v12, v8, v9
    v_cvt_pk_bf16_f32 v13, v10, v11
    ds_write_b64 v106, v[12:13] offset:0
    v_mul_f32 v16, v49, v80
    v_mul_f32 v17, v51, v80
    v_mul_f32 v18, v53, v80
    v_mul_f32 v19, v55, v80
    v_fma_f32 v16, v164, v48, v16
    v_fma_f32 v17, v165, v50, v17
    v_fma_f32 v18, v166, v52, v18
    v_fma_f32 v19, v167, v54, v19
    v_cvt_pk_bf16_f32 v20, v16, v17
    v_cvt_pk_bf16_f32 v21, v18, v19
    ds_write_b64 v106, v[20:21] offset:1024
    v_mul_f32 v8, v57, v80
    v_mul_f32 v9, v59, v80
    v_mul_f32 v10, v61, v80
    v_mul_f32 v11, v63, v80
    v_fma_f32 v8, v168, v56, v8
    v_fma_f32 v9, v169, v58, v9
    v_fma_f32 v10, v170, v60, v10
    v_fma_f32 v11, v171, v62, v11
    v_cvt_pk_bf16_f32 v12, v8, v9
    v_cvt_pk_bf16_f32 v13, v10, v11
    ds_write_b64 v106, v[12:13] offset:2048
    v_mul_f32 v16, v65, v80
    v_mul_f32 v17, v67, v80
    v_mul_f32 v18, v69, v80
    v_mul_f32 v19, v71, v80
    v_fma_f32 v16, v172, v64, v16
    v_fma_f32 v17, v173, v66, v17
    v_fma_f32 v18, v174, v68, v18
    v_fma_f32 v19, v175, v70, v19
    v_cvt_pk_bf16_f32 v20, v16, v17
    v_cvt_pk_bf16_f32 v21, v18, v19
    ds_write_b64 v106, v[20:21] offset:3072
    v_mul_f32 v8, v41, v84
    v_mul_f32 v9, v43, v84
    v_mul_f32 v10, v45, v84
    v_mul_f32 v11, v47, v84
    v_fma_f32 v8, v176, v40, v8
    v_fma_f32 v9, v177, v42, v9
    v_fma_f32 v10, v178, v44, v10
    v_fma_f32 v11, v179, v46, v11
    v_cvt_pk_bf16_f32 v12, v8, v9
    v_cvt_pk_bf16_f32 v13, v10, v11
    ds_write_b64 v107, v[12:13] offset:0
    v_mul_f32 v16, v49, v84
    v_mul_f32 v17, v51, v84
    v_mul_f32 v18, v53, v84
    v_mul_f32 v19, v55, v84
    v_fma_f32 v16, v180, v48, v16
    v_fma_f32 v17, v181, v50, v17
    v_fma_f32 v18, v182, v52, v18
    v_fma_f32 v19, v183, v54, v19
    v_cvt_pk_bf16_f32 v20, v16, v17
    v_cvt_pk_bf16_f32 v21, v18, v19
    ds_write_b64 v107, v[20:21] offset:1024
    v_mul_f32 v8, v57, v84
    v_mul_f32 v9, v59, v84
    v_mul_f32 v10, v61, v84
    v_mul_f32 v11, v63, v84
    v_fma_f32 v8, v184, v56, v8
    v_fma_f32 v9, v185, v58, v9
    v_fma_f32 v10, v186, v60, v10
    v_fma_f32 v11, v187, v62, v11
    v_cvt_pk_bf16_f32 v12, v8, v9
    v_cvt_pk_bf16_f32 v13, v10, v11
    ds_write_b64 v107, v[12:13] offset:2048
    v_mul_f32 v16, v65, v84
    v_mul_f32 v17, v67, v84
    v_mul_f32 v18, v69, v84
    v_mul_f32 v19, v71, v84
    v_fma_f32 v16, v188, v64, v16
    v_fma_f32 v17, v189, v66, v17
    v_fma_f32 v18, v190, v68, v18
    v_fma_f32 v19, v191, v70, v19
    v_cvt_pk_bf16_f32 v20, v16, v17
    v_cvt_pk_bf16_f32 v21, v18, v19
    ds_write_b64 v107, v[20:21] offset:3072
    v_mul_f32 v8, v41, v88
    v_mul_f32 v9, v43, v88
    v_mul_f32 v10, v45, v88
    v_mul_f32 v11, v47, v88
    v_fma_f32 v8, v192, v40, v8
    v_fma_f32 v9, v193, v42, v9
    v_fma_f32 v10, v194, v44, v10
    v_fma_f32 v11, v195, v46, v11
    v_cvt_pk_bf16_f32 v12, v8, v9
    v_cvt_pk_bf16_f32 v13, v10, v11
    ds_write_b64 v108, v[12:13] offset:0
    v_mul_f32 v16, v49, v88
    v_mul_f32 v17, v51, v88
    v_mul_f32 v18, v53, v88
    v_mul_f32 v19, v55, v88
    v_fma_f32 v16, v196, v48, v16
    v_fma_f32 v17, v197, v50, v17
    v_fma_f32 v18, v198, v52, v18
    v_fma_f32 v19, v199, v54, v19
    v_cvt_pk_bf16_f32 v20, v16, v17
    v_cvt_pk_bf16_f32 v21, v18, v19
    ds_write_b64 v108, v[20:21] offset:1024
    v_mul_f32 v8, v57, v88
    v_mul_f32 v9, v59, v88
    v_mul_f32 v10, v61, v88
    v_mul_f32 v11, v63, v88
    v_fma_f32 v8, v200, v56, v8
    v_fma_f32 v9, v201, v58, v9
    v_fma_f32 v10, v202, v60, v10
    v_fma_f32 v11, v203, v62, v11
    v_cvt_pk_bf16_f32 v12, v8, v9
    v_cvt_pk_bf16_f32 v13, v10, v11
    ds_write_b64 v108, v[12:13] offset:2048
    v_mul_f32 v16, v65, v88
    v_mul_f32 v17, v67, v88
    v_mul_f32 v18, v69, v88
    v_mul_f32 v19, v71, v88
    v_fma_f32 v16, v204, v64, v16
    v_fma_f32 v17, v205, v66, v17
    v_fma_f32 v18, v206, v68, v18
    v_fma_f32 v19, v207, v70, v19
    v_cvt_pk_bf16_f32 v20, v16, v17
    v_cvt_pk_bf16_f32 v21, v18, v19
    ds_write_b64 v108, v[20:21] offset:3072
    v_mul_f32 v8, v41, v92
    v_mul_f32 v9, v43, v92
    v_mul_f32 v10, v45, v92
    v_mul_f32 v11, v47, v92
    v_fma_f32 v8, v208, v40, v8
    v_fma_f32 v9, v209, v42, v9
    v_fma_f32 v10, v210, v44, v10
    v_fma_f32 v11, v211, v46, v11
    v_cvt_pk_bf16_f32 v12, v8, v9
    v_cvt_pk_bf16_f32 v13, v10, v11
    ds_write_b64 v109, v[12:13] offset:0
    v_mul_f32 v16, v49, v92
    v_mul_f32 v17, v51, v92
    v_mul_f32 v18, v53, v92
    v_mul_f32 v19, v55, v92
    v_fma_f32 v16, v212, v48, v16
    v_fma_f32 v17, v213, v50, v17
    v_fma_f32 v18, v214, v52, v18
    v_fma_f32 v19, v215, v54, v19
    v_cvt_pk_bf16_f32 v20, v16, v17
    v_cvt_pk_bf16_f32 v21, v18, v19
    ds_write_b64 v109, v[20:21] offset:1024
    v_mul_f32 v8, v57, v92
    v_mul_f32 v9, v59, v92
    v_mul_f32 v10, v61, v92
    v_mul_f32 v11, v63, v92
    v_fma_f32 v8, v216, v56, v8
    v_fma_f32 v9, v217, v58, v9
    v_fma_f32 v10, v218, v60, v10
    v_fma_f32 v11, v219, v62, v11
    v_cvt_pk_bf16_f32 v12, v8, v9
    v_cvt_pk_bf16_f32 v13, v10, v11
    ds_write_b64 v109, v[12:13] offset:2048
    v_mul_f32 v16, v65, v92
    v_mul_f32 v17, v67, v92
    v_mul_f32 v18, v69, v92
    v_mul_f32 v19, v71, v92
    v_fma_f32 v16, v220, v64, v16
    v_fma_f32 v17, v221, v66, v17
    v_fma_f32 v18, v222, v68, v18
    v_fma_f32 v19, v223, v70, v19
    v_cvt_pk_bf16_f32 v20, v16, v17
    v_cvt_pk_bf16_f32 v21, v18, v19
    ds_write_b64 v109, v[20:21] offset:3072
    v_mul_f32 v8, v41, v96
    v_mul_f32 v9, v43, v96
    v_mul_f32 v10, v45, v96
    v_mul_f32 v11, v47, v96
    v_fma_f32 v8, v224, v40, v8
    v_fma_f32 v9, v225, v42, v9
    v_fma_f32 v10, v226, v44, v10
    v_fma_f32 v11, v227, v46, v11
    v_cvt_pk_bf16_f32 v12, v8, v9
    v_cvt_pk_bf16_f32 v13, v10, v11
    ds_write_b64 v110, v[12:13] offset:0
    v_mul_f32 v16, v49, v96
    v_mul_f32 v17, v51, v96
    v_mul_f32 v18, v53, v96
    v_mul_f32 v19, v55, v96
    v_fma_f32 v16, v228, v48, v16
    v_fma_f32 v17, v229, v50, v17
    v_fma_f32 v18, v230, v52, v18
    v_fma_f32 v19, v231, v54, v19
    v_cvt_pk_bf16_f32 v20, v16, v17
    v_cvt_pk_bf16_f32 v21, v18, v19
    ds_write_b64 v110, v[20:21] offset:1024
    v_mul_f32 v8, v57, v96
    v_mul_f32 v9, v59, v96
    v_mul_f32 v10, v61, v96
    v_mul_f32 v11, v63, v96
    v_fma_f32 v8, v232, v56, v8
    v_fma_f32 v9, v233, v58, v9
    v_fma_f32 v10, v234, v60, v10
    v_fma_f32 v11, v235, v62, v11
    v_cvt_pk_bf16_f32 v12, v8, v9
    v_cvt_pk_bf16_f32 v13, v10, v11
    ds_write_b64 v110, v[12:13] offset:2048
    v_mul_f32 v16, v65, v96
    v_mul_f32 v17, v67, v96
    v_mul_f32 v18, v69, v96
    v_mul_f32 v19, v71, v96
    v_fma_f32 v16, v236, v64, v16
    v_fma_f32 v17, v237, v66, v17
    v_fma_f32 v18, v238, v68, v18
    v_fma_f32 v19, v239, v70, v19
    v_cvt_pk_bf16_f32 v20, v16, v17
    v_cvt_pk_bf16_f32 v21, v18, v19
    ds_write_b64 v110, v[20:21] offset:3072
K1_FC:
    v_lshrrev_b32 v6, 1, v1
    v_lshlrev_b32 v6, 10, v6
    v_and_b32 v7, 1, v1
    v_lshl_add_u32 v6, v7, 9, v6
    s_lshl_b32 s3, s26, 13
    s_add_u32 s3, s3, 320
    v_add_u32 v6, s3, v6
    v_add_u32 v7, 0x10000, v6
    v_mov_b32 v8, 0x3f803f80
    v_mov_b32 v9, 0x3f803f80
    v_mov_b32 v10, 0x3f803f80
    v_mov_b32 v11, 0x3f803f80
    v_cmp_gt_u32 vcc, 16, v1
    s_and_saveexec_b64 s[56:57], vcc
    ds_write_b128 v6, v[8:11] offset:0
    ds_write_b128 v6, v[8:11] offset:32768
    ds_write_b128 v7, v[8:11] offset:0
    s_mov_b64 exec, s[56:57]
    s_waitcnt lgkmcnt(0)
    s_barrier
    v_lshlrev_b32 v6, 4, v1
    s_lshl_b32 s3, s26, 13
    v_add_u32 v7, s3, v6
    v_add_u32 v5, 0x1000, v6
    v_add_u32 v4, 0x10000, v7
    s_mul_i32 s60, s37, 12
    s_add_u32 s60, s60, s26
    s_add_u32 s61, s60, 0
    s_sub_u32 s61, s61, 64
    s_lshl_b32 s61, s61, 17
    s_lshl_b32 s62, s36, 13
    s_add_u32 s61, s61, s62
    s_add_u32 s61, s61, 0x800000
    v_and_b32 v8, 31, v1
    v_cmp_gt_u32 vcc, 21, v8
    s_mov_b64 exec, vcc
    ds_read_b128 v[32:35], v7 offset:0
    ds_read_b128 v[36:39], v7 offset:1024
    ds_read_b128 v[40:43], v7 offset:2048
    ds_read_b128 v[44:47], v7 offset:3072
    ds_read_b128 v[48:51], v7 offset:4096
    ds_read_b128 v[52:55], v7 offset:5120
    ds_read_b128 v[56:59], v7 offset:6144
    ds_read_b128 v[60:63], v7 offset:7168
    s_waitcnt lgkmcnt(7)
    buffer_store_dwordx4 v[32:35], v6, s[48:51], s61 offen offset:0 sc1
    s_waitcnt lgkmcnt(6)
    buffer_store_dwordx4 v[36:39], v6, s[48:51], s61 offen offset:1024 sc1
    s_waitcnt lgkmcnt(5)
    buffer_store_dwordx4 v[40:43], v6, s[48:51], s61 offen offset:2048 sc1
    s_waitcnt lgkmcnt(4)
    buffer_store_dwordx4 v[44:47], v6, s[48:51], s61 offen offset:3072 sc1
    s_waitcnt lgkmcnt(3)
    buffer_store_dwordx4 v[48:51], v5, s[48:51], s61 offen offset:0 sc1
    s_waitcnt lgkmcnt(2)
    buffer_store_dwordx4 v[52:55], v5, s[48:51], s61 offen offset:1024 sc1
    s_waitcnt lgkmcnt(1)
    buffer_store_dwordx4 v[56:59], v5, s[48:51], s61 offen offset:2048 sc1
    s_waitcnt lgkmcnt(0)
    buffer_store_dwordx4 v[60:63], v5, s[48:51], s61 offen offset:3072 sc1
    s_add_u32 s61, s60, 4
    s_sub_u32 s61, s61, 64
    s_lshl_b32 s61, s61, 17
    s_lshl_b32 s62, s36, 13
    s_add_u32 s61, s61, s62
    s_add_u32 s61, s61, 0x800000
    ds_read_b128 v[64:67], v7 offset:32768
    ds_read_b128 v[68:71], v7 offset:33792
    ds_read_b128 v[72:75], v7 offset:34816
    ds_read_b128 v[76:79], v7 offset:35840
    ds_read_b128 v[80:83], v7 offset:36864
    ds_read_b128 v[84:87], v7 offset:37888
    ds_read_b128 v[88:91], v7 offset:38912
    ds_read_b128 v[92:95], v7 offset:39936
    s_waitcnt lgkmcnt(7)
    buffer_store_dwordx4 v[64:67], v6, s[48:51], s61 offen offset:0 sc1
    s_waitcnt lgkmcnt(6)
    buffer_store_dwordx4 v[68:71], v6, s[48:51], s61 offen offset:1024 sc1
    s_waitcnt lgkmcnt(5)
    buffer_store_dwordx4 v[72:75], v6, s[48:51], s61 offen offset:2048 sc1
    s_waitcnt lgkmcnt(4)
    buffer_store_dwordx4 v[76:79], v6, s[48:51], s61 offen offset:3072 sc1
    s_waitcnt lgkmcnt(3)
    buffer_store_dwordx4 v[80:83], v5, s[48:51], s61 offen offset:0 sc1
    s_waitcnt lgkmcnt(2)
    buffer_store_dwordx4 v[84:87], v5, s[48:51], s61 offen offset:1024 sc1
    s_waitcnt lgkmcnt(1)
    buffer_store_dwordx4 v[88:91], v5, s[48:51], s61 offen offset:2048 sc1
    s_waitcnt lgkmcnt(0)
    buffer_store_dwordx4 v[92:95], v5, s[48:51], s61 offen offset:3072 sc1
    s_add_u32 s61, s60, 8
    s_sub_u32 s61, s61, 64
    s_lshl_b32 s61, s61, 17
    s_lshl_b32 s62, s36, 13
    s_add_u32 s61, s61, s62
    s_add_u32 s61, s61, 0x800000
    ds_read_b128 v[32:35], v4 offset:0
    ds_read_b128 v[36:39], v4 offset:1024
    ds_read_b128 v[40:43], v4 offset:2048
    ds_read_b128 v[44:47], v4 offset:3072
    ds_read_b128 v[48:51], v4 offset:4096
    ds_read_b128 v[52:55], v4 offset:5120
    ds_read_b128 v[56:59], v4 offset:6144
    ds_read_b128 v[60:63], v4 offset:7168
    s_waitcnt lgkmcnt(7)
    buffer_store_dwordx4 v[32:35], v6, s[48:51], s61 offen offset:0 sc1
    s_waitcnt lgkmcnt(6)
    buffer_store_dwordx4 v[36:39], v6, s[48:51], s61 offen offset:1024 sc1
    s_waitcnt lgkmcnt(5)
    buffer_store_dwordx4 v[40:43], v6, s[48:51], s61 offen offset:2048 sc1
    s_waitcnt lgkmcnt(4)
    buffer_store_dwordx4 v[44:47], v6, s[48:51], s61 offen offset:3072 sc1
    s_waitcnt lgkmcnt(3)
    buffer_store_dwordx4 v[48:51], v5, s[48:51], s61 offen offset:0 sc1
    s_waitcnt lgkmcnt(2)
    buffer_store_dwordx4 v[52:55], v5, s[48:51], s61 offen offset:1024 sc1
    s_waitcnt lgkmcnt(1)
    buffer_store_dwordx4 v[56:59], v5, s[48:51], s61 offen offset:2048 sc1
    s_waitcnt lgkmcnt(0)
    buffer_store_dwordx4 v[60:63], v5, s[48:51], s61 offen offset:3072 sc1
    s_mov_b64 exec, -1
    s_waitcnt vmcnt(0)
    s_endpgm
K1_H:
    s_mov_b32 s32, s12
    s_mov_b32 s33, s13
    s_mov_b32 s34, 0x1e0000
    s_mov_b32 s35, 0x00020000
    s_sub_u32 s39, s37, 8
    s_mul_i32 s38, s39, 384
    s_add_u32 s48, s24, 0x1000000
    s_addc_u32 s49, s25, 0
    s_mov_b32 s50, 0x600000
    s_mov_b32 s51, 0x00020000
    s_mov_b32 s52, s14
    s_mov_b32 s53, s15
    s_mov_b32 s54, 0xc00
    s_mov_b32 s55, 0x00020000
    s_lshl_b32 s41, s26, 6
    s_mov_b32 s46, 3072
    v_add_u32 v2, s41, v1
    v_mul_u32_u24 v3, 2521, v2
    v_lshrrev_b32 v3, 16, v3
    v_mul_u32_u24 v4, 26, v3
    v_sub_u32 v4, v2, v4
    v_and_b32 v5, 35, v3
    v_bfe_u32 v6, v3, 4, 1
    v_lshl_or_b32 v5, v6, 2, v5
    v_bfe_u32 v6, v3, 2, 2
    v_lshl_or_b32 v5, v6, 3, v5
    v_mul_lo_u32 v5, v5, s46
    v_min_u32 v4, 23, v4
    v_lshl_add_u32 v5, v4, 4, v5
    v_add_u32 v16, s38, v5
    v_add_u32 v2, s41, v1
    v_add_u32 v2, 256, v2
    v_mul_u32_u24 v3, 2521, v2
    v_lshrrev_b32 v3, 16, v3
    v_mul_u32_u24 v4, 26, v3
    v_sub_u32 v4, v2, v4
    v_and_b32 v5, 35, v3
    v_bfe_u32 v6, v3, 4, 1
    v_lshl_or_b32 v5, v6, 2, v5
    v_bfe_u32 v6, v3, 2, 2
    v_lshl_or_b32 v5, v6, 3, v5
    v_mul_lo_u32 v5, v5, s46
    v_min_u32 v4, 23, v4
    v_lshl_add_u32 v5, v4, 4, v5
    v_add_u32 v17, s38, v5
    v_add_u32 v2, s41, v1
    v_add_u32 v2, 512, v2
    v_mul_u32_u24 v3, 2521, v2
    v_lshrrev_b32 v3, 16, v3
    v_mul_u32_u24 v4, 26, v3
    v_sub_u32 v4, v2, v4
    v_and_b32 v5, 35, v3
    v_bfe_u32 v6, v3, 4, 1
    v_lshl_or_b32 v5, v6, 2, v5
    v_bfe_u32 v6, v3, 2, 2
    v_lshl_or_b32 v5, v6, 3, v5
    v_mul_lo_u32 v5, v5, s46
    v_min_u32 v4, 23, v4
    v_lshl_add_u32 v5, v4, 4, v5
    v_add_u32 v18, s38, v5
    v_add_u32 v2, s41, v1
    v_add_u32 v2, 768, v2
    v_mul_u32_u24 v3, 2521, v2
    v_lshrrev_b32 v3, 16, v3
    v_mul_u32_u24 v4, 26, v3
    v_sub_u32 v4, v2, v4
    v_and_b32 v5, 35, v3
    v_bfe_u32 v6, v3, 4, 1
    v_lshl_or_b32 v5, v6, 2, v5
    v_bfe_u32 v6, v3, 2, 2
    v_lshl_or_b32 v5, v6, 3, v5
    v_mul_lo_u32 v5, v5, s46
    v_min_u32 v4, 23, v4
    v_lshl_add_u32 v5, v4, 4, v5
    v_add_u32 v19, s38, v5
    v_add_u32 v2, s41, v1
    v_add_u32 v2, 1024, v2
    v_mul_u32_u24 v3, 2521, v2
    v_lshrrev_b32 v3, 16, v3
    v_mul_u32_u24 v4, 26, v3
    v_sub_u32 v4, v2, v4
    v_and_b32 v5, 35, v3
    v_bfe_u32 v6, v3, 4, 1
    v_lshl_or_b32 v5, v6, 2, v5
    v_bfe_u32 v6, v3, 2, 2
    v_lshl_or_b32 v5, v6, 3, v5
    v_mul_lo_u32 v5, v5, s46
    v_min_u32 v4, 23, v4
    v_lshl_add_u32 v5, v4, 4, v5
    v_add_u32 v20, s38, v5
    v_add_u32 v2, s41, v1
    v_add_u32 v2, 1280, v2
    v_mul_u32_u24 v3, 2521, v2
    v_lshrrev_b32 v3, 16, v3
    v_mul_u32_u24 v4, 26, v3
    v_sub_u32 v4, v2, v4
    v_and_b32 v5, 35, v3
    v_bfe_u32 v6, v3, 4, 1
    v_lshl_or_b32 v5, v6, 2, v5
    v_bfe_u32 v6, v3, 2, 2
    v_lshl_or_b32 v5, v6, 3, v5
    v_mul_lo_u32 v5, v5, s46
    v_min_u32 v4, 23, v4
    v_lshl_add_u32 v5, v4, 4, v5
    v_add_u32 v21, s38, v5
    v_add_u32 v2, s41, v1
    v_add_u32 v2, 1536, v2
    v_mul_u32_u24 v3, 2521, v2
    v_lshrrev_b32 v3, 16, v3
    v_mul_u32_u24 v4, 26, v3
    v_sub_u32 v4, v2, v4
    v_and_b32 v5, 35, v3
    v_bfe_u32 v6, v3, 4, 1
    v_lshl_or_b32 v5, v6, 2, v5
    v_bfe_u32 v6, v3, 2, 2
    v_lshl_or_b32 v5, v6, 3, v5
    v_mul_lo_u32 v5, v5, s46
    v_min_u32 v4, 23, v4
    v_lshl_add_u32 v5, v4, 4, v5
    v_add_u32 v22, s38, v5
    v_add_u32 v2, s41, v1
    v_add_u32 v2, 1792, v2
    v_mul_u32_u24 v3, 2521, v2
    v_lshrrev_b32 v3, 16, v3
    v_mul_u32_u24 v4, 26, v3
    v_sub_u32 v4, v2, v4
    v_and_b32 v5, 35, v3
    v_bfe_u32 v6, v3, 4, 1
    v_lshl_or_b32 v5, v6, 2, v5
    v_bfe_u32 v6, v3, 2, 2
    v_lshl_or_b32 v5, v6, 3, v5
    v_mul_lo_u32 v5, v5, s46
    v_min_u32 v4, 23, v4
    v_lshl_add_u32 v5, v4, 4, v5
    v_add_u32 v23, s38, v5
    v_bfe_u32 v2, v1, 2, 4
    v_mul_u32_u24 v2, 416, v2
    v_and_b32 v3, 3, v1
    v_lshl_add_u32 v26, v3, 3, v2
    s_and_b32 s3, s26, 1
    s_mul_i32 s3, s3, 192
    v_add_u32 v26, s3, v26
    s_mul_i32 s47, s46, 64
    v_lshrrev_b32 v2, 4, v1
    v_lshlrev_b32 v2, 3, v2
    v_add_u32 v2, s38, v2
    s_and_b32 s3, s26, 1
    s_mul_i32 s3, s3, 192
    v_add_u32 v2, s3, v2
    buffer_load_dwordx2 v[224:225], v2, s[52:55], 0 offen offset:0
    buffer_load_dwordx2 v[226:227], v2, s[52:55], 0 offen offset:32
    buffer_load_dwordx2 v[228:229], v2, s[52:55], 0 offen offset:64
    buffer_load_dwordx2 v[230:231], v2, s[52:55], 0 offen offset:96
    buffer_load_dwordx2 v[232:233], v2, s[52:55], 0 offen offset:128
    buffer_load_dwordx2 v[234:235], v2, s[52:55], 0 offen offset:160
    s_lshl_b32 s66, s36, 3
    s_add_u32 s66, s66, s39
    s_lshl_b32 s66, s66, 2
    s_add_u32 s66, s66, s26
    s_lshl_b32 s41, s26, 10
    s_mul_i32 s43, s47, 0
    s_add_u32 m0, s41, 0
    s_nop 0
    buffer_load_dwordx4 v16, s[32:35], s43 offen lds
    s_add_u32 m0, s41, 4096
    s_nop 0
    buffer_load_dwordx4 v17, s[32:35], s43 offen lds
    s_add_u32 m0, s41, 8192
    s_nop 0
    buffer_load_dwordx4 v18, s[32:35], s43 offen lds
    s_add_u32 m0, s41, 12288
    s_nop 0
    buffer_load_dwordx4 v19, s[32:35], s43 offen lds
    s_add_u32 m0, s41, 16384
    s_nop 0
    buffer_load_dwordx4 v20, s[32:35], s43 offen lds
    s_add_u32 m0, s41, 20480
    s_nop 0
    buffer_load_dwordx4 v21, s[32:35], s43 offen lds
    s_cmp_ge_u32 s26, 2
    s_cbranch_scc1 K1_SK_17
    s_add_u32 m0, s41, 24576
    s_nop 0
    buffer_load_dwordx4 v22, s[32:35], s43 offen lds
K1_SK_17:
    s_add_u32 s92, s66, 0
    s_mov_b32 s94, -1
    s_cmp_ge_u32 s92, 680
    s_cbranch_scc1 K1_RP_18
    s_cmp_ge_u32 s92, 480
    s_cselect_b32 s84, s8, s16
    s_cselect_b32 s85, s9, s17
    s_mov_b32 s86, 1966080
    s_cselect_b32 s86, 819200, s86
    s_cselect_b32 s93, 480, 0
    s_cselect_b32 s94, 0x400000, 0
    s_cselect_b64 vcc, -1, 0
    s_mov_b32 s87, 0x00020000
    s_sub_u32 s68, s92, s93
    v_lshrrev_b32 v2, 3, v1
    s_mul_i32 s69, s68, 6554
    s_lshr_b32 s69, s69, 16
    s_mul_i32 s76, s69, 10
    s_sub_u32 s76, s68, s76
    s_mul_i32 s77, s69, 40960
    s_lshl_b32 s78, s76, 7
    s_add_u32 s77, s77, s78
    v_and_b32 v3, 7, v1
    s_lshl_b32 s93, s26, 13
    s_add_u32 s93, s93, 94208
    v_add_u32 v4, 0, v2
    v_and_b32 v5, 3, v4
    v_bfe_u32 v6, v4, 4, 1
    v_lshl_or_b32 v5, v6, 2, v5
    v_bfe_u32 v6, v4, 2, 2
    v_lshl_or_b32 v5, v6, 3, v5
    v_cndmask_b32 v4, v4, v5, vcc
    v_mul_u32_u24 v4, 1280, v4
    v_lshl_add_u32 v4, v3, 4, v4
    s_add_u32 m0, s93, 0
    s_nop 0
    buffer_load_dwordx4 v4, s[84:87], s77 offen lds
    v_add_u32 v4, 8, v2
    v_and_b32 v5, 3, v4
    v_bfe_u32 v6, v4, 4, 1
    v_lshl_or_b32 v5, v6, 2, v5
    v_bfe_u32 v6, v4, 2, 2
    v_lshl_or_b32 v5, v6, 3, v5
    v_cndmask_b32 v4, v4, v5, vcc
    v_mul_u32_u24 v4, 1280, v4
    v_lshl_add_u32 v4, v3, 4, v4
    s_add_u32 m0, s93, 1024
    s_nop 0
    buffer_load_dwordx4 v4, s[84:87], s77 offen lds
    v_add_u32 v4, 16, v2
    v_and_b32 v5, 3, v4
    v_bfe_u32 v6, v4, 4, 1
    v_lshl_or_b32 v5, v6, 2, v5
    v_bfe_u32 v6, v4, 2, 2
    v_lshl_or_b32 v5, v6, 3, v5
    v_cndmask_b32 v4, v4, v5, vcc
    v_mul_u32_u24 v4, 1280, v4
    v_lshl_add_u32 v4, v3, 4, v4
    s_add_u32 m0, s93, 2048
    s_nop 0
    buffer_load_dwordx4 v4, s[84:87], s77 offen lds
    v_add_u32 v4, 24, v2
    v_and_b32 v5, 3, v4
    v_bfe_u32 v6, v4, 4, 1
    v_lshl_or_b32 v5, v6, 2, v5
    v_bfe_u32 v6, v4, 2, 2
    v_lshl_or_b32 v5, v6, 3, v5
    v_cndmask_b32 v4, v4, v5, vcc
    v_mul_u32_u24 v4, 1280, v4
    v_lshl_add_u32 v4, v3, 4, v4
    s_add_u32 m0, s93, 3072
    s_nop 0
    buffer_load_dwordx4 v4, s[84:87], s77 offen lds
    s_mul_i32 s77, s69, 40
    s_lshl_b32 s78, s76, 2
    s_add_u32 s77, s77, s78
    s_lshl_b32 s77, s77, 10
    s_add_u32 s94, s94, s77
K1_RP_18:
    s_add_u32 s92, s66, 512
    s_mov_b32 s95, -1
    s_cmp_ge_u32 s92, 680
    s_cbranch_scc1 K1_RP_19
    s_cmp_ge_u32 s92, 480
    s_cselect_b32 s84, s8, s16
    s_cselect_b32 s85, s9, s17
    s_mov_b32 s86, 1966080
    s_cselect_b32 s86, 819200, s86
    s_cselect_b32 s93, 480, 0
    s_cselect_b32 s95, 0x400000, 0
    s_cselect_b64 vcc, -1, 0
    s_mov_b32 s87, 0x00020000
    s_sub_u32 s68, s92, s93
    v_lshrrev_b32 v2, 3, v1
    s_mul_i32 s69, s68, 6554
    s_lshr_b32 s69, s69, 16
    s_mul_i32 s76, s69, 10
    s_sub_u32 s76, s68, s76
    s_mul_i32 s77, s69, 40960
    s_lshl_b32 s78, s76, 7
    s_add_u32 s77, s77, s78
    v_and_b32 v3, 7, v1
    s_lshl_b32 s93, s26, 13
    s_add_u32 s93, s93, 98304
    v_add_u32 v4, 0, v2
    v_and_b32 v5, 3, v4
    v_bfe_u32 v6, v4, 4, 1
    v_lshl_or_b32 v5, v6, 2, v5
    v_bfe_u32 v6, v4, 2, 2
    v_lshl_or_b32 v5, v6, 3, v5
    v_cndmask_b32 v4, v4, v5, vcc
    v_mul_u32_u24 v4, 1280, v4
    v_lshl_add_u32 v4, v3, 4, v4
    s_add_u32 m0, s93, 0
    s_nop 0
    buffer_load_dwordx4 v4, s[84:87], s77 offen lds
    v_add_u32 v4, 8, v2
    v_and_b32 v5, 3, v4
    v_bfe_u32 v6, v4, 4, 1
    v_lshl_or_b32 v5, v6, 2, v5
    v_bfe_u32 v6, v4, 2, 2
    v_lshl_or_b32 v5, v6, 3, v5
    v_cndmask_b32 v4, v4, v5, vcc
    v_mul_u32_u24 v4, 1280, v4
    v_lshl_add_u32 v4, v3, 4, v4
    s_add_u32 m0, s93, 1024
    s_nop 0
    buffer_load_dwordx4 v4, s[84:87], s77 offen lds
    v_add_u32 v4, 16, v2
    v_and_b32 v5, 3, v4
    v_bfe_u32 v6, v4, 4, 1
    v_lshl_or_b32 v5, v6, 2, v5
    v_bfe_u32 v6, v4, 2, 2
    v_lshl_or_b32 v5, v6, 3, v5
    v_cndmask_b32 v4, v4, v5, vcc
    v_mul_u32_u24 v4, 1280, v4
    v_lshl_add_u32 v4, v3, 4, v4
    s_add_u32 m0, s93, 2048
    s_nop 0
    buffer_load_dwordx4 v4, s[84:87], s77 offen lds
    v_add_u32 v4, 24, v2
    v_and_b32 v5, 3, v4
    v_bfe_u32 v6, v4, 4, 1
    v_lshl_or_b32 v5, v6, 2, v5
    v_bfe_u32 v6, v4, 2, 2
    v_lshl_or_b32 v5, v6, 3, v5
    v_cndmask_b32 v4, v4, v5, vcc
    v_mul_u32_u24 v4, 1280, v4
    v_lshl_add_u32 v4, v3, 4, v4
    s_add_u32 m0, s93, 3072
    s_nop 0
    buffer_load_dwordx4 v4, s[84:87], s77 offen lds
    s_mul_i32 s77, s69, 40
    s_lshl_b32 s78, s76, 2
    s_add_u32 s77, s77, s78
    s_lshl_b32 s77, s77, 10
    s_add_u32 s95, s95, s77
K1_RP_19:
    s_add_u32 s42, s74, 47104
    s_movk_i32 s44, 128
    s_add_u32 m0, s42, 0
    s_nop 0
    buffer_load_dwordx4 v8, s[28:31], s44 offen lds
    s_add_u32 m0, s42, 1024
    s_nop 0
    buffer_load_dwordx4 v9, s[28:31], s44 offen lds
    s_add_u32 m0, s42, 2048
    s_nop 0
    buffer_load_dwordx4 v10, s[28:31], s44 offen lds
    s_add_u32 m0, s42, 3072
    s_nop 0
    buffer_load_dwordx4 v11, s[28:31], s44 offen lds
    s_movk_i32 s44, 256
    s_mul_i32 s43, s47, 1
    s_add_u32 m0, s41, 47104
    s_nop 0
    buffer_load_dwordx4 v16, s[32:35], s43 offen lds
    s_add_u32 m0, s41, 51200
    s_nop 0
    buffer_load_dwordx4 v17, s[32:35], s43 offen lds
    s_add_u32 m0, s41, 55296
    s_nop 0
    buffer_load_dwordx4 v18, s[32:35], s43 offen lds
    s_add_u32 m0, s41, 59392
    s_nop 0
    buffer_load_dwordx4 v19, s[32:35], s43 offen lds
    s_add_u32 m0, s41, 63488
    s_nop 0
    buffer_load_dwordx4 v20, s[32:35], s43 offen lds
    s_add_u32 m0, s41, 67584
    s_nop 0
    buffer_load_dwordx4 v21, s[32:35], s43 offen lds
    s_cmp_ge_u32 s26, 2
    s_cbranch_scc1 K1_SK_20
    s_add_u32 m0, s41, 71680
    s_nop 0
    buffer_load_dwordx4 v22, s[32:35], s43 offen lds
K1_SK_20:
    s_lshr_b32 s60, s2, 3
    v_and_b32 v2, 31, v1
    v_lshrrev_b32 v3, 5, v1
    s_and_b32 s61, s27, 1
    s_lshl_b32 s61, s61, 10
    s_lshl_b32 s62, s60, 5
    s_add_u32 s61, s61, s62
    v_add_u32 v4, s61, v2
    v_mul_u32_u24 v4, 1280, v4
    s_lshl_b32 s62, s26, 1
    s_add_u32 s62, s62, 2
    v_add_u32 v5, s62, v3
    v_lshl_add_u32 v4, v5, 7, v4
    v_mov_b32 v126, v4
    s_mul_i32 s61, s60, 24
    v_min_u32 v2, 23, v2
    v_add_u32 v4, s61, v2
    v_mul_u32_u24 v6, 5462, v4
    v_lshrrev_b32 v6, 16, v6
    v_mul_u32_u24 v7, 12, v6
    v_sub_u32 v7, v4, v7
    v_lshl_add_u32 v6, v5, 6, v6
    v_mul_lo_u32 v6, v6, s46
    v_lshl_add_u32 v6, v7, 7, v6
    s_lshr_b32 s61, s27, 1
    s_and_b32 s61, s61, 1
    s_mul_i32 s61, s61, 1536
    v_add_u32 v6, s61, v6
    v_mov_b32 v127, v6
    s_cmp_lg_u32 s26, 0
    s_cbranch_scc1 K1_T_21
    buffer_load_dword v124, v126, s[28:31], 0 offen
    buffer_load_dword v125, v127, s[32:35], 0 offen
K1_T_21:
    v_mov_b32 v92, 0
    v_mov_b32 v93, 0
    v_mov_b32 v94, 0
    v_mov_b32 v95, 0
    v_mov_b32 v96, 0
    v_mov_b32 v97, 0
    v_mov_b32 v98, 0
    v_mov_b32 v99, 0
    v_mov_b32 v100, 0
    v_mov_b32 v101, 0
    v_mov_b32 v102, 0
    v_mov_b32 v103, 0
    v_mov_b32 v104, 0
    v_mov_b32 v105, 0
    v_mov_b32 v106, 0
    v_mov_b32 v107, 0
    v_mov_b32 v108, 0
    v_mov_b32 v109, 0
    v_mov_b32 v110, 0
    v_mov_b32 v111, 0
    v_mov_b32 v112, 0
    v_mov_b32 v113, 0
    v_mov_b32 v114, 0
    v_mov_b32 v115, 0
    v_mov_b32 v116, 0
    v_mov_b32 v117, 0
    v_mov_b32 v118, 0
    v_mov_b32 v119, 0
    v_mov_b32 v120, 0
    v_mov_b32 v121, 0
    v_mov_b32 v122, 0
    v_mov_b32 v123, 0
    v_mov_b32 v128, 0
    v_mov_b32 v129, 0
    v_mov_b32 v130, 0
    v_mov_b32 v131, 0
    v_mov_b32 v132, 0
    v_mov_b32 v133, 0
    v_mov_b32 v134, 0
    v_mov_b32 v135, 0
    v_mov_b32 v136, 0
    v_mov_b32 v137, 0
    v_mov_b32 v138, 0
    v_mov_b32 v139, 0
    v_mov_b32 v140, 0
    v_mov_b32 v141, 0
    v_mov_b32 v142, 0
    v_mov_b32 v143, 0
    v_mov_b32 v144, 0
    v_mov_b32 v145, 0
    v_mov_b32 v146, 0
    v_mov_b32 v147, 0
    v_mov_b32 v148, 0
    v_mov_b32 v149, 0
    v_mov_b32 v150, 0
    v_mov_b32 v151, 0
    v_mov_b32 v152, 0
    v_mov_b32 v153, 0
    v_mov_b32 v154, 0
    v_mov_b32 v155, 0
    v_mov_b32 v156, 0
    v_mov_b32 v157, 0
    v_mov_b32 v158, 0
    v_mov_b32 v159, 0
    v_mov_b32 v160, 0
    v_mov_b32 v161, 0
    v_mov_b32 v162, 0
    v_mov_b32 v163, 0
    v_mov_b32 v164, 0
    v_mov_b32 v165, 0
    v_mov_b32 v166, 0
    v_mov_b32 v167, 0
    v_mov_b32 v168, 0
    v_mov_b32 v169, 0
    v_mov_b32 v170, 0
    v_mov_b32 v171, 0
    v_mov_b32 v172, 0
    v_mov_b32 v173, 0
    v_mov_b32 v174, 0
    v_mov_b32 v175, 0
    v_mov_b32 v176, 0
    v_mov_b32 v177, 0
    v_mov_b32 v178, 0
    v_mov_b32 v179, 0
    v_mov_b32 v180, 0
    v_mov_b32 v181, 0
    v_mov_b32 v182, 0
    v_mov_b32 v183, 0
    v_mov_b32 v184, 0
    v_mov_b32 v185, 0
    v_mov_b32 v186, 0
    v_mov_b32 v187, 0
    v_mov_b32 v188, 0
    v_mov_b32 v189, 0
    v_mov_b32 v190, 0
    v_mov_b32 v191, 0
    v_mov_b32 v192, 0
    v_mov_b32 v193, 0
    v_mov_b32 v194, 0
    v_mov_b32 v195, 0
    v_mov_b32 v196, 0
    v_mov_b32 v197, 0
    v_mov_b32 v198, 0
    v_mov_b32 v199, 0
    v_mov_b32 v200, 0
    v_mov_b32 v201, 0
    v_mov_b32 v202, 0
    v_mov_b32 v203, 0
    v_mov_b32 v204, 0
    v_mov_b32 v205, 0
    v_mov_b32 v206, 0
    v_mov_b32 v207, 0
    v_mov_b32 v208, 0
    v_mov_b32 v209, 0
    v_mov_b32 v210, 0
    v_mov_b32 v211, 0
    v_mov_b32 v212, 0
    v_mov_b32 v213, 0
    v_mov_b32 v214, 0
    v_mov_b32 v215, 0
    v_mov_b32 v216, 0
    v_mov_b32 v217, 0
    v_mov_b32 v218, 0
    v_mov_b32 v219, 0
    v_mov_b32 v220, 0
    v_mov_b32 v221, 0
    v_mov_b32 v222, 0
    v_mov_b32 v223, 0
    v_mov_b32 v28, 0x3f803f80
    v_mov_b32 v29, 0x3f803f80
    v_mov_b32 v30, 0x3f803f80
    v_mov_b32 v31, 0x3f803f80
    s_mul_i32 s43, s47, 2
    s_add_u32 s88, s24, 0x2400000
    s_addc_u32 s89, s25, 0
    s_mov_b32 s90, 0x4c8000
    s_mov_b32 s91, 0x00020000
    v_bfe_u32 v2, v1, 2, 4
    v_lshlrev_b32 v2, 7, v2
    v_and_b32 v3, 3, v1
    v_lshl_add_u32 v2, v3, 3, v2
    s_lshl_b32 s93, s26, 13
    s_add_u32 s93, s93, 94208
    v_add_u32 v2, s93, v2
    v_lshlrev_b32 v3, 4, v1
    s_waitcnt vmcnt(10)
    s_cmp_eq_u32 s94, -1
    s_cbranch_scc1 K1_RF_22
    ds_read_b64_tr_b16 v[64:65], v2 offset:0
    ds_read_b64_tr_b16 v[66:67], v2 offset:2048
    ds_read_b64_tr_b16 v[68:69], v2 offset:32
    ds_read_b64_tr_b16 v[70:71], v2 offset:2080
    ds_read_b64_tr_b16 v[72:73], v2 offset:64
    ds_read_b64_tr_b16 v[74:75], v2 offset:2112
    ds_read_b64_tr_b16 v[76:77], v2 offset:96
    ds_read_b64_tr_b16 v[78:79], v2 offset:2144
    s_waitcnt lgkmcnt(0)
    buffer_store_dwordx4 v[64:67], v3, s[88:91], s94 offen offset:0 sc1
    buffer_store_dwordx4 v[68:71], v3, s[88:91], s94 offen offset:1024 sc1
    buffer_store_dwordx4 v[72:75], v3, s[88:91], s94 offen offset:2048 sc1
    buffer_store_dwordx4 v[76:79], v3, s[88:91], s94 offen offset:3072 sc1
    s_nop 1
K1_RF_22:
    s_cmp_eq_u32 s95, -1
    s_cbranch_scc1 K1_RF_23
    ds_read_b64_tr_b16 v[64:65], v2 offset:4096
    ds_read_b64_tr_b16 v[66:67], v2 offset:6144
    ds_read_b64_tr_b16 v[68:69], v2 offset:4128
    ds_read_b64_tr_b16 v[70:71], v2 offset:6176
    ds_read_b64_tr_b16 v[72:73], v2 offset:4160
    ds_read_b64_tr_b16 v[74:75], v2 offset:6208
    ds_read_b64_tr_b16 v[76:77], v2 offset:4192
    ds_read_b64_tr_b16 v[78:79], v2 offset:6240
    s_waitcnt lgkmcnt(0)
    buffer_store_dwordx4 v[64:67], v3, s[88:91], s95 offen offset:0 sc1
    buffer_store_dwordx4 v[68:71], v3, s[88:91], s95 offen offset:1024 sc1
    buffer_store_dwordx4 v[72:75], v3, s[88:91], s95 offen offset:2048 sc1
    buffer_store_dwordx4 v[76:79], v3, s[88:91], s95 offen offset:3072 sc1
    s_nop 1
K1_RF_23:
    s_cmp_eq_u32 s26, 1
    s_cbranch_scc1 K1_H_W1
    s_cmp_eq_u32 s26, 2
    s_cbranch_scc1 K1_H_W2
    s_cmp_eq_u32 s26, 3
    s_cbranch_scc1 K1_H_W3
K1_H_W0:
    s_mov_b32 s70, 0
    s_mov_b32 s71, 47104
    s_mov_b32 s72, 94208
    v_add_u32 v27, s70, v26
    v_add_u32 v12, s71, v26
    v_add_u32 v13, s70, v24
    v_add_u32 v14, s70, v25
    v_add_u32 v15, s71, v24
    s_barrier
    ds_read_b128 v[32:35], v13 offset:0
    ds_read_b128 v[36:39], v13 offset:2048
    ds_read_b128 v[40:43], v13 offset:4096
    ds_read_b128 v[44:47], v13 offset:6144
    ds_read_b64_tr_b16 v[64:65], v27 offset:0
    ds_read_b64_tr_b16 v[66:67], v27 offset:6656
    ds_read_b64_tr_b16 v[68:69], v27 offset:32
    ds_read_b64_tr_b16 v[70:71], v27 offset:6688
    ds_read_b64_tr_b16 v[72:73], v27 offset:64
    ds_read_b64_tr_b16 v[74:75], v27 offset:6720
    s_mov_b32 s45, 0
K1_LH0:
    s_add_u32 s42, s72, s41
    s_add_u32 s73, s72, s74
    s_waitcnt lgkmcnt(4)
    v_mfma_f32_16x16x32_bf16 v[128:131], v[64:67], v[32:35], v[128:131]
    ds_read_b64_tr_b16 v[76:77], v27 offset:96
    v_mfma_f32_16x16x32_bf16 v[132:135], v[64:67], v[36:39], v[132:135]
    ds_read_b64_tr_b16 v[78:79], v27 offset:6752
    s_add_u32 m0, s42, 0
    v_mfma_f32_16x16x32_bf16 v[136:139], v[64:67], v[40:43], v[136:139]
    buffer_load_dwordx4 v16, s[32:35], s43 offen lds
    s_add_u32 m0, s42, 4096
    v_mfma_f32_16x16x32_bf16 v[140:143], v[64:67], v[44:47], v[140:143]
    buffer_load_dwordx4 v17, s[32:35], s43 offen lds
    v_mfma_f32_16x16x32_bf16 v[108:111], v[64:67], v[28:31], v[108:111]
    v_mfma_f32_16x16x32_bf16 v[92:95], v[28:31], v[32:35], v[92:95]
    ds_read_b128 v[48:51], v14 offset:0
    ds_read_b128 v[52:55], v14 offset:2048
    ds_read_b128 v[56:59], v14 offset:4096
    ds_read_b128 v[60:63], v14 offset:6144
    s_waitcnt lgkmcnt(8)
    v_mfma_f32_16x16x32_bf16 v[144:147], v[68:71], v[32:35], v[144:147]
    ds_read_b64_tr_b16 v[64:65], v27 offset:128
    v_mfma_f32_16x16x32_bf16 v[148:151], v[68:71], v[36:39], v[148:151]
    ds_read_b64_tr_b16 v[66:67], v27 offset:6784
    s_add_u32 m0, s42, 8192
    v_mfma_f32_16x16x32_bf16 v[152:155], v[68:71], v[40:43], v[152:155]
    buffer_load_dwordx4 v18, s[32:35], s43 offen lds
    v_mfma_f32_16x16x32_bf16 v[156:159], v[68:71], v[44:47], v[156:159]
    v_mfma_f32_16x16x32_bf16 v[96:99], v[28:31], v[36:39], v[96:99]
    s_waitcnt lgkmcnt(8)
    v_mfma_f32_16x16x32_bf16 v[160:163], v[72:75], v[32:35], v[160:163]
    ds_read_b64_tr_b16 v[68:69], v27 offset:160
    v_mfma_f32_16x16x32_bf16 v[164:167], v[72:75], v[36:39], v[164:167]
    ds_read_b64_tr_b16 v[70:71], v27 offset:6816
    s_add_u32 m0, s42, 12288
    v_mfma_f32_16x16x32_bf16 v[168:171], v[72:75], v[40:43], v[168:171]
    buffer_load_dwordx4 v19, s[32:35], s43 offen lds
    v_mfma_f32_16x16x32_bf16 v[172:175], v[72:75], v[44:47], v[172:175]
    v_mfma_f32_16x16x32_bf16 v[112:115], v[72:75], v[28:31], v[112:115]
    v_mfma_f32_16x16x32_bf16 v[100:103], v[28:31], v[40:43], v[100:103]
    s_waitcnt lgkmcnt(8)
    v_mfma_f32_16x16x32_bf16 v[176:179], v[76:79], v[32:35], v[176:179]
    ds_read_b64_tr_b16 v[72:73], v27 offset:13312
    v_mfma_f32_16x16x32_bf16 v[180:183], v[76:79], v[36:39], v[180:183]
    ds_read_b64_tr_b16 v[74:75], v27 offset:19968
    s_add_u32 m0, s42, 16384
    v_mfma_f32_16x16x32_bf16 v[184:187], v[76:79], v[40:43], v[184:187]
    buffer_load_dwordx4 v20, s[32:35], s43 offen lds
    v_mfma_f32_16x16x32_bf16 v[188:191], v[76:79], v[44:47], v[188:191]
    v_mfma_f32_16x16x32_bf16 v[104:107], v[28:31], v[44:47], v[104:107]
    s_waitcnt lgkmcnt(4)
    v_mfma_f32_16x16x32_bf16 v[192:195], v[64:67], v[32:35], v[192:195]
    ds_read_b64_tr_b16 v[76:77], v27 offset:13344
    v_mfma_f32_16x16x32_bf16 v[196:199], v[64:67], v[36:39], v[196:199]
    ds_read_b64_tr_b16 v[78:79], v27 offset:20000
    s_add_u32 m0, s42, 20480
    v_mfma_f32_16x16x32_bf16 v[200:203], v[64:67], v[40:43], v[200:203]
    buffer_load_dwordx4 v21, s[32:35], s43 offen lds
    v_mfma_f32_16x16x32_bf16 v[204:207], v[64:67], v[44:47], v[204:207]
    v_mfma_f32_16x16x32_bf16 v[116:119], v[64:67], v[28:31], v[116:119]
    s_waitcnt lgkmcnt(4)
    v_mfma_f32_16x16x32_bf16 v[208:211], v[68:71], v[32:35], v[208:211]
    ds_read_b64_tr_b16 v[64:65], v27 offset:13376
    v_mfma_f32_16x16x32_bf16 v[212:215], v[68:71], v[36:39], v[212:215]
    ds_read_b64_tr_b16 v[66:67], v27 offset:20032
    s_add_u32 m0, s42, 24576
    v_mfma_f32_16x16x32_bf16 v[216:219], v[68:71], v[40:43], v[216:219]
    buffer_load_dwordx4 v22, s[32:35], s43 offen lds
    v_mfma_f32_16x16x32_bf16 v[220:223], v[68:71], v[44:47], v[220:223]
    s_waitcnt lgkmcnt(4)
    v_mfma_f32_16x16x32_bf16 v[128:131], v[72:75], v[48:51], v[128:131]
    ds_read_b64_tr_b16 v[68:69], v27 offset:13408
    v_mfma_f32_16x16x32_bf16 v[132:135], v[72:75], v[52:55], v[132:135]
    ds_read_b64_tr_b16 v[70:71], v27 offset:20064
    s_add_u32 m0, s73, 0
    v_mfma_f32_16x16x32_bf16 v[136:139], v[72:75], v[56:59], v[136:139]
    buffer_load_dwordx4 v8, s[28:31], s44 offen lds
    v_mfma_f32_16x16x32_bf16 v[140:143], v[72:75], v[60:63], v[140:143]
    v_mfma_f32_16x16x32_bf16 v[108:111], v[72:75], v[28:31], v[108:111]
    v_mfma_f32_16x16x32_bf16 v[92:95], v[28:31], v[48:51], v[92:95]
    s_waitcnt lgkmcnt(4)
    v_mfma_f32_16x16x32_bf16 v[144:147], v[76:79], v[48:51], v[144:147]
    ds_read_b64_tr_b16 v[72:73], v27 offset:13440
    v_mfma_f32_16x16x32_bf16 v[148:151], v[76:79], v[52:55], v[148:151]
    ds_read_b64_tr_b16 v[74:75], v27 offset:20096
    s_add_u32 m0, s73, 1024
    v_mfma_f32_16x16x32_bf16 v[152:155], v[76:79], v[56:59], v[152:155]
    buffer_load_dwordx4 v9, s[28:31], s44 offen lds
    v_mfma_f32_16x16x32_bf16 v[156:159], v[76:79], v[60:63], v[156:159]
    v_mfma_f32_16x16x32_bf16 v[96:99], v[28:31], v[52:55], v[96:99]
    s_waitcnt lgkmcnt(4)
    v_mfma_f32_16x16x32_bf16 v[160:163], v[64:67], v[48:51], v[160:163]
    ds_read_b64_tr_b16 v[76:77], v27 offset:13472
    v_mfma_f32_16x16x32_bf16 v[164:167], v[64:67], v[52:55], v[164:167]
    ds_read_b64_tr_b16 v[78:79], v27 offset:20128
    s_add_u32 m0, s73, 2048
    v_mfma_f32_16x16x32_bf16 v[168:171], v[64:67], v[56:59], v[168:171]
    buffer_load_dwordx4 v10, s[28:31], s44 offen lds
    v_mfma_f32_16x16x32_bf16 v[172:175], v[64:67], v[60:63], v[172:175]
    v_mfma_f32_16x16x32_bf16 v[112:115], v[64:67], v[28:31], v[112:115]
    v_mfma_f32_16x16x32_bf16 v[100:103], v[28:31], v[56:59], v[100:103]
    s_waitcnt lgkmcnt(4)
    v_mfma_f32_16x16x32_bf16 v[176:179], v[68:71], v[48:51], v[176:179]
    v_mfma_f32_16x16x32_bf16 v[180:183], v[68:71], v[52:55], v[180:183]
    s_add_u32 m0, s73, 3072
    v_mfma_f32_16x16x32_bf16 v[184:187], v[68:71], v[56:59], v[184:187]
    buffer_load_dwordx4 v11, s[28:31], s44 offen lds
    v_mfma_f32_16x16x32_bf16 v[188:191], v[68:71], v[60:63], v[188:191]
    v_mfma_f32_16x16x32_bf16 v[104:107], v[28:31], v[60:63], v[104:107]
    s_waitcnt vmcnt(11) lgkmcnt(0)
    s_barrier
    ds_read_b128 v[32:35], v15 offset:0
    ds_read_b128 v[36:39], v15 offset:2048
    ds_read_b128 v[40:43], v15 offset:4096
    ds_read_b128 v[44:47], v15 offset:6144
    v_mfma_f32_16x16x32_bf16 v[192:195], v[72:75], v[48:51], v[192:195]
    ds_read_b64_tr_b16 v[64:65], v12 offset:0
    ds_read_b64_tr_b16 v[66:67], v12 offset:6656
    v_mfma_f32_16x16x32_bf16 v[196:199], v[72:75], v[52:55], v[196:199]
    ds_read_b64_tr_b16 v[68:69], v12 offset:32
    ds_read_b64_tr_b16 v[70:71], v12 offset:6688
    v_mfma_f32_16x16x32_bf16 v[200:203], v[72:75], v[56:59], v[200:203]
    v_mfma_f32_16x16x32_bf16 v[204:207], v[72:75], v[60:63], v[204:207]
    v_mfma_f32_16x16x32_bf16 v[116:119], v[72:75], v[28:31], v[116:119]
    v_mfma_f32_16x16x32_bf16 v[208:211], v[76:79], v[48:51], v[208:211]
    ds_read_b64_tr_b16 v[72:73], v12 offset:64
    v_mfma_f32_16x16x32_bf16 v[212:215], v[76:79], v[52:55], v[212:215]
    ds_read_b64_tr_b16 v[74:75], v12 offset:6720
    v_mfma_f32_16x16x32_bf16 v[216:219], v[76:79], v[56:59], v[216:219]
    v_mfma_f32_16x16x32_bf16 v[220:223], v[76:79], v[60:63], v[220:223]
    s_add_u32 s43, s43, s47
    s_add_u32 s44, s44, 128
    s_min_u32 s44, s44, 1152
    s_mov_b32 s75, s70
    s_mov_b32 s70, s71
    s_mov_b32 s71, s72
    s_mov_b32 s72, s75
    v_add_u32 v27, s70, v26
    v_add_u32 v12, s71, v26
    v_add_u32 v13, s70, v24
    v_add_u32 v14, s70, v25
    v_add_u32 v15, s71, v24
    s_add_u32 s45, s45, 1
    s_cmp_lt_u32 s45, 10
    s_cbranch_scc1 K1_LH0
    s_waitcnt lgkmcnt(0)
    s_nop 9
    v_and_b32 v2, 15, v1
    v_lshrrev_b32 v3, 4, v1
    v_lshlrev_b32 v4, 4, v3
    v_add_u32 v4, 141312, v4
    v_cmp_eq_u32 vcc, 0, v2
    s_and_saveexec_b64 s[56:57], vcc
    ds_write_b128 v4, v[108:111] offset:0
    ds_write_b128 v4, v[112:115] offset:128
    ds_write_b128 v4, v[116:119] offset:256
    s_mov_b64 exec, s[56:57]
    v_lshlrev_b32 v7, 3, v2
    v_add_u32 v7, 142336, v7
    v_cmp_eq_u32 vcc, 0, v3
    s_and_saveexec_b64 s[56:57], vcc
    ds_write_b32 v7, v92 offset:0
    ds_write_b32 v7, v96 offset:128
    ds_write_b32 v7, v100 offset:256
    ds_write_b32 v7, v104 offset:384
    s_mov_b64 exec, s[56:57]
    s_waitcnt vmcnt(0) lgkmcnt(0)
    s_barrier
    s_branch K1_EH
K1_H_W1:
    s_mov_b32 s70, 0
    s_mov_b32 s71, 47104
    s_mov_b32 s72, 94208
    v_add_u32 v27, s70, v26
    v_add_u32 v12, s71, v26
    v_add_u32 v13, s70, v24
    v_add_u32 v14, s70, v25
    v_add_u32 v15, s71, v24
    s_barrier
    ds_read_b128 v[32:35], v13 offset:0
    ds_read_b128 v[36:39], v13 offset:2048
    ds_read_b128 v[40:43], v13 offset:4096
    ds_read_b128 v[44:47], v13 offset:6144
    ds_read_b64_tr_b16 v[64:65], v27 offset:0
    ds_read_b64_tr_b16 v[66:67], v27 offset:6656
    ds_read_b64_tr_b16 v[68:69], v27 offset:32
    ds_read_b64_tr_b16 v[70:71], v27 offset:6688
    ds_read_b64_tr_b16 v[72:73], v27 offset:64
    ds_read_b64_tr_b16 v[74:75], v27 offset:6720
    s_mov_b32 s45, 0
K1_LH1:
    s_add_u32 s42, s72, s41
    s_add_u32 s73, s72, s74
    s_waitcnt lgkmcnt(4)
    v_mfma_f32_16x16x32_bf16 v[128:131], v[64:67], v[32:35], v[128:131]
    ds_read_b64_tr_b16 v[76:77], v27 offset:96
    v_mfma_f32_16x16x32_bf16 v[132:135], v[64:67], v[36:39], v[132:135]
    ds_read_b64_tr_b16 v[78:79], v27 offset:6752
    s_add_u32 m0, s42, 0
    v_mfma_f32_16x16x32_bf16 v[136:139], v[64:67], v[40:43], v[136:139]
    buffer_load_dwordx4 v16, s[32:35], s43 offen lds
    s_add_u32 m0, s42, 4096
    v_mfma_f32_16x16x32_bf16 v[140:143], v[64:67], v[44:47], v[140:143]
    buffer_load_dwordx4 v17, s[32:35], s43 offen lds
    v_mfma_f32_16x16x32_bf16 v[108:111], v[64:67], v[28:31], v[108:111]
    v_mfma_f32_16x16x32_bf16 v[92:95], v[32:35], v[32:35], v[92:95]
    ds_read_b128 v[48:51], v14 offset:0
    ds_read_b128 v[52:55], v14 offset:2048
    ds_read_b128 v[56:59], v14 offset:4096
    ds_read_b128 v[60:63], v14 offset:6144
    s_waitcnt lgkmcnt(8)
    v_mfma_f32_16x16x32_bf16 v[144:147], v[68:71], v[32:35], v[144:147]
    ds_read_b64_tr_b16 v[64:65], v27 offset:128
    v_mfma_f32_16x16x32_bf16 v[148:151], v[68:71], v[36:39], v[148:151]
    ds_read_b64_tr_b16 v[66:67], v27 offset:6784
    s_add_u32 m0, s42, 8192
    v_mfma_f32_16x16x32_bf16 v[152:155], v[68:71], v[40:43], v[152:155]
    buffer_load_dwordx4 v18, s[32:35], s43 offen lds
    v_mfma_f32_16x16x32_bf16 v[156:159], v[68:71], v[44:47], v[156:159]
    v_mfma_f32_16x16x32_bf16 v[96:99], v[36:39], v[36:39], v[96:99]
    s_waitcnt lgkmcnt(8)
    v_mfma_f32_16x16x32_bf16 v[160:163], v[72:75], v[32:35], v[160:163]
    ds_read_b64_tr_b16 v[68:69], v27 offset:160
    v_mfma_f32_16x16x32_bf16 v[164:167], v[72:75], v[36:39], v[164:167]
    ds_read_b64_tr_b16 v[70:71], v27 offset:6816
    s_add_u32 m0, s42, 12288
    v_mfma_f32_16x16x32_bf16 v[168:171], v[72:75], v[40:43], v[168:171]
    buffer_load_dwordx4 v19, s[32:35], s43 offen lds
    v_mfma_f32_16x16x32_bf16 v[172:175], v[72:75], v[44:47], v[172:175]
    v_mfma_f32_16x16x32_bf16 v[112:115], v[72:75], v[28:31], v[112:115]
    v_mfma_f32_16x16x32_bf16 v[100:103], v[40:43], v[40:43], v[100:103]
    s_waitcnt lgkmcnt(8)
    v_mfma_f32_16x16x32_bf16 v[176:179], v[76:79], v[32:35], v[176:179]
    ds_read_b64_tr_b16 v[72:73], v27 offset:13312
    v_mfma_f32_16x16x32_bf16 v[180:183], v[76:79], v[36:39], v[180:183]
    ds_read_b64_tr_b16 v[74:75], v27 offset:19968
    s_add_u32 m0, s42, 16384
    v_mfma_f32_16x16x32_bf16 v[184:187], v[76:79], v[40:43], v[184:187]
    buffer_load_dwordx4 v20, s[32:35], s43 offen lds
    v_mfma_f32_16x16x32_bf16 v[188:191], v[76:79], v[44:47], v[188:191]
    v_mfma_f32_16x16x32_bf16 v[104:107], v[44:47], v[44:47], v[104:107]
    s_waitcnt lgkmcnt(4)
    v_mfma_f32_16x16x32_bf16 v[192:195], v[64:67], v[32:35], v[192:195]
    ds_read_b64_tr_b16 v[76:77], v27 offset:13344
    v_mfma_f32_16x16x32_bf16 v[196:199], v[64:67], v[36:39], v[196:199]
    ds_read_b64_tr_b16 v[78:79], v27 offset:20000
    s_add_u32 m0, s42, 20480
    v_mfma_f32_16x16x32_bf16 v[200:203], v[64:67], v[40:43], v[200:203]
    buffer_load_dwordx4 v21, s[32:35], s43 offen lds
    v_mfma_f32_16x16x32_bf16 v[204:207], v[64:67], v[44:47], v[204:207]
    v_mfma_f32_16x16x32_bf16 v[116:119], v[64:67], v[28:31], v[116:119]
    s_waitcnt lgkmcnt(4)
    v_mfma_f32_16x16x32_bf16 v[208:211], v[68:71], v[32:35], v[208:211]
    ds_read_b64_tr_b16 v[64:65], v27 offset:13376
    v_mfma_f32_16x16x32_bf16 v[212:215], v[68:71], v[36:39], v[212:215]
    ds_read_b64_tr_b16 v[66:67], v27 offset:20032
    s_add_u32 m0, s42, 24576
    v_mfma_f32_16x16x32_bf16 v[216:219], v[68:71], v[40:43], v[216:219]
    buffer_load_dwordx4 v22, s[32:35], s43 offen lds
    v_mfma_f32_16x16x32_bf16 v[220:223], v[68:71], v[44:47], v[220:223]
    s_waitcnt lgkmcnt(4)
    v_mfma_f32_16x16x32_bf16 v[128:131], v[72:75], v[48:51], v[128:131]
    ds_read_b64_tr_b16 v[68:69], v27 offset:13408
    v_mfma_f32_16x16x32_bf16 v[132:135], v[72:75], v[52:55], v[132:135]
    ds_read_b64_tr_b16 v[70:71], v27 offset:20064
    s_add_u32 m0, s73, 0
    v_mfma_f32_16x16x32_bf16 v[136:139], v[72:75], v[56:59], v[136:139]
    buffer_load_dwordx4 v8, s[28:31], s44 offen lds
    v_mfma_f32_16x16x32_bf16 v[140:143], v[72:75], v[60:63], v[140:143]
    v_mfma_f32_16x16x32_bf16 v[108:111], v[72:75], v[28:31], v[108:111]
    v_mfma_f32_16x16x32_bf16 v[92:95], v[48:51], v[48:51], v[92:95]
    s_waitcnt lgkmcnt(4)
    v_mfma_f32_16x16x32_bf16 v[144:147], v[76:79], v[48:51], v[144:147]
    ds_read_b64_tr_b16 v[72:73], v27 offset:13440
    v_mfma_f32_16x16x32_bf16 v[148:151], v[76:79], v[52:55], v[148:151]
    ds_read_b64_tr_b16 v[74:75], v27 offset:20096
    s_add_u32 m0, s73, 1024
    v_mfma_f32_16x16x32_bf16 v[152:155], v[76:79], v[56:59], v[152:155]
    buffer_load_dwordx4 v9, s[28:31], s44 offen lds
    v_mfma_f32_16x16x32_bf16 v[156:159], v[76:79], v[60:63], v[156:159]
    v_mfma_f32_16x16x32_bf16 v[96:99], v[52:55], v[52:55], v[96:99]
    s_waitcnt lgkmcnt(4)
    v_mfma_f32_16x16x32_bf16 v[160:163], v[64:67], v[48:51], v[160:163]
    ds_read_b64_tr_b16 v[76:77], v27 offset:13472
    v_mfma_f32_16x16x32_bf16 v[164:167], v[64:67], v[52:55], v[164:167]
    ds_read_b64_tr_b16 v[78:79], v27 offset:20128
    s_add_u32 m0, s73, 2048
    v_mfma_f32_16x16x32_bf16 v[168:171], v[64:67], v[56:59], v[168:171]
    buffer_load_dwordx4 v10, s[28:31], s44 offen lds
    v_mfma_f32_16x16x32_bf16 v[172:175], v[64:67], v[60:63], v[172:175]
    v_mfma_f32_16x16x32_bf16 v[112:115], v[64:67], v[28:31], v[112:115]
    v_mfma_f32_16x16x32_bf16 v[100:103], v[56:59], v[56:59], v[100:103]
    s_waitcnt lgkmcnt(4)
    v_mfma_f32_16x16x32_bf16 v[176:179], v[68:71], v[48:51], v[176:179]
    v_mfma_f32_16x16x32_bf16 v[180:183], v[68:71], v[52:55], v[180:183]
    s_add_u32 m0, s73, 3072
    v_mfma_f32_16x16x32_bf16 v[184:187], v[68:71], v[56:59], v[184:187]
    buffer_load_dwordx4 v11, s[28:31], s44 offen lds
    s_cmp_lg_u32 s45, 0
    s_cbranch_scc1 K1_T_24
    buffer_load_dword v124, v126, s[28:31], 0 offen
    buffer_load_dword v125, v127, s[32:35], 0 offen
K1_T_24:
    v_mfma_f32_16x16x32_bf16 v[188:191], v[68:71], v[60:63], v[188:191]
    v_mfma_f32_16x16x32_bf16 v[104:107], v[60:63], v[60:63], v[104:107]
    s_waitcnt vmcnt(11) lgkmcnt(0)
    s_barrier
    ds_read_b128 v[32:35], v15 offset:0
    ds_read_b128 v[36:39], v15 offset:2048
    ds_read_b128 v[40:43], v15 offset:4096
    ds_read_b128 v[44:47], v15 offset:6144
    v_mfma_f32_16x16x32_bf16 v[192:195], v[72:75], v[48:51], v[192:195]
    ds_read_b64_tr_b16 v[64:65], v12 offset:0
    ds_read_b64_tr_b16 v[66:67], v12 offset:6656
    v_mfma_f32_16x16x32_bf16 v[196:199], v[72:75], v[52:55], v[196:199]
    ds_read_b64_tr_b16 v[68:69], v12 offset:32
    ds_read_b64_tr_b16 v[70:71], v12 offset:6688
    v_mfma_f32_16x16x32_bf16 v[200:203], v[72:75], v[56:59], v[200:203]
    v_mfma_f32_16x16x32_bf16 v[204:207], v[72:75], v[60:63], v[204:207]
    v_mfma_f32_16x16x32_bf16 v[116:119], v[72:75], v[28:31], v[116:119]
    v_mfma_f32_16x16x32_bf16 v[208:211], v[76:79], v[48:51], v[208:211]
    ds_read_b64_tr_b16 v[72:73], v12 offset:64
    v_mfma_f32_16x16x32_bf16 v[212:215], v[76:79], v[52:55], v[212:215]
    ds_read_b64_tr_b16 v[74:75], v12 offset:6720
    v_mfma_f32_16x16x32_bf16 v[216:219], v[76:79], v[56:59], v[216:219]
    v_mfma_f32_16x16x32_bf16 v[220:223], v[76:79], v[60:63], v[220:223]
    s_add_u32 s43, s43, s47
    s_add_u32 s44, s44, 128
    s_min_u32 s44, s44, 1152
    s_mov_b32 s75, s70
    s_mov_b32 s70, s71
    s_mov_b32 s71, s72
    s_mov_b32 s72, s75
    v_add_u32 v27, s70, v26
    v_add_u32 v12, s71, v26
    v_add_u32 v13, s70, v24
    v_add_u32 v14, s70, v25
    v_add_u32 v15, s71, v24
    s_add_u32 s45, s45, 1
    s_cmp_lt_u32 s45, 10
    s_cbranch_scc1 K1_LH1
    s_waitcnt lgkmcnt(0)
    s_nop 9
    v_and_b32 v2, 15, v1
    v_lshrrev_b32 v3, 4, v1
    v_lshlrev_b32 v4, 4, v3
    v_add_u32 v4, 141312, v4
    v_cmp_eq_u32 vcc, 0, v2
    s_and_saveexec_b64 s[56:57], vcc
    ds_write_b128 v4, v[108:111] offset:384
    ds_write_b128 v4, v[112:115] offset:512
    ds_write_b128 v4, v[116:119] offset:640
    s_mov_b64 exec, s[56:57]
    v_lshlrev_b32 v7, 3, v2
    v_add_u32 v7, 142336, v7
    v_and_b32 v5, 3, v2
    v_lshrrev_b32 v6, 2, v2
    v_cmp_eq_u32 s[62:63], 1, v5
    v_cmp_eq_u32 s[64:65], 2, v5
    v_cmp_eq_u32 s[66:67], 3, v5
    v_cmp_eq_u32 vcc, v6, v3
    s_and_saveexec_b64 s[56:57], vcc
    v_mov_b32 v8, v92
    v_cndmask_b32 v8, v8, v93, s[62:63]
    v_cndmask_b32 v8, v8, v94, s[64:65]
    v_cndmask_b32 v8, v8, v95, s[66:67]
    ds_write_b32 v7, v8 offset:4
    s_nop 0
    v_mov_b32 v8, v96
    v_cndmask_b32 v8, v8, v97, s[62:63]
    v_cndmask_b32 v8, v8, v98, s[64:65]
    v_cndmask_b32 v8, v8, v99, s[66:67]
    ds_write_b32 v7, v8 offset:132
    s_nop 0
    v_mov_b32 v8, v100
    v_cndmask_b32 v8, v8, v101, s[62:63]
    v_cndmask_b32 v8, v8, v102, s[64:65]
    v_cndmask_b32 v8, v8, v103, s[66:67]
    ds_write_b32 v7, v8 offset:260
    s_nop 0
    v_mov_b32 v8, v104
    v_cndmask_b32 v8, v8, v105, s[62:63]
    v_cndmask_b32 v8, v8, v106, s[64:65]
    v_cndmask_b32 v8, v8, v107, s[66:67]
    ds_write_b32 v7, v8 offset:388
    s_nop 0
    s_mov_b64 exec, s[56:57]
    s_waitcnt vmcnt(0) lgkmcnt(0)
    s_barrier
    s_branch K1_EH
K1_H_W2:
    s_mov_b32 s70, 0
    s_mov_b32 s71, 47104
    s_mov_b32 s72, 94208
    v_add_u32 v27, s70, v26
    v_add_u32 v12, s71, v26
    v_add_u32 v13, s70, v24
    v_add_u32 v14, s70, v25
    v_add_u32 v15, s71, v24
    s_barrier
    ds_read_b128 v[32:35], v13 offset:0
    ds_read_b128 v[36:39], v13 offset:2048
    ds_read_b128 v[40:43], v13 offset:4096
    ds_read_b128 v[44:47], v13 offset:6144
    ds_read_b64_tr_b16 v[64:65], v27 offset:0
    ds_read_b64_tr_b16 v[66:67], v27 offset:6656
    ds_read_b64_tr_b16 v[68:69], v27 offset:32
    ds_read_b64_tr_b16 v[70:71], v27 offset:6688
    ds_read_b64_tr_b16 v[72:73], v27 offset:64
    ds_read_b64_tr_b16 v[74:75], v27 offset:6720
    s_mov_b32 s45, 0
K1_LH2:
    s_add_u32 s42, s72, s41
    s_add_u32 s73, s72, s74
    s_waitcnt lgkmcnt(4)
    v_mfma_f32_16x16x32_bf16 v[128:131], v[64:67], v[32:35], v[128:131]
    ds_read_b64_tr_b16 v[76:77], v27 offset:96
    v_mfma_f32_16x16x32_bf16 v[132:135], v[64:67], v[36:39], v[132:135]
    ds_read_b64_tr_b16 v[78:79], v27 offset:6752
    s_add_u32 m0, s42, 0
    v_mfma_f32_16x16x32_bf16 v[136:139], v[64:67], v[40:43], v[136:139]
    buffer_load_dwordx4 v16, s[32:35], s43 offen lds
    v_mfma_f32_16x16x32_bf16 v[140:143], v[64:67], v[44:47], v[140:143]
    v_mfma_f32_16x16x32_bf16 v[92:95], v[28:31], v[32:35], v[92:95]
    ds_read_b128 v[48:51], v14 offset:0
    ds_read_b128 v[52:55], v14 offset:2048
    ds_read_b128 v[56:59], v14 offset:4096
    ds_read_b128 v[60:63], v14 offset:6144
    s_waitcnt lgkmcnt(8)
    v_mfma_f32_16x16x32_bf16 v[144:147], v[68:71], v[32:35], v[144:147]
    ds_read_b64_tr_b16 v[64:65], v27 offset:128
    v_mfma_f32_16x16x32_bf16 v[148:151], v[68:71], v[36:39], v[148:151]
    ds_read_b64_tr_b16 v[66:67], v27 offset:6784
    s_add_u32 m0, s42, 4096
    v_mfma_f32_16x16x32_bf16 v[152:155], v[68:71], v[40:43], v[152:155]
    buffer_load_dwordx4 v17, s[32:35], s43 offen lds
    v_mfma_f32_16x16x32_bf16 v[156:159], v[68:71], v[44:47], v[156:159]
    v_mfma_f32_16x16x32_bf16 v[108:111], v[68:71], v[28:31], v[108:111]
    v_mfma_f32_16x16x32_bf16 v[96:99], v[28:31], v[36:39], v[96:99]
    s_waitcnt lgkmcnt(8)
    v_mfma_f32_16x16x32_bf16 v[160:163], v[72:75], v[32:35], v[160:163]
    ds_read_b64_tr_b16 v[68:69], v27 offset:160
    v_mfma_f32_16x16x32_bf16 v[164:167], v[72:75], v[36:39], v[164:167]
    ds_read_b64_tr_b16 v[70:71], v27 offset:6816
    s_add_u32 m0, s42, 8192
    v_mfma_f32_16x16x32_bf16 v[168:171], v[72:75], v[40:43], v[168:171]
    buffer_load_dwordx4 v18, s[32:35], s43 offen lds
    v_mfma_f32_16x16x32_bf16 v[172:175], v[72:75], v[44:47], v[172:175]
    v_mfma_f32_16x16x32_bf16 v[100:103], v[28:31], v[40:43], v[100:103]
    s_waitcnt lgkmcnt(8)
    v_mfma_f32_16x16x32_bf16 v[176:179], v[76:79], v[32:35], v[176:179]
    ds_read_b64_tr_b16 v[72:73], v27 offset:13312
    v_mfma_f32_16x16x32_bf16 v[180:183], v[76:79], v[36:39], v[180:183]
    ds_read_b64_tr_b16 v[74:75], v27 offset:19968
    s_add_u32 m0, s42, 12288
    v_mfma_f32_16x16x32_bf16 v[184:187], v[76:79], v[40:43], v[184:187]
    buffer_load_dwordx4 v19, s[32:35], s43 offen lds
    v_mfma_f32_16x16x32_bf16 v[188:191], v[76:79], v[44:47], v[188:191]
    v_mfma_f32_16x16x32_bf16 v[112:115], v[76:79], v[28:31], v[112:115]
    v_mfma_f32_16x16x32_bf16 v[104:107], v[28:31], v[44:47], v[104:107]
    s_waitcnt lgkmcnt(4)
    v_mfma_f32_16x16x32_bf16 v[192:195], v[64:67], v[32:35], v[192:195]
    ds_read_b64_tr_b16 v[76:77], v27 offset:13344
    v_mfma_f32_16x16x32_bf16 v[196:199], v[64:67], v[36:39], v[196:199]
    ds_read_b64_tr_b16 v[78:79], v27 offset:20000
    s_add_u32 m0, s42, 16384
    v_mfma_f32_16x16x32_bf16 v[200:203], v[64:67], v[40:43], v[200:203]
    buffer_load_dwordx4 v20, s[32:35], s43 offen lds
    v_mfma_f32_16x16x32_bf16 v[204:207], v[64:67], v[44:47], v[204:207]
    s_waitcnt lgkmcnt(4)
    v_mfma_f32_16x16x32_bf16 v[208:211], v[68:71], v[32:35], v[208:211]
    ds_read_b64_tr_b16 v[64:65], v27 offset:13376
    v_mfma_f32_16x16x32_bf16 v[212:215], v[68:71], v[36:39], v[212:215]
    ds_read_b64_tr_b16 v[66:67], v27 offset:20032
    s_add_u32 m0, s42, 20480
    v_mfma_f32_16x16x32_bf16 v[216:219], v[68:71], v[40:43], v[216:219]
    buffer_load_dwordx4 v21, s[32:35], s43 offen lds
    v_mfma_f32_16x16x32_bf16 v[220:223], v[68:71], v[44:47], v[220:223]
    v_mfma_f32_16x16x32_bf16 v[116:119], v[68:71], v[28:31], v[116:119]
    s_waitcnt lgkmcnt(4)
    v_mfma_f32_16x16x32_bf16 v[128:131], v[72:75], v[48:51], v[128:131]
    ds_read_b64_tr_b16 v[68:69], v27 offset:13408
    v_mfma_f32_16x16x32_bf16 v[132:135], v[72:75], v[52:55], v[132:135]
    ds_read_b64_tr_b16 v[70:71], v27 offset:20064
    s_add_u32 m0, s73, 0
    v_mfma_f32_16x16x32_bf16 v[136:139], v[72:75], v[56:59], v[136:139]
    buffer_load_dwordx4 v8, s[28:31], s44 offen lds
    v_mfma_f32_16x16x32_bf16 v[140:143], v[72:75], v[60:63], v[140:143]
    v_mfma_f32_16x16x32_bf16 v[92:95], v[28:31], v[48:51], v[92:95]
    s_waitcnt lgkmcnt(4)
    v_mfma_f32_16x16x32_bf16 v[144:147], v[76:79], v[48:51], v[144:147]
    ds_read_b64_tr_b16 v[72:73], v27 offset:13440
    v_mfma_f32_16x16x32_bf16 v[148:151], v[76:79], v[52:55], v[148:151]
    ds_read_b64_tr_b16 v[74:75], v27 offset:20096
    s_add_u32 m0, s73, 1024
    v_mfma_f32_16x16x32_bf16 v[152:155], v[76:79], v[56:59], v[152:155]
    buffer_load_dwordx4 v9, s[28:31], s44 offen lds
    v_mfma_f32_16x16x32_bf16 v[156:159], v[76:79], v[60:63], v[156:159]
    v_mfma_f32_16x16x32_bf16 v[108:111], v[76:79], v[28:31], v[108:111]
    v_mfma_f32_16x16x32_bf16 v[96:99], v[28:31], v[52:55], v[96:99]
    s_waitcnt lgkmcnt(4)
    v_mfma_f32_16x16x32_bf16 v[160:163], v[64:67], v[48:51], v[160:163]
    ds_read_b64_tr_b16 v[76:77], v27 offset:13472
    v_mfma_f32_16x16x32_bf16 v[164:167], v[64:67], v[52:55], v[164:167]
    ds_read_b64_tr_b16 v[78:79], v27 offset:20128
    s_add_u32 m0, s73, 2048
    v_mfma_f32_16x16x32_bf16 v[168:171], v[64:67], v[56:59], v[168:171]
    buffer_load_dwordx4 v10, s[28:31], s44 offen lds
    v_mfma_f32_16x16x32_bf16 v[172:175], v[64:67], v[60:63], v[172:175]
    v_mfma_f32_16x16x32_bf16 v[100:103], v[28:31], v[56:59], v[100:103]
    s_waitcnt lgkmcnt(4)
    v_mfma_f32_16x16x32_bf16 v[176:179], v[68:71], v[48:51], v[176:179]
    v_mfma_f32_16x16x32_bf16 v[180:183], v[68:71], v[52:55], v[180:183]
    s_add_u32 m0, s73, 3072
    v_mfma_f32_16x16x32_bf16 v[184:187], v[68:71], v[56:59], v[184:187]
    buffer_load_dwordx4 v11, s[28:31], s44 offen lds
    s_cmp_lg_u32 s45, 2
    s_cbranch_scc1 K1_T_25
    buffer_load_dword v124, v126, s[28:31], 0 offen
    buffer_load_dword v125, v127, s[32:35], 0 offen
K1_T_25:
    v_mfma_f32_16x16x32_bf16 v[188:191], v[68:71], v[60:63], v[188:191]
    v_mfma_f32_16x16x32_bf16 v[112:115], v[68:71], v[28:31], v[112:115]
    v_mfma_f32_16x16x32_bf16 v[104:107], v[28:31], v[60:63], v[104:107]
    s_waitcnt vmcnt(10) lgkmcnt(0)
    s_barrier
    ds_read_b128 v[32:35], v15 offset:0
    ds_read_b128 v[36:39], v15 offset:2048
    ds_read_b128 v[40:43], v15 offset:4096
    ds_read_b128 v[44:47], v15 offset:6144
    v_mfma_f32_16x16x32_bf16 v[192:195], v[72:75], v[48:51], v[192:195]
    ds_read_b64_tr_b16 v[64:65], v12 offset:0
    ds_read_b64_tr_b16 v[66:67], v12 offset:6656
    v_mfma_f32_16x16x32_bf16 v[196:199], v[72:75], v[52:55], v[196:199]
    ds_read_b64_tr_b16 v[68:69], v12 offset:32
    ds_read_b64_tr_b16 v[70:71], v12 offset:6688
    v_mfma_f32_16x16x32_bf16 v[200:203], v[72:75], v[56:59], v[200:203]
    v_mfma_f32_16x16x32_bf16 v[204:207], v[72:75], v[60:63], v[204:207]
    v_mfma_f32_16x16x32_bf16 v[208:211], v[76:79], v[48:51], v[208:211]
    ds_read_b64_tr_b16 v[72:73], v12 offset:64
    v_mfma_f32_16x16x32_bf16 v[212:215], v[76:79], v[52:55], v[212:215]
    ds_read_b64_tr_b16 v[74:75], v12 offset:6720
    v_mfma_f32_16x16x32_bf16 v[216:219], v[76:79], v[56:59], v[216:219]
    v_mfma_f32_16x16x32_bf16 v[220:223], v[76:79], v[60:63], v[220:223]
    v_mfma_f32_16x16x32_bf16 v[116:119], v[76:79], v[28:31], v[116:119]
    s_add_u32 s43, s43, s47
    s_add_u32 s44, s44, 128
    s_min_u32 s44, s44, 1152
    s_mov_b32 s75, s70
    s_mov_b32 s70, s71
    s_mov_b32 s71, s72
    s_mov_b32 s72, s75
    v_add_u32 v27, s70, v26
    v_add_u32 v12, s71, v26
    v_add_u32 v13, s70, v24
    v_add_u32 v14, s70, v25
    v_add_u32 v15, s71, v24
    s_add_u32 s45, s45, 1
    s_cmp_lt_u32 s45, 10
    s_cbranch_scc1 K1_LH2
    s_waitcnt lgkmcnt(0)
    s_nop 9
    v_and_b32 v2, 15, v1
    v_lshrrev_b32 v3, 4, v1
    v_lshlrev_b32 v4, 4, v3
    v_add_u32 v4, 141312, v4
    v_cmp_eq_u32 vcc, 0, v2
    s_and_saveexec_b64 s[56:57], vcc
    ds_write_b128 v4, v[108:111] offset:64
    ds_write_b128 v4, v[112:115] offset:192
    ds_write_b128 v4, v[116:119] offset:320
    s_mov_b64 exec, s[56:57]
    v_lshlrev_b32 v7, 3, v2
    v_add_u32 v7, 142848, v7
    v_cmp_eq_u32 vcc, 0, v3
    s_and_saveexec_b64 s[56:57], vcc
    ds_write_b32 v7, v92 offset:0
    ds_write_b32 v7, v96 offset:128
    ds_write_b32 v7, v100 offset:256
    ds_write_b32 v7, v104 offset:384
    s_mov_b64 exec, s[56:57]
    s_waitcnt vmcnt(0) lgkmcnt(0)
    s_barrier
    s_branch K1_EH
K1_H_W3:
    s_mov_b32 s70, 0
    s_mov_b32 s71, 47104
    s_mov_b32 s72, 94208
    v_add_u32 v27, s70, v26
    v_add_u32 v12, s71, v26
    v_add_u32 v13, s70, v24
    v_add_u32 v14, s70, v25
    v_add_u32 v15, s71, v24
    s_barrier
    ds_read_b128 v[32:35], v13 offset:0
    ds_read_b128 v[36:39], v13 offset:2048
    ds_read_b128 v[40:43], v13 offset:4096
    ds_read_b128 v[44:47], v13 offset:6144
    ds_read_b64_tr_b16 v[64:65], v27 offset:0
    ds_read_b64_tr_b16 v[66:67], v27 offset:6656
    ds_read_b64_tr_b16 v[68:69], v27 offset:32
    ds_read_b64_tr_b16 v[70:71], v27 offset:6688
    ds_read_b64_tr_b16 v[72:73], v27 offset:64
    ds_read_b64_tr_b16 v[74:75], v27 offset:6720
    s_mov_b32 s45, 0
K1_LH3:
    s_add_u32 s42, s72, s41
    s_add_u32 s73, s72, s74
    s_waitcnt lgkmcnt(4)
    v_mfma_f32_16x16x32_bf16 v[128:131], v[64:67], v[32:35], v[128:131]
    ds_read_b64_tr_b16 v[76:77], v27 offset:96
    v_mfma_f32_16x16x32_bf16 v[132:135], v[64:67], v[36:39], v[132:135]
    ds_read_b64_tr_b16 v[78:79], v27 offset:6752
    s_add_u32 m0, s42, 0
    v_mfma_f32_16x16x32_bf16 v[136:139], v[64:67], v[40:43], v[136:139]
    buffer_load_dwordx4 v16, s[32:35], s43 offen lds
    v_mfma_f32_16x16x32_bf16 v[140:143], v[64:67], v[44:47], v[140:143]
    v_mfma_f32_16x16x32_bf16 v[92:95], v[32:35], v[32:35], v[92:95]
    ds_read_b128 v[48:51], v14 offset:0
    ds_read_b128 v[52:55], v14 offset:2048
    ds_read_b128 v[56:59], v14 offset:4096
    ds_read_b128 v[60:63], v14 offset:6144
    s_waitcnt lgkmcnt(8)
    v_mfma_f32_16x16x32_bf16 v[144:147], v[68:71], v[32:35], v[144:147]
    ds_read_b64_tr_b16 v[64:65], v27 offset:128
    v_mfma_f32_16x16x32_bf16 v[148:151], v[68:71], v[36:39], v[148:151]
    ds_read_b64_tr_b16 v[66:67], v27 offset:6784
    s_add_u32 m0, s42, 4096
    v_mfma_f32_16x16x32_bf16 v[152:155], v[68:71], v[40:43], v[152:155]
    buffer_load_dwordx4 v17, s[32:35], s43 offen lds
    v_mfma_f32_16x16x32_bf16 v[156:159], v[68:71], v[44:47], v[156:159]
    v_mfma_f32_16x16x32_bf16 v[108:111], v[68:71], v[28:31], v[108:111]
    v_mfma_f32_16x16x32_bf16 v[96:99], v[36:39], v[36:39], v[96:99]
    s_waitcnt lgkmcnt(8)
    v_mfma_f32_16x16x32_bf16 v[160:163], v[72:75], v[32:35], v[160:163]
    ds_read_b64_tr_b16 v[68:69], v27 offset:160
    v_mfma_f32_16x16x32_bf16 v[164:167], v[72:75], v[36:39], v[164:167]
    ds_read_b64_tr_b16 v[70:71], v27 offset:6816
    s_add_u32 m0, s42, 8192
    v_mfma_f32_16x16x32_bf16 v[168:171], v[72:75], v[40:43], v[168:171]
    buffer_load_dwordx4 v18, s[32:35], s43 offen lds
    v_mfma_f32_16x16x32_bf16 v[172:175], v[72:75], v[44:47], v[172:175]
    v_mfma_f32_16x16x32_bf16 v[100:103], v[40:43], v[40:43], v[100:103]
    s_waitcnt lgkmcnt(8)
    v_mfma_f32_16x16x32_bf16 v[176:179], v[76:79], v[32:35], v[176:179]
    ds_read_b64_tr_b16 v[72:73], v27 offset:13312
    v_mfma_f32_16x16x32_bf16 v[180:183], v[76:79], v[36:39], v[180:183]
    ds_read_b64_tr_b16 v[74:75], v27 offset:19968
    s_add_u32 m0, s42, 12288
    v_mfma_f32_16x16x32_bf16 v[184:187], v[76:79], v[40:43], v[184:187]
    buffer_load_dwordx4 v19, s[32:35], s43 offen lds
    v_mfma_f32_16x16x32_bf16 v[188:191], v[76:79], v[44:47], v[188:191]
    v_mfma_f32_16x16x32_bf16 v[112:115], v[76:79], v[28:31], v[112:115]
    v_mfma_f32_16x16x32_bf16 v[104:107], v[44:47], v[44:47], v[104:107]
    s_waitcnt lgkmcnt(4)
    v_mfma_f32_16x16x32_bf16 v[192:195], v[64:67], v[32:35], v[192:195]
    ds_read_b64_tr_b16 v[76:77], v27 offset:13344
    v_mfma_f32_16x16x32_bf16 v[196:199], v[64:67], v[36:39], v[196:199]
    ds_read_b64_tr_b16 v[78:79], v27 offset:20000
    s_add_u32 m0, s42, 16384
    v_mfma_f32_16x16x32_bf16 v[200:203], v[64:67], v[40:43], v[200:203]
    buffer_load_dwordx4 v20, s[32:35], s43 offen lds
    v_mfma_f32_16x16x32_bf16 v[204:207], v[64:67], v[44:47], v[204:207]
    s_waitcnt lgkmcnt(4)
    v_mfma_f32_16x16x32_bf16 v[208:211], v[68:71], v[32:35], v[208:211]
    ds_read_b64_tr_b16 v[64:65], v27 offset:13376
    v_mfma_f32_16x16x32_bf16 v[212:215], v[68:71], v[36:39], v[212:215]
    ds_read_b64_tr_b16 v[66:67], v27 offset:20032
    s_add_u32 m0, s42, 20480
    v_mfma_f32_16x16x32_bf16 v[216:219], v[68:71], v[40:43], v[216:219]
    buffer_load_dwordx4 v21, s[32:35], s43 offen lds
    v_mfma_f32_16x16x32_bf16 v[220:223], v[68:71], v[44:47], v[220:223]
    v_mfma_f32_16x16x32_bf16 v[116:119], v[68:71], v[28:31], v[116:119]
    s_waitcnt lgkmcnt(4)
    v_mfma_f32_16x16x32_bf16 v[128:131], v[72:75], v[48:51], v[128:131]
    ds_read_b64_tr_b16 v[68:69], v27 offset:13408
    v_mfma_f32_16x16x32_bf16 v[132:135], v[72:75], v[52:55], v[132:135]
    ds_read_b64_tr_b16 v[70:71], v27 offset:20064
    s_add_u32 m0, s73, 0
    v_mfma_f32_16x16x32_bf16 v[136:139], v[72:75], v[56:59], v[136:139]
    buffer_load_dwordx4 v8, s[28:31], s44 offen lds
    v_mfma_f32_16x16x32_bf16 v[140:143], v[72:75], v[60:63], v[140:143]
    v_mfma_f32_16x16x32_bf16 v[92:95], v[48:51], v[48:51], v[92:95]
    s_waitcnt lgkmcnt(4)
    v_mfma_f32_16x16x32_bf16 v[144:147], v[76:79], v[48:51], v[144:147]
    ds_read_b64_tr_b16 v[72:73], v27 offset:13440
    v_mfma_f32_16x16x32_bf16 v[148:151], v[76:79], v[52:55], v[148:151]
    ds_read_b64_tr_b16 v[74:75], v27 offset:20096
    s_add_u32 m0, s73, 1024
    v_mfma_f32_16x16x32_bf16 v[152:155], v[76:79], v[56:59], v[152:155]
    buffer_load_dwordx4 v9, s[28:31], s44 offen lds
    v_mfma_f32_16x16x32_bf16 v[156:159], v[76:79], v[60:63], v[156:159]
    v_mfma_f32_16x16x32_bf16 v[108:111], v[76:79], v[28:31], v[108:111]
    v_mfma_f32_16x16x32_bf16 v[96:99], v[52:55], v[52:55], v[96:99]
    s_waitcnt lgkmcnt(4)
    v_mfma_f32_16x16x32_bf16 v[160:163], v[64:67], v[48:51], v[160:163]
    ds_read_b64_tr_b16 v[76:77], v27 offset:13472
    v_mfma_f32_16x16x32_bf16 v[164:167], v[64:67], v[52:55], v[164:167]
    ds_read_b64_tr_b16 v[78:79], v27 offset:20128
    s_add_u32 m0, s73, 2048
    v_mfma_f32_16x16x32_bf16 v[168:171], v[64:67], v[56:59], v[168:171]
    buffer_load_dwordx4 v10, s[28:31], s44 offen lds
    v_mfma_f32_16x16x32_bf16 v[172:175], v[64:67], v[60:63], v[172:175]
    v_mfma_f32_16x16x32_bf16 v[100:103], v[56:59], v[56:59], v[100:103]
    s_waitcnt lgkmcnt(4)
    v_mfma_f32_16x16x32_bf16 v[176:179], v[68:71], v[48:51], v[176:179]
    v_mfma_f32_16x16x32_bf16 v[180:183], v[68:71], v[52:55], v[180:183]
    s_add_u32 m0, s73, 3072
    v_mfma_f32_16x16x32_bf16 v[184:187], v[68:71], v[56:59], v[184:187]
    buffer_load_dwordx4 v11, s[28:31], s44 offen lds
    s_cmp_lg_u32 s45, 4
    s_cbranch_scc1 K1_T_26
    buffer_load_dword v124, v126, s[28:31], 0 offen
    buffer_load_dword v125, v127, s[32:35], 0 offen
K1_T_26:
    v_mfma_f32_16x16x32_bf16 v[188:191], v[68:71], v[60:63], v[188:191]
    v_mfma_f32_16x16x32_bf16 v[112:115], v[68:71], v[28:31], v[112:115]
    v_mfma_f32_16x16x32_bf16 v[104:107], v[60:63], v[60:63], v[104:107]
    s_waitcnt vmcnt(10) lgkmcnt(0)
    s_barrier
    ds_read_b128 v[32:35], v15 offset:0
    ds_read_b128 v[36:39], v15 offset:2048
    ds_read_b128 v[40:43], v15 offset:4096
    ds_read_b128 v[44:47], v15 offset:6144
    v_mfma_f32_16x16x32_bf16 v[192:195], v[72:75], v[48:51], v[192:195]
    ds_read_b64_tr_b16 v[64:65], v12 offset:0
    ds_read_b64_tr_b16 v[66:67], v12 offset:6656
    v_mfma_f32_16x16x32_bf16 v[196:199], v[72:75], v[52:55], v[196:199]
    ds_read_b64_tr_b16 v[68:69], v12 offset:32
    ds_read_b64_tr_b16 v[70:71], v12 offset:6688
    v_mfma_f32_16x16x32_bf16 v[200:203], v[72:75], v[56:59], v[200:203]
    v_mfma_f32_16x16x32_bf16 v[204:207], v[72:75], v[60:63], v[204:207]
    v_mfma_f32_16x16x32_bf16 v[208:211], v[76:79], v[48:51], v[208:211]
    ds_read_b64_tr_b16 v[72:73], v12 offset:64
    v_mfma_f32_16x16x32_bf16 v[212:215], v[76:79], v[52:55], v[212:215]
    ds_read_b64_tr_b16 v[74:75], v12 offset:6720
    v_mfma_f32_16x16x32_bf16 v[216:219], v[76:79], v[56:59], v[216:219]
    v_mfma_f32_16x16x32_bf16 v[220:223], v[76:79], v[60:63], v[220:223]
    v_mfma_f32_16x16x32_bf16 v[116:119], v[76:79], v[28:31], v[116:119]
    s_add_u32 s43, s43, s47
    s_add_u32 s44, s44, 128
    s_min_u32 s44, s44, 1152
    s_mov_b32 s75, s70
    s_mov_b32 s70, s71
    s_mov_b32 s71, s72
    s_mov_b32 s72, s75
    v_add_u32 v27, s70, v26
    v_add_u32 v12, s71, v26
    v_add_u32 v13, s70, v24
    v_add_u32 v14, s70, v25
    v_add_u32 v15, s71, v24
    s_add_u32 s45, s45, 1
    s_cmp_lt_u32 s45, 10
    s_cbranch_scc1 K1_LH3
    s_waitcnt lgkmcnt(0)
    s_nop 9
    v_and_b32 v2, 15, v1
    v_lshrrev_b32 v3, 4, v1
    v_lshlrev_b32 v4, 4, v3
    v_add_u32 v4, 141312, v4
    v_cmp_eq_u32 vcc, 0, v2
    s_and_saveexec_b64 s[56:57], vcc
    ds_write_b128 v4, v[108:111] offset:448
    ds_write_b128 v4, v[112:115] offset:576
    ds_write_b128 v4, v[116:119] offset:704
    s_mov_b64 exec, s[56:57]
    v_lshlrev_b32 v7, 3, v2
    v_add_u32 v7, 142848, v7
    v_and_b32 v5, 3, v2
    v_lshrrev_b32 v6, 2, v2
    v_cmp_eq_u32 s[62:63], 1, v5
    v_cmp_eq_u32 s[64:65], 2, v5
    v_cmp_eq_u32 s[66:67], 3, v5
    v_cmp_eq_u32 vcc, v6, v3
    s_and_saveexec_b64 s[56:57], vcc
    v_mov_b32 v8, v92
    v_cndmask_b32 v8, v8, v93, s[62:63]
    v_cndmask_b32 v8, v8, v94, s[64:65]
    v_cndmask_b32 v8, v8, v95, s[66:67]
    ds_write_b32 v7, v8 offset:4
    s_nop 0
    v_mov_b32 v8, v96
    v_cndmask_b32 v8, v8, v97, s[62:63]
    v_cndmask_b32 v8, v8, v98, s[64:65]
    v_cndmask_b32 v8, v8, v99, s[66:67]
    ds_write_b32 v7, v8 offset:132
    s_nop 0
    v_mov_b32 v8, v100
    v_cndmask_b32 v8, v8, v101, s[62:63]
    v_cndmask_b32 v8, v8, v102, s[64:65]
    v_cndmask_b32 v8, v8, v103, s[66:67]
    ds_write_b32 v7, v8 offset:260
    s_nop 0
    v_mov_b32 v8, v104
    v_cndmask_b32 v8, v8, v105, s[62:63]
    v_cndmask_b32 v8, v8, v106, s[64:65]
    v_cndmask_b32 v8, v8, v107, s[66:67]
    ds_write_b32 v7, v8 offset:388
    s_nop 0
    s_mov_b64 exec, s[56:57]
    s_waitcnt vmcnt(0) lgkmcnt(0)
    s_barrier
    s_branch K1_EH
K1_EH:
    v_and_b32 v2, 15, v1
    v_lshrrev_b32 v3, 4, v1
    s_cmp_ge_u32 s26, 2
    s_cbranch_scc1 K1_S2_27
    s_lshl_b32 s3, s26, 9
    s_add_u32 s3, s3, 142336
    v_lshlrev_b32 v7, 3, v1
    v_add_u32 v7, s3, v7
    ds_read_b64 v[8:9], v7
    s_waitcnt lgkmcnt(0)
    v_mul_f32 v9, 0x3acccccd, v9
    v_mul_f32 v8, 0x3acccccd, v8
    v_fma_f32 v9, -v8, v8, v9
    v_max_f32 v9, 0, v9
    v_add_f32 v9, 0x3727c5ac, v9
    v_rsq_f32 v10, v9
    s_nop 5
    v_mul_f32 v11, v8, v10
    v_sub_f32 v11, 0, v11
    ds_write_b64 v7, v[10:11]
    s_waitcnt lgkmcnt(0)
K1_S2_27:
    s_barrier
    s_lshr_b32 s58, s26, 1
    s_lshl_b32 s58, s58, 9
    s_add_u32 s58, s58, 142336
    s_and_b32 s57, s26, 1
    v_lshlrev_b32 v7, 3, v2
    v_add_u32 v7, s58, v7
    ds_read_b64 v[32:33], v7 offset:0
    ds_read_b64 v[34:35], v7 offset:128
    ds_read_b64 v[36:37], v7 offset:256
    ds_read_b64 v[38:39], v7 offset:384
    v_lshlrev_b32 v4, 4, v3
    s_mul_i32 s61, s57, 384
    s_add_u32 s61, s61, 141312
    v_add_u32 v4, s61, v4
    s_lshl_b32 s60, s36, 3
    s_lshr_b32 s61, s26, 1
    s_lshl_b32 s61, s61, 2
    s_add_u32 s60, s60, s61
    s_mul_i32 s60, s60, 48
    s_mul_i32 s61, s39, 6
    s_add_u32 s60, s60, s61
    s_mul_i32 s61, s57, 3
    s_add_u32 s60, s60, s61
    s_lshl_b32 s60, s60, 10
    v_lshlrev_b32 v6, 4, v1
    ds_read_b128 v[64:67], v4 offset:0
    ds_read_b128 v[68:71], v4 offset:64
    ds_read_b128 v[72:75], v4 offset:128
    ds_read_b128 v[76:79], v4 offset:192
    ds_read_b128 v[80:83], v4 offset:256
    ds_read_b128 v[84:87], v4 offset:320
    s_waitcnt lgkmcnt(0)
    v_lshlrev_b32 v88, 16, v224
    v_and_b32 v89, 0xffff0000, v224
    v_lshlrev_b32 v90, 16, v225
    v_and_b32 v91, 0xffff0000, v225
    v_lshlrev_b32 v92, 16, v226
    v_and_b32 v93, 0xffff0000, v226
    v_lshlrev_b32 v94, 16, v227
    v_and_b32 v95, 0xffff0000, v227
    v_fma_f32 v8, v33, v64, v88
    v_fma_f32 v9, v33, v65, v89
    v_fma_f32 v10, v33, v66, v90
    v_fma_f32 v11, v33, v67, v91
    v_fma_f32 v8, v128, v32, v8
    v_fma_f32 v9, v129, v32, v9
    v_fma_f32 v10, v130, v32, v10
    v_fma_f32 v11, v131, v32, v11
    v_max_f32 v8, 0, v8
    v_max_f32 v9, 0, v9
    v_max_f32 v10, 0, v10
    v_max_f32 v11, 0, v11
    v_mul_f32 v8, v8, v8
    v_mul_f32 v9, v9, v9
    v_mul_f32 v10, v10, v10
    v_mul_f32 v11, v11, v11
    v_fma_f32 v12, v33, v68, v92
    v_fma_f32 v13, v33, v69, v93
    v_fma_f32 v14, v33, v70, v94
    v_fma_f32 v15, v33, v71, v95
    v_fma_f32 v12, v144, v32, v12
    v_fma_f32 v13, v145, v32, v13
    v_fma_f32 v14, v146, v32, v14
    v_fma_f32 v15, v147, v32, v15
    v_max_f32 v12, 0, v12
    v_max_f32 v13, 0, v13
    v_max_f32 v14, 0, v14
    v_max_f32 v15, 0, v15
    v_mul_f32 v12, v12, v12
    v_mul_f32 v13, v13, v13
    v_mul_f32 v14, v14, v14
    v_mul_f32 v15, v15, v15
    v_cvt_pk_bf16_f32 v16, v8, v9
    v_cvt_pk_bf16_f32 v17, v10, v11
    v_cvt_pk_bf16_f32 v18, v12, v13
    v_cvt_pk_bf16_f32 v19, v14, v15
    buffer_store_dwordx4 v[16:19], v6, s[48:51], s60 offen offset:0 sc1
    v_lshlrev_b32 v96, 16, v228
    v_and_b32 v97, 0xffff0000, v228
    v_lshlrev_b32 v98, 16, v229
    v_and_b32 v99, 0xffff0000, v229
    v_lshlrev_b32 v100, 16, v230
    v_and_b32 v101, 0xffff0000, v230
    v_lshlrev_b32 v102, 16, v231
    v_and_b32 v103, 0xffff0000, v231
    v_fma_f32 v20, v33, v72, v96
    v_fma_f32 v21, v33, v73, v97
    v_fma_f32 v22, v33, v74, v98
    v_fma_f32 v23, v33, v75, v99
    v_fma_f32 v20, v160, v32, v20
    v_fma_f32 v21, v161, v32, v21
    v_fma_f32 v22, v162, v32, v22
    v_fma_f32 v23, v163, v32, v23
    v_max_f32 v20, 0, v20
    v_max_f32 v21, 0, v21
    v_max_f32 v22, 0, v22
    v_max_f32 v23, 0, v23
    v_mul_f32 v20, v20, v20
    v_mul_f32 v21, v21, v21
    v_mul_f32 v22, v22, v22
    v_mul_f32 v23, v23, v23
    v_fma_f32 v24, v33, v76, v100
    v_fma_f32 v25, v33, v77, v101
    v_fma_f32 v26, v33, v78, v102
    v_fma_f32 v27, v33, v79, v103
    v_fma_f32 v24, v176, v32, v24
    v_fma_f32 v25, v177, v32, v25
    v_fma_f32 v26, v178, v32, v26
    v_fma_f32 v27, v179, v32, v27
    v_max_f32 v24, 0, v24
    v_max_f32 v25, 0, v25
    v_max_f32 v26, 0, v26
    v_max_f32 v27, 0, v27
    v_mul_f32 v24, v24, v24
    v_mul_f32 v25, v25, v25
    v_mul_f32 v26, v26, v26
    v_mul_f32 v27, v27, v27
    v_cvt_pk_bf16_f32 v28, v20, v21
    v_cvt_pk_bf16_f32 v29, v22, v23
    v_cvt_pk_bf16_f32 v30, v24, v25
    v_cvt_pk_bf16_f32 v31, v26, v27
    buffer_store_dwordx4 v[28:31], v6, s[48:51], s60 offen offset:1024 sc1
    v_lshlrev_b32 v104, 16, v232
    v_and_b32 v105, 0xffff0000, v232
    v_lshlrev_b32 v106, 16, v233
    v_and_b32 v107, 0xffff0000, v233
    v_lshlrev_b32 v108, 16, v234
    v_and_b32 v109, 0xffff0000, v234
    v_lshlrev_b32 v110, 16, v235
    v_and_b32 v111, 0xffff0000, v235
    v_fma_f32 v8, v33, v80, v104
    v_fma_f32 v9, v33, v81, v105
    v_fma_f32 v10, v33, v82, v106
    v_fma_f32 v11, v33, v83, v107
    v_fma_f32 v8, v192, v32, v8
    v_fma_f32 v9, v193, v32, v9
    v_fma_f32 v10, v194, v32, v10
    v_fma_f32 v11, v195, v32, v11
    v_max_f32 v8, 0, v8
    v_max_f32 v9, 0, v9
    v_max_f32 v10, 0, v10
    v_max_f32 v11, 0, v11
    v_mul_f32 v8, v8, v8
    v_mul_f32 v9, v9, v9
    v_mul_f32 v10, v10, v10
    v_mul_f32 v11, v11, v11
    v_fma_f32 v12, v33, v84, v108
    v_fma_f32 v13, v33, v85, v109
    v_fma_f32 v14, v33, v86, v110
    v_fma_f32 v15, v33, v87, v111
    v_fma_f32 v12, v208, v32, v12
    v_fma_f32 v13, v209, v32, v13
    v_fma_f32 v14, v210, v32, v14
    v_fma_f32 v15, v211, v32, v15
    v_max_f32 v12, 0, v12
    v_max_f32 v13, 0, v13
    v_max_f32 v14, 0, v14
    v_max_f32 v15, 0, v15
    v_mul_f32 v12, v12, v12
    v_mul_f32 v13, v13, v13
    v_mul_f32 v14, v14, v14
    v_mul_f32 v15, v15, v15
    v_cvt_pk_bf16_f32 v16, v8, v9
    v_cvt_pk_bf16_f32 v17, v10, v11
    v_cvt_pk_bf16_f32 v18, v12, v13
    v_cvt_pk_bf16_f32 v19, v14, v15
    buffer_store_dwordx4 v[16:19], v6, s[48:51], s60 offen offset:2048 sc1
    s_add_u32 s60, s60, 49152
    v_fma_f32 v20, v35, v64, v88
    v_fma_f32 v21, v35, v65, v89
    v_fma_f32 v22, v35, v66, v90
    v_fma_f32 v23, v35, v67, v91
    v_fma_f32 v20, v132, v34, v20
    v_fma_f32 v21, v133, v34, v21
    v_fma_f32 v22, v134, v34, v22
    v_fma_f32 v23, v135, v34, v23
    v_max_f32 v20, 0, v20
    v_max_f32 v21, 0, v21
    v_max_f32 v22, 0, v22
    v_max_f32 v23, 0, v23
    v_mul_f32 v20, v20, v20
    v_mul_f32 v21, v21, v21
    v_mul_f32 v22, v22, v22
    v_mul_f32 v23, v23, v23
    v_fma_f32 v24, v35, v68, v92
    v_fma_f32 v25, v35, v69, v93
    v_fma_f32 v26, v35, v70, v94
    v_fma_f32 v27, v35, v71, v95
    v_fma_f32 v24, v148, v34, v24
    v_fma_f32 v25, v149, v34, v25
    v_fma_f32 v26, v150, v34, v26
    v_fma_f32 v27, v151, v34, v27
    v_max_f32 v24, 0, v24
    v_max_f32 v25, 0, v25
    v_max_f32 v26, 0, v26
    v_max_f32 v27, 0, v27
    v_mul_f32 v24, v24, v24
    v_mul_f32 v25, v25, v25
    v_mul_f32 v26, v26, v26
    v_mul_f32 v27, v27, v27
    v_cvt_pk_bf16_f32 v28, v20, v21
    v_cvt_pk_bf16_f32 v29, v22, v23
    v_cvt_pk_bf16_f32 v30, v24, v25
    v_cvt_pk_bf16_f32 v31, v26, v27
    buffer_store_dwordx4 v[28:31], v6, s[48:51], s60 offen offset:0 sc1
    v_fma_f32 v8, v35, v72, v96
    v_fma_f32 v9, v35, v73, v97
    v_fma_f32 v10, v35, v74, v98
    v_fma_f32 v11, v35, v75, v99
    v_fma_f32 v8, v164, v34, v8
    v_fma_f32 v9, v165, v34, v9
    v_fma_f32 v10, v166, v34, v10
    v_fma_f32 v11, v167, v34, v11
    v_max_f32 v8, 0, v8
    v_max_f32 v9, 0, v9
    v_max_f32 v10, 0, v10
    v_max_f32 v11, 0, v11
    v_mul_f32 v8, v8, v8
    v_mul_f32 v9, v9, v9
    v_mul_f32 v10, v10, v10
    v_mul_f32 v11, v11, v11
    v_fma_f32 v12, v35, v76, v100
    v_fma_f32 v13, v35, v77, v101
    v_fma_f32 v14, v35, v78, v102
    v_fma_f32 v15, v35, v79, v103
    v_fma_f32 v12, v180, v34, v12
    v_fma_f32 v13, v181, v34, v13
    v_fma_f32 v14, v182, v34, v14
    v_fma_f32 v15, v183, v34, v15
    v_max_f32 v12, 0, v12
    v_max_f32 v13, 0, v13
    v_max_f32 v14, 0, v14
    v_max_f32 v15, 0, v15
    v_mul_f32 v12, v12, v12
    v_mul_f32 v13, v13, v13
    v_mul_f32 v14, v14, v14
    v_mul_f32 v15, v15, v15
    v_cvt_pk_bf16_f32 v16, v8, v9
    v_cvt_pk_bf16_f32 v17, v10, v11
    v_cvt_pk_bf16_f32 v18, v12, v13
    v_cvt_pk_bf16_f32 v19, v14, v15
    buffer_store_dwordx4 v[16:19], v6, s[48:51], s60 offen offset:1024 sc1
    v_fma_f32 v20, v35, v80, v104
    v_fma_f32 v21, v35, v81, v105
    v_fma_f32 v22, v35, v82, v106
    v_fma_f32 v23, v35, v83, v107
    v_fma_f32 v20, v196, v34, v20
    v_fma_f32 v21, v197, v34, v21
    v_fma_f32 v22, v198, v34, v22
    v_fma_f32 v23, v199, v34, v23
    v_max_f32 v20, 0, v20
    v_max_f32 v21, 0, v21
    v_max_f32 v22, 0, v22
    v_max_f32 v23, 0, v23
    v_mul_f32 v20, v20, v20
    v_mul_f32 v21, v21, v21
    v_mul_f32 v22, v22, v22
    v_mul_f32 v23, v23, v23
    v_fma_f32 v24, v35, v84, v108
    v_fma_f32 v25, v35, v85, v109
    v_fma_f32 v26, v35, v86, v110
    v_fma_f32 v27, v35, v87, v111
    v_fma_f32 v24, v212, v34, v24
    v_fma_f32 v25, v213, v34, v25
    v_fma_f32 v26, v214, v34, v26
    v_fma_f32 v27, v215, v34, v27
    v_max_f32 v24, 0, v24
    v_max_f32 v25, 0, v25
    v_max_f32 v26, 0, v26
    v_max_f32 v27, 0, v27
    v_mul_f32 v24, v24, v24
    v_mul_f32 v25, v25, v25
    v_mul_f32 v26, v26, v26
    v_mul_f32 v27, v27, v27
    v_cvt_pk_bf16_f32 v28, v20, v21
    v_cvt_pk_bf16_f32 v29, v22, v23
    v_cvt_pk_bf16_f32 v30, v24, v25
    v_cvt_pk_bf16_f32 v31, v26, v27
    buffer_store_dwordx4 v[28:31], v6, s[48:51], s60 offen offset:2048 sc1
    s_add_u32 s60, s60, 49152
    v_fma_f32 v8, v37, v64, v88
    v_fma_f32 v9, v37, v65, v89
    v_fma_f32 v10, v37, v66, v90
    v_fma_f32 v11, v37, v67, v91
    v_fma_f32 v8, v136, v36, v8
    v_fma_f32 v9, v137, v36, v9
    v_fma_f32 v10, v138, v36, v10
    v_fma_f32 v11, v139, v36, v11
    v_max_f32 v8, 0, v8
    v_max_f32 v9, 0, v9
    v_max_f32 v10, 0, v10
    v_max_f32 v11, 0, v11
    v_mul_f32 v8, v8, v8
    v_mul_f32 v9, v9, v9
    v_mul_f32 v10, v10, v10
    v_mul_f32 v11, v11, v11
    v_fma_f32 v12, v37, v68, v92
    v_fma_f32 v13, v37, v69, v93
    v_fma_f32 v14, v37, v70, v94
    v_fma_f32 v15, v37, v71, v95
    v_fma_f32 v12, v152, v36, v12
    v_fma_f32 v13, v153, v36, v13
    v_fma_f32 v14, v154, v36, v14
    v_fma_f32 v15, v155, v36, v15
    v_max_f32 v12, 0, v12
    v_max_f32 v13, 0, v13
    v_max_f32 v14, 0, v14
    v_max_f32 v15, 0, v15
    v_mul_f32 v12, v12, v12
    v_mul_f32 v13, v13, v13
    v_mul_f32 v14, v14, v14
    v_mul_f32 v15, v15, v15
    v_cvt_pk_bf16_f32 v16, v8, v9
    v_cvt_pk_bf16_f32 v17, v10, v11
    v_cvt_pk_bf16_f32 v18, v12, v13
    v_cvt_pk_bf16_f32 v19, v14, v15
    buffer_store_dwordx4 v[16:19], v6, s[48:51], s60 offen offset:0 sc1
    v_fma_f32 v20, v37, v72, v96
    v_fma_f32 v21, v37, v73, v97
    v_fma_f32 v22, v37, v74, v98
    v_fma_f32 v23, v37, v75, v99
    v_fma_f32 v20, v168, v36, v20
    v_fma_f32 v21, v169, v36, v21
    v_fma_f32 v22, v170, v36, v22
    v_fma_f32 v23, v171, v36, v23
    v_max_f32 v20, 0, v20
    v_max_f32 v21, 0, v21
    v_max_f32 v22, 0, v22
    v_max_f32 v23, 0, v23
    v_mul_f32 v20, v20, v20
    v_mul_f32 v21, v21, v21
    v_mul_f32 v22, v22, v22
    v_mul_f32 v23, v23, v23
    v_fma_f32 v24, v37, v76, v100
    v_fma_f32 v25, v37, v77, v101
    v_fma_f32 v26, v37, v78, v102
    v_fma_f32 v27, v37, v79, v103
    v_fma_f32 v24, v184, v36, v24
    v_fma_f32 v25, v185, v36, v25
    v_fma_f32 v26, v186, v36, v26
    v_fma_f32 v27, v187, v36, v27
    v_max_f32 v24, 0, v24
    v_max_f32 v25, 0, v25
    v_max_f32 v26, 0, v26
    v_max_f32 v27, 0, v27
    v_mul_f32 v24, v24, v24
    v_mul_f32 v25, v25, v25
    v_mul_f32 v26, v26, v26
    v_mul_f32 v27, v27, v27
    v_cvt_pk_bf16_f32 v28, v20, v21
    v_cvt_pk_bf16_f32 v29, v22, v23
    v_cvt_pk_bf16_f32 v30, v24, v25
    v_cvt_pk_bf16_f32 v31, v26, v27
    buffer_store_dwordx4 v[28:31], v6, s[48:51], s60 offen offset:1024 sc1
    v_fma_f32 v8, v37, v80, v104
    v_fma_f32 v9, v37, v81, v105
    v_fma_f32 v10, v37, v82, v106
    v_fma_f32 v11, v37, v83, v107
    v_fma_f32 v8, v200, v36, v8
    v_fma_f32 v9, v201, v36, v9
    v_fma_f32 v10, v202, v36, v10
    v_fma_f32 v11, v203, v36, v11
    v_max_f32 v8, 0, v8
    v_max_f32 v9, 0, v9
    v_max_f32 v10, 0, v10
    v_max_f32 v11, 0, v11
    v_mul_f32 v8, v8, v8
    v_mul_f32 v9, v9, v9
    v_mul_f32 v10, v10, v10
    v_mul_f32 v11, v11, v11
    v_fma_f32 v12, v37, v84, v108
    v_fma_f32 v13, v37, v85, v109
    v_fma_f32 v14, v37, v86, v110
    v_fma_f32 v15, v37, v87, v111
    v_fma_f32 v12, v216, v36, v12
    v_fma_f32 v13, v217, v36, v13
    v_fma_f32 v14, v218, v36, v14
    v_fma_f32 v15, v219, v36, v15
    v_max_f32 v12, 0, v12
    v_max_f32 v13, 0, v13
    v_max_f32 v14, 0, v14
    v_max_f32 v15, 0, v15
    v_mul_f32 v12, v12, v12
    v_mul_f32 v13, v13, v13
    v_mul_f32 v14, v14, v14
    v_mul_f32 v15, v15, v15
    v_cvt_pk_bf16_f32 v16, v8, v9
    v_cvt_pk_bf16_f32 v17, v10, v11
    v_cvt_pk_bf16_f32 v18, v12, v13
    v_cvt_pk_bf16_f32 v19, v14, v15
    buffer_store_dwordx4 v[16:19], v6, s[48:51], s60 offen offset:2048 sc1
    s_add_u32 s60, s60, 49152
    v_fma_f32 v20, v39, v64, v88
    v_fma_f32 v21, v39, v65, v89
    v_fma_f32 v22, v39, v66, v90
    v_fma_f32 v23, v39, v67, v91
    v_fma_f32 v20, v140, v38, v20
    v_fma_f32 v21, v141, v38, v21
    v_fma_f32 v22, v142, v38, v22
    v_fma_f32 v23, v143, v38, v23
    v_max_f32 v20, 0, v20
    v_max_f32 v21, 0, v21
    v_max_f32 v22, 0, v22
    v_max_f32 v23, 0, v23
    v_mul_f32 v20, v20, v20
    v_mul_f32 v21, v21, v21
    v_mul_f32 v22, v22, v22
    v_mul_f32 v23, v23, v23
    v_fma_f32 v24, v39, v68, v92
    v_fma_f32 v25, v39, v69, v93
    v_fma_f32 v26, v39, v70, v94
    v_fma_f32 v27, v39, v71, v95
    v_fma_f32 v24, v156, v38, v24
    v_fma_f32 v25, v157, v38, v25
    v_fma_f32 v26, v158, v38, v26
    v_fma_f32 v27, v159, v38, v27
    v_max_f32 v24, 0, v24
    v_max_f32 v25, 0, v25
    v_max_f32 v26, 0, v26
    v_max_f32 v27, 0, v27
    v_mul_f32 v24, v24, v24
    v_mul_f32 v25, v25, v25
    v_mul_f32 v26, v26, v26
    v_mul_f32 v27, v27, v27
    v_cvt_pk_bf16_f32 v28, v20, v21
    v_cvt_pk_bf16_f32 v29, v22, v23
    v_cvt_pk_bf16_f32 v30, v24, v25
    v_cvt_pk_bf16_f32 v31, v26, v27
    buffer_store_dwordx4 v[28:31], v6, s[48:51], s60 offen offset:0 sc1
    v_fma_f32 v8, v39, v72, v96
    v_fma_f32 v9, v39, v73, v97
    v_fma_f32 v10, v39, v74, v98
    v_fma_f32 v11, v39, v75, v99
    v_fma_f32 v8, v172, v38, v8
    v_fma_f32 v9, v173, v38, v9
    v_fma_f32 v10, v174, v38, v10
    v_fma_f32 v11, v175, v38, v11
    v_max_f32 v8, 0, v8
    v_max_f32 v9, 0, v9
    v_max_f32 v10, 0, v10
    v_max_f32 v11, 0, v11
    v_mul_f32 v8, v8, v8
    v_mul_f32 v9, v9, v9
    v_mul_f32 v10, v10, v10
    v_mul_f32 v11, v11, v11
    v_fma_f32 v12, v39, v76, v100
    v_fma_f32 v13, v39, v77, v101
    v_fma_f32 v14, v39, v78, v102
    v_fma_f32 v15, v39, v79, v103
    v_fma_f32 v12, v188, v38, v12
    v_fma_f32 v13, v189, v38, v13
    v_fma_f32 v14, v190, v38, v14
    v_fma_f32 v15, v191, v38, v15
    v_max_f32 v12, 0, v12
    v_max_f32 v13, 0, v13
    v_max_f32 v14, 0, v14
    v_max_f32 v15, 0, v15
    v_mul_f32 v12, v12, v12
    v_mul_f32 v13, v13, v13
    v_mul_f32 v14, v14, v14
    v_mul_f32 v15, v15, v15
    v_cvt_pk_bf16_f32 v16, v8, v9
    v_cvt_pk_bf16_f32 v17, v10, v11
    v_cvt_pk_bf16_f32 v18, v12, v13
    v_cvt_pk_bf16_f32 v19, v14, v15
    buffer_store_dwordx4 v[16:19], v6, s[48:51], s60 offen offset:1024 sc1
    v_fma_f32 v20, v39, v80, v104
    v_fma_f32 v21, v39, v81, v105
    v_fma_f32 v22, v39, v82, v106
    v_fma_f32 v23, v39, v83, v107
    v_fma_f32 v20, v204, v38, v20
    v_fma_f32 v21, v205, v38, v21
    v_fma_f32 v22, v206, v38, v22
    v_fma_f32 v23, v207, v38, v23
    v_max_f32 v20, 0, v20
    v_max_f32 v21, 0, v21
    v_max_f32 v22, 0, v22
    v_max_f32 v23, 0, v23
    v_mul_f32 v20, v20, v20
    v_mul_f32 v21, v21, v21
    v_mul_f32 v22, v22, v22
    v_mul_f32 v23, v23, v23
    v_fma_f32 v24, v39, v84, v108
    v_fma_f32 v25, v39, v85, v109
    v_fma_f32 v26, v39, v86, v110
    v_fma_f32 v27, v39, v87, v111
    v_fma_f32 v24, v220, v38, v24
    v_fma_f32 v25, v221, v38, v25
    v_fma_f32 v26, v222, v38, v26
    v_fma_f32 v27, v223, v38, v27
    v_max_f32 v24, 0, v24
    v_max_f32 v25, 0, v25
    v_max_f32 v26, 0, v26
    v_max_f32 v27, 0, v27
    v_mul_f32 v24, v24, v24
    v_mul_f32 v25, v25, v25
    v_mul_f32 v26, v26, v26
    v_mul_f32 v27, v27, v27
    v_cvt_pk_bf16_f32 v28, v20, v21
    v_cvt_pk_bf16_f32 v29, v22, v23
    v_cvt_pk_bf16_f32 v30, v24, v25
    v_cvt_pk_bf16_f32 v31, v26, v27
    buffer_store_dwordx4 v[28:31], v6, s[48:51], s60 offen offset:2048 sc1
    s_waitcnt vmcnt(0)
K1_END:
    s_endpgm
.globl k2_kernel
.p2align 8
.type k2_kernel,@function
k2_kernel:
    s_cmp_ge_u32 s2, 256
    s_cbranch_scc1 K2_END
    s_load_dwordx16 s[4:19], s[0:1], 0
    s_load_dwordx4 s[20:23], s[0:1], 64
    s_load_dwordx2 s[24:25], s[0:1], 80
    v_and_b32 v1, 63, v0
    v_lshrrev_b32 v2, 6, v0
    s_nop 0
    v_readfirstlane_b32 s26, v2
    s_waitcnt lgkmcnt(0)
    s_cmp_ge_u32 s26, 4
    s_cbranch_scc1 K2_AT
    s_and_b32 s27, s2, 7
    s_lshr_b32 s3, s2, 3
    s_and_b32 s36, s27, 3
    s_lshl_b32 s36, s36, 3
    s_lshr_b32 s37, s3, 2
    s_add_u32 s36, s36, s37
    s_lshr_b32 s37, s27, 2
    s_lshl_b32 s37, s37, 2
    s_and_b32 s3, s3, 3
    s_add_u32 s37, s37, s3
    s_add_u32 s28, s24, 0x1000000
    s_addc_u32 s29, s25, 0
    s_mov_b32 s30, 0x600000
    s_mov_b32 s31, 0x00020000
    s_add_u32 s32, s24, 0x2400000
    s_addc_u32 s33, s25, 0
    s_mov_b32 s34, 0x1e0000
    s_mov_b32 s35, 0x00020000
    s_mov_b32 s48, s4
    s_mov_b32 s49, s5
    s_mov_b32 s50, 0x280000
    s_mov_b32 s51, 0x00020000
    s_mov_b32 s52, s18
    s_mov_b32 s53, s19
    s_mov_b32 s54, 0x500
    s_mov_b32 s55, 0x00020000
    s_mov_b32 s56, s20
    s_mov_b32 s57, s21
    s_mov_b32 s58, 0x280000
    s_mov_b32 s59, 0x00020000
    s_mul_i32 s38, s37, 160
    v_lshlrev_b32 v7, 4, v1
    v_add_u32 v8, 0x1000, v7
    s_mul_i32 s39, s26, 20480
    s_mul_i32 s45, s26, 12
    s_mul_i32 s40, s45, 40
    s_mul_i32 s41, s37, 5
    s_add_u32 s40, s40, s41
    s_lshl_b32 s40, s40, 10
    s_lshl_b32 s41, s36, 2
    s_add_u32 s41, s41, 0
    s_mul_i32 s41, s41, 48
    s_add_u32 s41, s41, s45
    s_lshl_b32 s41, s41, 10
    s_lshl_b32 s42, s36, 2
    s_add_u32 s42, s42, 1
    s_mul_i32 s42, s42, 48
    s_add_u32 s42, s42, s45
    s_lshl_b32 s42, s42, 10
    s_lshl_b32 s43, s36, 2
    s_add_u32 s43, s43, 2
    s_mul_i32 s43, s43, 48
    s_add_u32 s43, s43, s45
    s_lshl_b32 s43, s43, 10
    s_lshl_b32 s44, s36, 2
    s_add_u32 s44, s44, 3
    s_mul_i32 s44, s44, 48
    s_add_u32 s44, s44, s45
    s_lshl_b32 s44, s44, 10
    buffer_load_dwordx4 v[112:115], v7, s[32:35], s40 offen offset:0
    buffer_load_dwordx4 v[96:99], v7, s[28:31], s41 offen
    buffer_load_dwordx4 v[100:103], v7, s[28:31], s42 offen
    buffer_load_dwordx4 v[104:107], v7, s[28:31], s43 offen
    buffer_load_dwordx4 v[108:111], v7, s[28:31], s44 offen
    buffer_load_dwordx4 v[116:119], v7, s[32:35], s40 offen offset:1024
    buffer_load_dwordx4 v[120:123], v7, s[32:35], s40 offen offset:2048
    buffer_load_dwordx4 v[124:127], v7, s[32:35], s40 offen offset:3072
    buffer_load_dwordx4 v[128:131], v8, s[32:35], s40 offen
    s_add_u32 s40, s40, 40960
    buffer_load_dwordx4 v[148:151], v7, s[32:35], s40 offen offset:0
    s_add_u32 s41, s41, 1024
    buffer_load_dwordx4 v[132:135], v7, s[28:31], s41 offen
    s_add_u32 s42, s42, 1024
    buffer_load_dwordx4 v[136:139], v7, s[28:31], s42 offen
    s_add_u32 s43, s43, 1024
    buffer_load_dwordx4 v[140:143], v7, s[28:31], s43 offen
    s_add_u32 s44, s44, 1024
    buffer_load_dwordx4 v[144:147], v7, s[28:31], s44 offen
    buffer_load_dwordx4 v[152:155], v7, s[32:35], s40 offen offset:1024
    buffer_load_dwordx4 v[156:159], v7, s[32:35], s40 offen offset:2048
    buffer_load_dwordx4 v[160:163], v7, s[32:35], s40 offen offset:3072
    buffer_load_dwordx4 v[164:167], v8, s[32:35], s40 offen
    s_add_u32 s40, s40, 40960
    buffer_load_dwordx4 v[184:187], v7, s[32:35], s40 offen offset:0
    s_add_u32 s41, s41, 1024
    buffer_load_dwordx4 v[168:171], v7, s[28:31], s41 offen
    s_add_u32 s42, s42, 1024
    buffer_load_dwordx4 v[172:175], v7, s[28:31], s42 offen
    s_add_u32 s43, s43, 1024
    buffer_load_dwordx4 v[176:179], v7, s[28:31], s43 offen
    s_add_u32 s44, s44, 1024
    buffer_load_dwordx4 v[180:183], v7, s[28:31], s44 offen
    buffer_load_dwordx4 v[188:191], v7, s[32:35], s40 offen offset:1024
    buffer_load_dwordx4 v[192:195], v7, s[32:35], s40 offen offset:2048
    buffer_load_dwordx4 v[196:199], v7, s[32:35], s40 offen offset:3072
    buffer_load_dwordx4 v[200:203], v8, s[32:35], s40 offen
    s_add_u32 s40, s40, 40960
    buffer_load_dwordx4 v[220:223], v7, s[32:35], s40 offen offset:0
    s_add_u32 s41, s41, 1024
    buffer_load_dwordx4 v[204:207], v7, s[28:31], s41 offen
    s_add_u32 s42, s42, 1024
    buffer_load_dwordx4 v[208:211], v7, s[28:31], s42 offen
    s_add_u32 s43, s43, 1024
    buffer_load_dwordx4 v[212:215], v7, s[28:31], s43 offen
    s_add_u32 s44, s44, 1024
    buffer_load_dwordx4 v[216:219], v7, s[28:31], s44 offen
    buffer_load_dwordx4 v[224:227], v7, s[32:35], s40 offen offset:1024
    buffer_load_dwordx4 v[228:231], v7, s[32:35], s40 offen offset:2048
    buffer_load_dwordx4 v[232:235], v7, s[32:35], s40 offen offset:3072
    buffer_load_dwordx4 v[236:239], v8, s[32:35], s40 offen
    v_lshrrev_b32 v9, 4, v1
    v_and_b32 v15, 15, v1
    s_lshl_b32 s47, s36, 6
    s_lshl_b32 s46, s26, 4
    s_add_u32 s47, s47, s46
    v_add_u32 v14, s47, v15
    v_mul_u32_u24 v14, 1280, v14
    v_lshl_add_u32 v14, v9, 3, v14
    v_add_u32 v14, s38, v14
    v_lshlrev_b32 v10, 3, v9
    v_add_u32 v10, s38, v10
    v_mov_b32 v16, 0
    v_mov_b32 v17, 0
    v_mov_b32 v18, 0
    v_mov_b32 v19, 0
    v_mov_b32 v20, 0
    v_mov_b32 v21, 0
    v_mov_b32 v22, 0
    v_mov_b32 v23, 0
    v_mov_b32 v24, 0
    v_mov_b32 v25, 0
    v_mov_b32 v26, 0
    v_mov_b32 v27, 0
    v_mov_b32 v28, 0
    v_mov_b32 v29, 0
    v_mov_b32 v30, 0
    v_mov_b32 v31, 0
    v_mov_b32 v32, 0
    v_mov_b32 v33, 0
    v_mov_b32 v34, 0
    v_mov_b32 v35, 0
    v_mov_b32 v36, 0
    v_mov_b32 v37, 0
    v_mov_b32 v38, 0
    v_mov_b32 v39, 0
    v_mov_b32 v40, 0
    v_mov_b32 v41, 0
    v_mov_b32 v42, 0
    v_mov_b32 v43, 0
    v_mov_b32 v44, 0
    v_mov_b32 v45, 0
    v_mov_b32 v46, 0
    v_mov_b32 v47, 0
    v_mov_b32 v48, 0
    v_mov_b32 v49, 0
    v_mov_b32 v50, 0
    v_mov_b32 v51, 0
    v_mov_b32 v52, 0
    v_mov_b32 v53, 0
    v_mov_b32 v54, 0
    v_mov_b32 v55, 0
    v_mov_b32 v56, 0
    v_mov_b32 v57, 0
    v_mov_b32 v58, 0
    v_mov_b32 v59, 0
    v_mov_b32 v60, 0
    v_mov_b32 v61, 0
    v_mov_b32 v62, 0
    v_mov_b32 v63, 0
    v_mov_b32 v64, 0
    v_mov_b32 v65, 0
    v_mov_b32 v66, 0
    v_mov_b32 v67, 0
    v_mov_b32 v68, 0
    v_mov_b32 v69, 0
    v_mov_b32 v70, 0
    v_mov_b32 v71, 0
    v_mov_b32 v72, 0
    v_mov_b32 v73, 0
    v_mov_b32 v74, 0
    v_mov_b32 v75, 0
    v_mov_b32 v76, 0
    v_mov_b32 v77, 0
    v_mov_b32 v78, 0
    v_mov_b32 v79, 0
    v_mov_b32 v80, 0
    v_mov_b32 v81, 0
    v_mov_b32 v82, 0
    v_mov_b32 v83, 0
    v_mov_b32 v84, 0
    v_mov_b32 v85, 0
    v_mov_b32 v86, 0
    v_mov_b32 v87, 0
    v_mov_b32 v88, 0
    v_mov_b32 v89, 0
    v_mov_b32 v90, 0
    v_mov_b32 v91, 0
    v_mov_b32 v92, 0
    v_mov_b32 v93, 0
    v_mov_b32 v94, 0
    v_mov_b32 v95, 0
    s_waitcnt vmcnt(31)
    v_mfma_f32_16x16x32_bf16 v[16:19], v[112:115], v[96:99], v[16:19]
    v_mfma_f32_16x16x32_bf16 v[36:39], v[112:115], v[100:103], v[36:39]
    v_mfma_f32_16x16x32_bf16 v[56:59], v[112:115], v[104:107], v[56:59]
    v_mfma_f32_16x16x32_bf16 v[76:79], v[112:115], v[108:111], v[76:79]
    s_waitcnt vmcnt(30)
    v_mfma_f32_16x16x32_bf16 v[20:23], v[116:119], v[96:99], v[20:23]
    v_mfma_f32_16x16x32_bf16 v[40:43], v[116:119], v[100:103], v[40:43]
    v_mfma_f32_16x16x32_bf16 v[60:63], v[116:119], v[104:107], v[60:63]
    v_mfma_f32_16x16x32_bf16 v[80:83], v[116:119], v[108:111], v[80:83]
    s_waitcnt vmcnt(29)
    v_mfma_f32_16x16x32_bf16 v[24:27], v[120:123], v[96:99], v[24:27]
    v_mfma_f32_16x16x32_bf16 v[44:47], v[120:123], v[100:103], v[44:47]
    v_mfma_f32_16x16x32_bf16 v[64:67], v[120:123], v[104:107], v[64:67]
    v_mfma_f32_16x16x32_bf16 v[84:87], v[120:123], v[108:111], v[84:87]
    s_waitcnt vmcnt(28)
    v_mfma_f32_16x16x32_bf16 v[28:31], v[124:127], v[96:99], v[28:31]
    v_mfma_f32_16x16x32_bf16 v[48:51], v[124:127], v[100:103], v[48:51]
    v_mfma_f32_16x16x32_bf16 v[68:71], v[124:127], v[104:107], v[68:71]
    v_mfma_f32_16x16x32_bf16 v[88:91], v[124:127], v[108:111], v[88:91]
    s_waitcnt vmcnt(27)
    v_mfma_f32_16x16x32_bf16 v[32:35], v[128:131], v[96:99], v[32:35]
    v_mfma_f32_16x16x32_bf16 v[52:55], v[128:131], v[100:103], v[52:55]
    v_mfma_f32_16x16x32_bf16 v[72:75], v[128:131], v[104:107], v[72:75]
    v_mfma_f32_16x16x32_bf16 v[92:95], v[128:131], v[108:111], v[92:95]
    s_add_u32 s40, s40, 40960
    buffer_load_dwordx4 v[112:115], v7, s[32:35], s40 offen offset:0
    s_add_u32 s41, s41, 1024
    buffer_load_dwordx4 v[96:99], v7, s[28:31], s41 offen
    s_add_u32 s42, s42, 1024
    buffer_load_dwordx4 v[100:103], v7, s[28:31], s42 offen
    s_add_u32 s43, s43, 1024
    buffer_load_dwordx4 v[104:107], v7, s[28:31], s43 offen
    s_add_u32 s44, s44, 1024
    buffer_load_dwordx4 v[108:111], v7, s[28:31], s44 offen
    buffer_load_dwordx4 v[116:119], v7, s[32:35], s40 offen offset:1024
    buffer_load_dwordx4 v[120:123], v7, s[32:35], s40 offen offset:2048
    buffer_load_dwordx4 v[124:127], v7, s[32:35], s40 offen offset:3072
    buffer_load_dwordx4 v[128:131], v8, s[32:35], s40 offen
    s_waitcnt vmcnt(31)
    v_mfma_f32_16x16x32_bf16 v[16:19], v[148:151], v[132:135], v[16:19]
    v_mfma_f32_16x16x32_bf16 v[36:39], v[148:151], v[136:139], v[36:39]
    v_mfma_f32_16x16x32_bf16 v[56:59], v[148:151], v[140:143], v[56:59]
    v_mfma_f32_16x16x32_bf16 v[76:79], v[148:151], v[144:147], v[76:79]
    s_waitcnt vmcnt(30)
    v_mfma_f32_16x16x32_bf16 v[20:23], v[152:155], v[132:135], v[20:23]
    v_mfma_f32_16x16x32_bf16 v[40:43], v[152:155], v[136:139], v[40:43]
    v_mfma_f32_16x16x32_bf16 v[60:63], v[152:155], v[140:143], v[60:63]
    v_mfma_f32_16x16x32_bf16 v[80:83], v[152:155], v[144:147], v[80:83]
    s_waitcnt vmcnt(29)
    v_mfma_f32_16x16x32_bf16 v[24:27], v[156:159], v[132:135], v[24:27]
    v_mfma_f32_16x16x32_bf16 v[44:47], v[156:159], v[136:139], v[44:47]
    v_mfma_f32_16x16x32_bf16 v[64:67], v[156:159], v[140:143], v[64:67]
    v_mfma_f32_16x16x32_bf16 v[84:87], v[156:159], v[144:147], v[84:87]
    s_waitcnt vmcnt(28)
    v_mfma_f32_16x16x32_bf16 v[28:31], v[160:163], v[132:135], v[28:31]
    v_mfma_f32_16x16x32_bf16 v[48:51], v[160:163], v[136:139], v[48:51]
    v_mfma_f32_16x16x32_bf16 v[68:71], v[160:163], v[140:143], v[68:71]
    v_mfma_f32_16x16x32_bf16 v[88:91], v[160:163], v[144:147], v[88:91]
    s_waitcnt vmcnt(27)
    v_mfma_f32_16x16x32_bf16 v[32:35], v[164:167], v[132:135], v[32:35]
    v_mfma_f32_16x16x32_bf16 v[52:55], v[164:167], v[136:139], v[52:55]
    v_mfma_f32_16x16x32_bf16 v[72:75], v[164:167], v[140:143], v[72:75]
    v_mfma_f32_16x16x32_bf16 v[92:95], v[164:167], v[144:147], v[92:95]
    s_add_u32 s40, s40, 40960
    buffer_load_dwordx4 v[148:151], v7, s[32:35], s40 offen offset:0
    s_add_u32 s41, s41, 1024
    buffer_load_dwordx4 v[132:135], v7, s[28:31], s41 offen
    s_add_u32 s42, s42, 1024
    buffer_load_dwordx4 v[136:139], v7, s[28:31], s42 offen
    s_add_u32 s43, s43, 1024
    buffer_load_dwordx4 v[140:143], v7, s[28:31], s43 offen
    s_add_u32 s44, s44, 1024
    buffer_load_dwordx4 v[144:147], v7, s[28:31], s44 offen
    buffer_load_dwordx4 v[152:155], v7, s[32:35], s40 offen offset:1024
    buffer_load_dwordx4 v[156:159], v7, s[32:35], s40 offen offset:2048
    buffer_load_dwordx4 v[160:163], v7, s[32:35], s40 offen offset:3072
    buffer_load_dwordx4 v[164:167], v8, s[32:35], s40 offen
    s_waitcnt vmcnt(31)
    v_mfma_f32_16x16x32_bf16 v[16:19], v[184:187], v[168:171], v[16:19]
    v_mfma_f32_16x16x32_bf16 v[36:39], v[184:187], v[172:175], v[36:39]
    v_mfma_f32_16x16x32_bf16 v[56:59], v[184:187], v[176:179], v[56:59]
    v_mfma_f32_16x16x32_bf16 v[76:79], v[184:187], v[180:183], v[76:79]
    s_waitcnt vmcnt(30)
    v_mfma_f32_16x16x32_bf16 v[20:23], v[188:191], v[168:171], v[20:23]
    v_mfma_f32_16x16x32_bf16 v[40:43], v[188:191], v[172:175], v[40:43]
    v_mfma_f32_16x16x32_bf16 v[60:63], v[188:191], v[176:179], v[60:63]
    v_mfma_f32_16x16x32_bf16 v[80:83], v[188:191], v[180:183], v[80:83]
    s_waitcnt vmcnt(29)
    v_mfma_f32_16x16x32_bf16 v[24:27], v[192:195], v[168:171], v[24:27]
    v_mfma_f32_16x16x32_bf16 v[44:47], v[192:195], v[172:175], v[44:47]
    v_mfma_f32_16x16x32_bf16 v[64:67], v[192:195], v[176:179], v[64:67]
    v_mfma_f32_16x16x32_bf16 v[84:87], v[192:195], v[180:183], v[84:87]
    s_waitcnt vmcnt(28)
    v_mfma_f32_16x16x32_bf16 v[28:31], v[196:199], v[168:171], v[28:31]
    v_mfma_f32_16x16x32_bf16 v[48:51], v[196:199], v[172:175], v[48:51]
    v_mfma_f32_16x16x32_bf16 v[68:71], v[196:199], v[176:179], v[68:71]
    v_mfma_f32_16x16x32_bf16 v[88:91], v[196:199], v[180:183], v[88:91]
    s_waitcnt vmcnt(27)
    v_mfma_f32_16x16x32_bf16 v[32:35], v[200:203], v[168:171], v[32:35]
    v_mfma_f32_16x16x32_bf16 v[52:55], v[200:203], v[172:175], v[52:55]
    v_mfma_f32_16x16x32_bf16 v[72:75], v[200:203], v[176:179], v[72:75]
    v_mfma_f32_16x16x32_bf16 v[92:95], v[200:203], v[180:183], v[92:95]
    s_add_u32 s40, s40, 40960
    buffer_load_dwordx4 v[184:187], v7, s[32:35], s40 offen offset:0
    s_add_u32 s41, s41, 1024
    buffer_load_dwordx4 v[168:171], v7, s[28:31], s41 offen
    s_add_u32 s42, s42, 1024
    buffer_load_dwordx4 v[172:175], v7, s[28:31], s42 offen
    s_add_u32 s43, s43, 1024
    buffer_load_dwordx4 v[176:179], v7, s[28:31], s43 offen
    s_add_u32 s44, s44, 1024
    buffer_load_dwordx4 v[180:183], v7, s[28:31], s44 offen
    buffer_load_dwordx4 v[188:191], v7, s[32:35], s40 offen offset:1024
    buffer_load_dwordx4 v[192:195], v7, s[32:35], s40 offen offset:2048
    buffer_load_dwordx4 v[196:199], v7, s[32:35], s40 offen offset:3072
    buffer_load_dwordx4 v[200:203], v8, s[32:35], s40 offen
    s_waitcnt vmcnt(31)
    v_mfma_f32_16x16x32_bf16 v[16:19], v[220:223], v[204:207], v[16:19]
    v_mfma_f32_16x16x32_bf16 v[36:39], v[220:223], v[208:211], v[36:39]
    v_mfma_f32_16x16x32_bf16 v[56:59], v[220:223], v[212:215], v[56:59]
    v_mfma_f32_16x16x32_bf16 v[76:79], v[220:223], v[216:219], v[76:79]
    s_waitcnt vmcnt(30)
    v_mfma_f32_16x16x32_bf16 v[20:23], v[224:227], v[204:207], v[20:23]
    v_mfma_f32_16x16x32_bf16 v[40:43], v[224:227], v[208:211], v[40:43]
    v_mfma_f32_16x16x32_bf16 v[60:63], v[224:227], v[212:215], v[60:63]
    v_mfma_f32_16x16x32_bf16 v[80:83], v[224:227], v[216:219], v[80:83]
    s_waitcnt vmcnt(29)
    v_mfma_f32_16x16x32_bf16 v[24:27], v[228:231], v[204:207], v[24:27]
    v_mfma_f32_16x16x32_bf16 v[44:47], v[228:231], v[208:211], v[44:47]
    v_mfma_f32_16x16x32_bf16 v[64:67], v[228:231], v[212:215], v[64:67]
    v_mfma_f32_16x16x32_bf16 v[84:87], v[228:231], v[216:219], v[84:87]
    s_waitcnt vmcnt(28)
    v_mfma_f32_16x16x32_bf16 v[28:31], v[232:235], v[204:207], v[28:31]
    v_mfma_f32_16x16x32_bf16 v[48:51], v[232:235], v[208:211], v[48:51]
    v_mfma_f32_16x16x32_bf16 v[68:71], v[232:235], v[212:215], v[68:71]
    v_mfma_f32_16x16x32_bf16 v[88:91], v[232:235], v[216:219], v[88:91]
    s_waitcnt vmcnt(27)
    v_mfma_f32_16x16x32_bf16 v[32:35], v[236:239], v[204:207], v[32:35]
    v_mfma_f32_16x16x32_bf16 v[52:55], v[236:239], v[208:211], v[52:55]
    v_mfma_f32_16x16x32_bf16 v[72:75], v[236:239], v[212:215], v[72:75]
    v_mfma_f32_16x16x32_bf16 v[92:95], v[236:239], v[216:219], v[92:95]
    s_add_u32 s40, s40, 40960
    buffer_load_dwordx4 v[220:223], v7, s[32:35], s40 offen offset:0
    s_add_u32 s41, s41, 1024
    buffer_load_dwordx4 v[204:207], v7, s[28:31], s41 offen
    s_add_u32 s42, s42, 1024
    buffer_load_dwordx4 v[208:211], v7, s[28:31], s42 offen
    s_add_u32 s43, s43, 1024
    buffer_load_dwordx4 v[212:215], v7, s[28:31], s43 offen
    s_add_u32 s44, s44, 1024
    buffer_load_dwordx4 v[216:219], v7, s[28:31], s44 offen
    buffer_load_dwordx4 v[224:227], v7, s[32:35], s40 offen offset:1024
    buffer_load_dwordx4 v[228:231], v7, s[32:35], s40 offen offset:2048
    buffer_load_dwordx4 v[232:235], v7, s[32:35], s40 offen offset:3072
    buffer_load_dwordx4 v[236:239], v8, s[32:35], s40 offen
    s_waitcnt vmcnt(31)
    v_mfma_f32_16x16x32_bf16 v[16:19], v[112:115], v[96:99], v[16:19]
    v_mfma_f32_16x16x32_bf16 v[36:39], v[112:115], v[100:103], v[36:39]
    v_mfma_f32_16x16x32_bf16 v[56:59], v[112:115], v[104:107], v[56:59]
    v_mfma_f32_16x16x32_bf16 v[76:79], v[112:115], v[108:111], v[76:79]
    s_waitcnt vmcnt(30)
    v_mfma_f32_16x16x32_bf16 v[20:23], v[116:119], v[96:99], v[20:23]
    v_mfma_f32_16x16x32_bf16 v[40:43], v[116:119], v[100:103], v[40:43]
    v_mfma_f32_16x16x32_bf16 v[60:63], v[116:119], v[104:107], v[60:63]
    v_mfma_f32_16x16x32_bf16 v[80:83], v[116:119], v[108:111], v[80:83]
    s_waitcnt vmcnt(29)
    v_mfma_f32_16x16x32_bf16 v[24:27], v[120:123], v[96:99], v[24:27]
    v_mfma_f32_16x16x32_bf16 v[44:47], v[120:123], v[100:103], v[44:47]
    v_mfma_f32_16x16x32_bf16 v[64:67], v[120:123], v[104:107], v[64:67]
    v_mfma_f32_16x16x32_bf16 v[84:87], v[120:123], v[108:111], v[84:87]
    s_waitcnt vmcnt(28)
    v_mfma_f32_16x16x32_bf16 v[28:31], v[124:127], v[96:99], v[28:31]
    v_mfma_f32_16x16x32_bf16 v[48:51], v[124:127], v[100:103], v[48:51]
    v_mfma_f32_16x16x32_bf16 v[68:71], v[124:127], v[104:107], v[68:71]
    v_mfma_f32_16x16x32_bf16 v[88:91], v[124:127], v[108:111], v[88:91]
    s_waitcnt vmcnt(27)
    v_mfma_f32_16x16x32_bf16 v[32:35], v[128:131], v[96:99], v[32:35]
    v_mfma_f32_16x16x32_bf16 v[52:55], v[128:131], v[100:103], v[52:55]
    v_mfma_f32_16x16x32_bf16 v[72:75], v[128:131], v[104:107], v[72:75]
    v_mfma_f32_16x16x32_bf16 v[92:95], v[128:131], v[108:111], v[92:95]
    s_add_u32 s40, s40, 40960
    buffer_load_dwordx4 v[112:115], v7, s[32:35], s40 offen offset:0
    s_add_u32 s41, s41, 1024
    buffer_load_dwordx4 v[96:99], v7, s[28:31], s41 offen
    s_add_u32 s42, s42, 1024
    buffer_load_dwordx4 v[100:103], v7, s[28:31], s42 offen
    s_add_u32 s43, s43, 1024
    buffer_load_dwordx4 v[104:107], v7, s[28:31], s43 offen
    s_add_u32 s44, s44, 1024
    buffer_load_dwordx4 v[108:111], v7, s[28:31], s44 offen
    buffer_load_dwordx4 v[116:119], v7, s[32:35], s40 offen offset:1024
    buffer_load_dwordx4 v[120:123], v7, s[32:35], s40 offen offset:2048
    buffer_load_dwordx4 v[124:127], v7, s[32:35], s40 offen offset:3072
    buffer_load_dwordx4 v[128:131], v8, s[32:35], s40 offen
    s_waitcnt vmcnt(31)
    v_mfma_f32_16x16x32_bf16 v[16:19], v[148:151], v[132:135], v[16:19]
    v_mfma_f32_16x16x32_bf16 v[36:39], v[148:151], v[136:139], v[36:39]
    v_mfma_f32_16x16x32_bf16 v[56:59], v[148:151], v[140:143], v[56:59]
    v_mfma_f32_16x16x32_bf16 v[76:79], v[148:151], v[144:147], v[76:79]
    s_waitcnt vmcnt(30)
    v_mfma_f32_16x16x32_bf16 v[20:23], v[152:155], v[132:135], v[20:23]
    v_mfma_f32_16x16x32_bf16 v[40:43], v[152:155], v[136:139], v[40:43]
    v_mfma_f32_16x16x32_bf16 v[60:63], v[152:155], v[140:143], v[60:63]
    v_mfma_f32_16x16x32_bf16 v[80:83], v[152:155], v[144:147], v[80:83]
    s_waitcnt vmcnt(29)
    v_mfma_f32_16x16x32_bf16 v[24:27], v[156:159], v[132:135], v[24:27]
    v_mfma_f32_16x16x32_bf16 v[44:47], v[156:159], v[136:139], v[44:47]
    v_mfma_f32_16x16x32_bf16 v[64:67], v[156:159], v[140:143], v[64:67]
    v_mfma_f32_16x16x32_bf16 v[84:87], v[156:159], v[144:147], v[84:87]
    s_waitcnt vmcnt(28)
    v_mfma_f32_16x16x32_bf16 v[28:31], v[160:163], v[132:135], v[28:31]
    v_mfma_f32_16x16x32_bf16 v[48:51], v[160:163], v[136:139], v[48:51]
    v_mfma_f32_16x16x32_bf16 v[68:71], v[160:163], v[140:143], v[68:71]
    v_mfma_f32_16x16x32_bf16 v[88:91], v[160:163], v[144:147], v[88:91]
    s_waitcnt vmcnt(27)
    v_mfma_f32_16x16x32_bf16 v[32:35], v[164:167], v[132:135], v[32:35]
    v_mfma_f32_16x16x32_bf16 v[52:55], v[164:167], v[136:139], v[52:55]
    v_mfma_f32_16x16x32_bf16 v[72:75], v[164:167], v[140:143], v[72:75]
    v_mfma_f32_16x16x32_bf16 v[92:95], v[164:167], v[144:147], v[92:95]
    s_add_u32 s40, s40, 40960
    buffer_load_dwordx4 v[148:151], v7, s[32:35], s40 offen offset:0
    s_add_u32 s41, s41, 1024
    buffer_load_dwordx4 v[132:135], v7, s[28:31], s41 offen
    s_add_u32 s42, s42, 1024
    buffer_load_dwordx4 v[136:139], v7, s[28:31], s42 offen
    s_add_u32 s43, s43, 1024
    buffer_load_dwordx4 v[140:143], v7, s[28:31], s43 offen
    s_add_u32 s44, s44, 1024
    buffer_load_dwordx4 v[144:147], v7, s[28:31], s44 offen
    buffer_load_dwordx4 v[152:155], v7, s[32:35], s40 offen offset:1024
    buffer_load_dwordx4 v[156:159], v7, s[32:35], s40 offen offset:2048
    buffer_load_dwordx4 v[160:163], v7, s[32:35], s40 offen offset:3072
    buffer_load_dwordx4 v[164:167], v8, s[32:35], s40 offen
    s_waitcnt vmcnt(31)
    v_mfma_f32_16x16x32_bf16 v[16:19], v[184:187], v[168:171], v[16:19]
    v_mfma_f32_16x16x32_bf16 v[36:39], v[184:187], v[172:175], v[36:39]
    v_mfma_f32_16x16x32_bf16 v[56:59], v[184:187], v[176:179], v[56:59]
    v_mfma_f32_16x16x32_bf16 v[76:79], v[184:187], v[180:183], v[76:79]
    s_waitcnt vmcnt(30)
    v_mfma_f32_16x16x32_bf16 v[20:23], v[188:191], v[168:171], v[20:23]
    v_mfma_f32_16x16x32_bf16 v[40:43], v[188:191], v[172:175], v[40:43]
    v_mfma_f32_16x16x32_bf16 v[60:63], v[188:191], v[176:179], v[60:63]
    v_mfma_f32_16x16x32_bf16 v[80:83], v[188:191], v[180:183], v[80:83]
    s_waitcnt vmcnt(29)
    v_mfma_f32_16x16x32_bf16 v[24:27], v[192:195], v[168:171], v[24:27]
    v_mfma_f32_16x16x32_bf16 v[44:47], v[192:195], v[172:175], v[44:47]
    v_mfma_f32_16x16x32_bf16 v[64:67], v[192:195], v[176:179], v[64:67]
    v_mfma_f32_16x16x32_bf16 v[84:87], v[192:195], v[180:183], v[84:87]
    s_waitcnt vmcnt(28)
    v_mfma_f32_16x16x32_bf16 v[28:31], v[196:199], v[168:171], v[28:31]
    v_mfma_f32_16x16x32_bf16 v[48:51], v[196:199], v[172:175], v[48:51]
    v_mfma_f32_16x16x32_bf16 v[68:71], v[196:199], v[176:179], v[68:71]
    v_mfma_f32_16x16x32_bf16 v[88:91], v[196:199], v[180:183], v[88:91]
    s_waitcnt vmcnt(27)
    v_mfma_f32_16x16x32_bf16 v[32:35], v[200:203], v[168:171], v[32:35]
    v_mfma_f32_16x16x32_bf16 v[52:55], v[200:203], v[172:175], v[52:55]
    v_mfma_f32_16x16x32_bf16 v[72:75], v[200:203], v[176:179], v[72:75]
    v_mfma_f32_16x16x32_bf16 v[92:95], v[200:203], v[180:183], v[92:95]
    s_add_u32 s40, s40, 40960
    buffer_load_dwordx4 v[184:187], v7, s[32:35], s40 offen offset:0
    s_add_u32 s41, s41, 1024
    buffer_load_dwordx4 v[168:171], v7, s[28:31], s41 offen
    s_add_u32 s42, s42, 1024
    buffer_load_dwordx4 v[172:175], v7, s[28:31], s42 offen
    s_add_u32 s43, s43, 1024
    buffer_load_dwordx4 v[176:179], v7, s[28:31], s43 offen
    s_add_u32 s44, s44, 1024
    buffer_load_dwordx4 v[180:183], v7, s[28:31], s44 offen
    buffer_load_dwordx4 v[188:191], v7, s[32:35], s40 offen offset:1024
    buffer_load_dwordx4 v[192:195], v7, s[32:35], s40 offen offset:2048
    buffer_load_dwordx4 v[196:199], v7, s[32:35], s40 offen offset:3072
    buffer_load_dwordx4 v[200:203], v8, s[32:35], s40 offen
    s_waitcnt vmcnt(31)
    v_mfma_f32_16x16x32_bf16 v[16:19], v[220:223], v[204:207], v[16:19]
    v_mfma_f32_16x16x32_bf16 v[36:39], v[220:223], v[208:211], v[36:39]
    v_mfma_f32_16x16x32_bf16 v[56:59], v[220:223], v[212:215], v[56:59]
    v_mfma_f32_16x16x32_bf16 v[76:79], v[220:223], v[216:219], v[76:79]
    s_waitcnt vmcnt(30)
    v_mfma_f32_16x16x32_bf16 v[20:23], v[224:227], v[204:207], v[20:23]
    v_mfma_f32_16x16x32_bf16 v[40:43], v[224:227], v[208:211], v[40:43]
    v_mfma_f32_16x16x32_bf16 v[60:63], v[224:227], v[212:215], v[60:63]
    v_mfma_f32_16x16x32_bf16 v[80:83], v[224:227], v[216:219], v[80:83]
    s_waitcnt vmcnt(29)
    v_mfma_f32_16x16x32_bf16 v[24:27], v[228:231], v[204:207], v[24:27]
    v_mfma_f32_16x16x32_bf16 v[44:47], v[228:231], v[208:211], v[44:47]
    v_mfma_f32_16x16x32_bf16 v[64:67], v[228:231], v[212:215], v[64:67]
    v_mfma_f32_16x16x32_bf16 v[84:87], v[228:231], v[216:219], v[84:87]
    s_waitcnt vmcnt(28)
    v_mfma_f32_16x16x32_bf16 v[28:31], v[232:235], v[204:207], v[28:31]
    v_mfma_f32_16x16x32_bf16 v[48:51], v[232:235], v[208:211], v[48:51]
    v_mfma_f32_16x16x32_bf16 v[68:71], v[232:235], v[212:215], v[68:71]
    v_mfma_f32_16x16x32_bf16 v[88:91], v[232:235], v[216:219], v[88:91]
    s_waitcnt vmcnt(27)
    v_mfma_f32_16x16x32_bf16 v[32:35], v[236:239], v[204:207], v[32:35]
    v_mfma_f32_16x16x32_bf16 v[52:55], v[236:239], v[208:211], v[52:55]
    v_mfma_f32_16x16x32_bf16 v[72:75], v[236:239], v[212:215], v[72:75]
    v_mfma_f32_16x16x32_bf16 v[92:95], v[236:239], v[216:219], v[92:95]
    s_add_u32 s40, s40, 40960
    buffer_load_dwordx4 v[220:223], v7, s[32:35], s40 offen offset:0
    s_add_u32 s41, s41, 1024
    buffer_load_dwordx4 v[204:207], v7, s[28:31], s41 offen
    s_add_u32 s42, s42, 1024
    buffer_load_dwordx4 v[208:211], v7, s[28:31], s42 offen
    s_add_u32 s43, s43, 1024
    buffer_load_dwordx4 v[212:215], v7, s[28:31], s43 offen
    s_add_u32 s44, s44, 1024
    buffer_load_dwordx4 v[216:219], v7, s[28:31], s44 offen
    buffer_load_dwordx4 v[224:227], v7, s[32:35], s40 offen offset:1024
    buffer_load_dwordx4 v[228:231], v7, s[32:35], s40 offen offset:2048
    buffer_load_dwordx4 v[232:235], v7, s[32:35], s40 offen offset:3072
    buffer_load_dwordx4 v[236:239], v8, s[32:35], s40 offen
    buffer_load_dwordx2 v[240:241], v10, s[52:55], 0 offen offset:0
    buffer_load_dwordx2 v[242:243], v10, s[52:55], 0 offen offset:32
    buffer_load_dwordx2 v[244:245], v10, s[52:55], 0 offen offset:64
    buffer_load_dwordx2 v[246:247], v10, s[52:55], 0 offen offset:96
    buffer_load_dwordx2 v[248:249], v10, s[52:55], 0 offen offset:128
    buffer_load_dwordx2 v[250:251], v14, s[48:51], 0 offen offset:0
    buffer_load_dwordx2 v[252:253], v14, s[48:51], 0 offen offset:32
    buffer_load_dwordx2 v[254:255], v14, s[48:51], 0 offen offset:64
    buffer_load_dwordx2 v[2:3], v14, s[48:51], 0 offen offset:96
    buffer_load_dwordx2 v[4:5], v14, s[48:51], 0 offen offset:128
    s_waitcnt vmcnt(41)
    v_mfma_f32_16x16x32_bf16 v[16:19], v[112:115], v[96:99], v[16:19]
    v_mfma_f32_16x16x32_bf16 v[36:39], v[112:115], v[100:103], v[36:39]
    v_mfma_f32_16x16x32_bf16 v[56:59], v[112:115], v[104:107], v[56:59]
    v_mfma_f32_16x16x32_bf16 v[76:79], v[112:115], v[108:111], v[76:79]
    s_waitcnt vmcnt(40)
    v_mfma_f32_16x16x32_bf16 v[20:23], v[116:119], v[96:99], v[20:23]
    v_mfma_f32_16x16x32_bf16 v[40:43], v[116:119], v[100:103], v[40:43]
    v_mfma_f32_16x16x32_bf16 v[60:63], v[116:119], v[104:107], v[60:63]
    v_mfma_f32_16x16x32_bf16 v[80:83], v[116:119], v[108:111], v[80:83]
    s_waitcnt vmcnt(39)
    v_mfma_f32_16x16x32_bf16 v[24:27], v[120:123], v[96:99], v[24:27]
    v_mfma_f32_16x16x32_bf16 v[44:47], v[120:123], v[100:103], v[44:47]
    v_mfma_f32_16x16x32_bf16 v[64:67], v[120:123], v[104:107], v[64:67]
    v_mfma_f32_16x16x32_bf16 v[84:87], v[120:123], v[108:111], v[84:87]
    s_waitcnt vmcnt(38)
    v_mfma_f32_16x16x32_bf16 v[28:31], v[124:127], v[96:99], v[28:31]
    v_mfma_f32_16x16x32_bf16 v[48:51], v[124:127], v[100:103], v[48:51]
    v_mfma_f32_16x16x32_bf16 v[68:71], v[124:127], v[104:107], v[68:71]
    v_mfma_f32_16x16x32_bf16 v[88:91], v[124:127], v[108:111], v[88:91]
    s_waitcnt vmcnt(37)
    v_mfma_f32_16x16x32_bf16 v[32:35], v[128:131], v[96:99], v[32:35]
    v_mfma_f32_16x16x32_bf16 v[52:55], v[128:131], v[100:103], v[52:55]
    v_mfma_f32_16x16x32_bf16 v[72:75], v[128:131], v[104:107], v[72:75]
    v_mfma_f32_16x16x32_bf16 v[92:95], v[128:131], v[108:111], v[92:95]
    s_waitcnt vmcnt(32)
    v_mfma_f32_16x16x32_bf16 v[16:19], v[148:151], v[132:135], v[16:19]
    v_mfma_f32_16x16x32_bf16 v[36:39], v[148:151], v[136:139], v[36:39]
    v_mfma_f32_16x16x32_bf16 v[56:59], v[148:151], v[140:143], v[56:59]
    v_mfma_f32_16x16x32_bf16 v[76:79], v[148:151], v[144:147], v[76:79]
    s_waitcnt vmcnt(31)
    v_mfma_f32_16x16x32_bf16 v[20:23], v[152:155], v[132:135], v[20:23]
    v_mfma_f32_16x16x32_bf16 v[40:43], v[152:155], v[136:139], v[40:43]
    v_mfma_f32_16x16x32_bf16 v[60:63], v[152:155], v[140:143], v[60:63]
    v_mfma_f32_16x16x32_bf16 v[80:83], v[152:155], v[144:147], v[80:83]
    s_waitcnt vmcnt(30)
    v_mfma_f32_16x16x32_bf16 v[24:27], v[156:159], v[132:135], v[24:27]
    v_mfma_f32_16x16x32_bf16 v[44:47], v[156:159], v[136:139], v[44:47]
    v_mfma_f32_16x16x32_bf16 v[64:67], v[156:159], v[140:143], v[64:67]
    v_mfma_f32_16x16x32_bf16 v[84:87], v[156:159], v[144:147], v[84:87]
    s_waitcnt vmcnt(29)
    v_mfma_f32_16x16x32_bf16 v[28:31], v[160:163], v[132:135], v[28:31]
    v_mfma_f32_16x16x32_bf16 v[48:51], v[160:163], v[136:139], v[48:51]
    v_mfma_f32_16x16x32_bf16 v[68:71], v[160:163], v[140:143], v[68:71]
    v_mfma_f32_16x16x32_bf16 v[88:91], v[160:163], v[144:147], v[88:91]
    s_waitcnt vmcnt(28)
    v_mfma_f32_16x16x32_bf16 v[32:35], v[164:167], v[132:135], v[32:35]
    v_mfma_f32_16x16x32_bf16 v[52:55], v[164:167], v[136:139], v[52:55]
    v_mfma_f32_16x16x32_bf16 v[72:75], v[164:167], v[140:143], v[72:75]
    v_mfma_f32_16x16x32_bf16 v[92:95], v[164:167], v[144:147], v[92:95]
    s_waitcnt vmcnt(23)
    v_mfma_f32_16x16x32_bf16 v[16:19], v[184:187], v[168:171], v[16:19]
    v_mfma_f32_16x16x32_bf16 v[36:39], v[184:187], v[172:175], v[36:39]
    v_mfma_f32_16x16x32_bf16 v[56:59], v[184:187], v[176:179], v[56:59]
    v_mfma_f32_16x16x32_bf16 v[76:79], v[184:187], v[180:183], v[76:79]
    s_waitcnt vmcnt(22)
    v_mfma_f32_16x16x32_bf16 v[20:23], v[188:191], v[168:171], v[20:23]
    v_mfma_f32_16x16x32_bf16 v[40:43], v[188:191], v[172:175], v[40:43]
    v_mfma_f32_16x16x32_bf16 v[60:63], v[188:191], v[176:179], v[60:63]
    v_mfma_f32_16x16x32_bf16 v[80:83], v[188:191], v[180:183], v[80:83]
    s_waitcnt vmcnt(21)
    v_mfma_f32_16x16x32_bf16 v[24:27], v[192:195], v[168:171], v[24:27]
    v_mfma_f32_16x16x32_bf16 v[44:47], v[192:195], v[172:175], v[44:47]
    v_mfma_f32_16x16x32_bf16 v[64:67], v[192:195], v[176:179], v[64:67]
    v_mfma_f32_16x16x32_bf16 v[84:87], v[192:195], v[180:183], v[84:87]
    s_waitcnt vmcnt(20)
    v_mfma_f32_16x16x32_bf16 v[28:31], v[196:199], v[168:171], v[28:31]
    v_mfma_f32_16x16x32_bf16 v[48:51], v[196:199], v[172:175], v[48:51]
    v_mfma_f32_16x16x32_bf16 v[68:71], v[196:199], v[176:179], v[68:71]
    v_mfma_f32_16x16x32_bf16 v[88:91], v[196:199], v[180:183], v[88:91]
    s_waitcnt vmcnt(19)
    v_mfma_f32_16x16x32_bf16 v[32:35], v[200:203], v[168:171], v[32:35]
    v_mfma_f32_16x16x32_bf16 v[52:55], v[200:203], v[172:175], v[52:55]
    v_mfma_f32_16x16x32_bf16 v[72:75], v[200:203], v[176:179], v[72:75]
    v_mfma_f32_16x16x32_bf16 v[92:95], v[200:203], v[180:183], v[92:95]
    s_waitcnt vmcnt(14)
    v_mfma_f32_16x16x32_bf16 v[16:19], v[220:223], v[204:207], v[16:19]
    v_mfma_f32_16x16x32_bf16 v[36:39], v[220:223], v[208:211], v[36:39]
    v_mfma_f32_16x16x32_bf16 v[56:59], v[220:223], v[212:215], v[56:59]
    v_mfma_f32_16x16x32_bf16 v[76:79], v[220:223], v[216:219], v[76:79]
    s_waitcnt vmcnt(13)
    v_mfma_f32_16x16x32_bf16 v[20:23], v[224:227], v[204:207], v[20:23]
    v_mfma_f32_16x16x32_bf16 v[40:43], v[224:227], v[208:211], v[40:43]
    v_mfma_f32_16x16x32_bf16 v[60:63], v[224:227], v[212:215], v[60:63]
    v_mfma_f32_16x16x32_bf16 v[80:83], v[224:227], v[216:219], v[80:83]
    s_waitcnt vmcnt(12)
    v_mfma_f32_16x16x32_bf16 v[24:27], v[228:231], v[204:207], v[24:27]
    v_mfma_f32_16x16x32_bf16 v[44:47], v[228:231], v[208:211], v[44:47]
    v_mfma_f32_16x16x32_bf16 v[64:67], v[228:231], v[212:215], v[64:67]
    v_mfma_f32_16x16x32_bf16 v[84:87], v[228:231], v[216:219], v[84:87]
    s_waitcnt vmcnt(11)
    v_mfma_f32_16x16x32_bf16 v[28:31], v[232:235], v[204:207], v[28:31]
    v_mfma_f32_16x16x32_bf16 v[48:51], v[232:235], v[208:211], v[48:51]
    v_mfma_f32_16x16x32_bf16 v[68:71], v[232:235], v[212:215], v[68:71]
    v_mfma_f32_16x16x32_bf16 v[88:91], v[232:235], v[216:219], v[88:91]
    s_waitcnt vmcnt(10)
    v_mfma_f32_16x16x32_bf16 v[32:35], v[236:239], v[204:207], v[32:35]
    v_mfma_f32_16x16x32_bf16 v[52:55], v[236:239], v[208:211], v[52:55]
    v_mfma_f32_16x16x32_bf16 v[72:75], v[236:239], v[212:215], v[72:75]
    v_mfma_f32_16x16x32_bf16 v[92:95], v[236:239], v[216:219], v[92:95]
    s_nop 9
    v_lshlrev_b32 v10, 4, v1
    v_add_u32 v11, s39, v10
    ds_write_b128 v11, v[16:19] offset:0
    ds_write_b128 v11, v[20:23] offset:1024
    ds_write_b128 v11, v[24:27] offset:2048
    ds_write_b128 v11, v[28:31] offset:3072
    ds_write_b128 v11, v[32:35] offset:4096
    ds_write_b128 v11, v[36:39] offset:5120
    ds_write_b128 v11, v[40:43] offset:6144
    ds_write_b128 v11, v[44:47] offset:7168
    ds_write_b128 v11, v[48:51] offset:8192
    ds_write_b128 v11, v[52:55] offset:9216
    ds_write_b128 v11, v[56:59] offset:10240
    ds_write_b128 v11, v[60:63] offset:11264
    ds_write_b128 v11, v[64:67] offset:12288
    ds_write_b128 v11, v[68:71] offset:13312
    ds_write_b128 v11, v[72:75] offset:14336
    ds_write_b128 v11, v[76:79] offset:15360
    ds_write_b128 v11, v[80:83] offset:16384
    ds_write_b128 v11, v[84:87] offset:17408
    ds_write_b128 v11, v[88:91] offset:18432
    ds_write_b128 v11, v[92:95] offset:19456
    s_waitcnt lgkmcnt(0)
    s_barrier
    s_mul_i32 s46, s26, 5120
    v_add_u32 v11, s46, v10
    v_add_u32 v12, 0xa000, v11
    v_add_u32 v13, 0x14000, v11
    v_add_u32 v15, 0x1e000, v11
    ds_read_b128 v[96:99], v11 offset:0
    ds_read_b128 v[100:103], v11 offset:20480
    ds_read_b128 v[104:107], v12 offset:0
    ds_read_b128 v[108:111], v12 offset:20480
    ds_read_b128 v[112:115], v11 offset:1024
    ds_read_b128 v[116:119], v11 offset:21504
    ds_read_b128 v[120:123], v12 offset:1024
    ds_read_b128 v[124:127], v12 offset:21504
    ds_read_b128 v[128:131], v11 offset:2048
    ds_read_b128 v[132:135], v11 offset:22528
    ds_read_b128 v[136:139], v12 offset:2048
    ds_read_b128 v[140:143], v12 offset:22528
    ds_read_b128 v[144:147], v11 offset:3072
    ds_read_b128 v[148:151], v11 offset:23552
    ds_read_b128 v[152:155], v12 offset:3072
    ds_read_b128 v[156:159], v12 offset:23552
    ds_read_b128 v[160:163], v11 offset:4096
    ds_read_b128 v[164:167], v11 offset:24576
    ds_read_b128 v[168:171], v12 offset:4096
    ds_read_b128 v[172:175], v12 offset:24576
    s_waitcnt vmcnt(0)
    s_waitcnt lgkmcnt(15)
    v_add_f32 v96, v96, v100
    v_add_f32 v104, v104, v108
    v_add_f32 v97, v97, v101
    v_add_f32 v105, v105, v109
    v_add_f32 v98, v98, v102
    v_add_f32 v106, v106, v110
    v_add_f32 v99, v99, v103
    v_add_f32 v107, v107, v111
    v_add_f32 v96, v96, v104
    v_add_f32 v97, v97, v105
    v_add_f32 v98, v98, v106
    v_add_f32 v99, v99, v107
    v_lshlrev_b32 v100, 16, v240
    v_and_b32 v101, 0xffff0000, v240
    v_lshlrev_b32 v102, 16, v241
    v_and_b32 v103, 0xffff0000, v241
    v_add_f32 v96, v96, v100
    v_add_f32 v97, v97, v101
    v_add_f32 v98, v98, v102
    v_add_f32 v99, v99, v103
    v_mul_f32 v100, 0xbfb8aa3b, v96
    v_mul_f32 v101, 0xbfb8aa3b, v97
    v_mul_f32 v102, 0xbfb8aa3b, v98
    v_mul_f32 v103, 0xbfb8aa3b, v99
    v_exp_f32 v100, v100
    v_exp_f32 v101, v101
    v_exp_f32 v102, v102
    v_exp_f32 v103, v103
    v_lshlrev_b32 v36, 16, v250
    v_and_b32 v37, 0xffff0000, v250
    v_lshlrev_b32 v38, 16, v251
    v_and_b32 v39, 0xffff0000, v251
    v_add_f32 v100, 1.0, v100
    v_add_f32 v101, 1.0, v101
    v_add_f32 v102, 1.0, v102
    v_add_f32 v103, 1.0, v103
    v_rcp_f32 v100, v100
    v_rcp_f32 v101, v101
    v_rcp_f32 v102, v102
    v_rcp_f32 v103, v103
    s_nop 3
    v_mul_f32 v16, v96, v100
    v_mul_f32 v17, v97, v101
    v_mul_f32 v18, v98, v102
    v_mul_f32 v19, v99, v103
    s_waitcnt lgkmcnt(12)
    v_add_f32 v112, v112, v116
    v_add_f32 v120, v120, v124
    v_add_f32 v113, v113, v117
    v_add_f32 v121, v121, v125
    v_add_f32 v114, v114, v118
    v_add_f32 v122, v122, v126
    v_add_f32 v115, v115, v119
    v_add_f32 v123, v123, v127
    v_add_f32 v112, v112, v120
    v_add_f32 v113, v113, v121
    v_add_f32 v114, v114, v122
    v_add_f32 v115, v115, v123
    v_lshlrev_b32 v116, 16, v242
    v_and_b32 v117, 0xffff0000, v242
    v_lshlrev_b32 v118, 16, v243
    v_and_b32 v119, 0xffff0000, v243
    v_add_f32 v112, v112, v116
    v_add_f32 v113, v113, v117
    v_add_f32 v114, v114, v118
    v_add_f32 v115, v115, v119
    v_mul_f32 v116, 0xbfb8aa3b, v112
    v_mul_f32 v117, 0xbfb8aa3b, v113
    v_mul_f32 v118, 0xbfb8aa3b, v114
    v_mul_f32 v119, 0xbfb8aa3b, v115
    v_exp_f32 v116, v116
    v_exp_f32 v117, v117
    v_exp_f32 v118, v118
    v_exp_f32 v119, v119
    v_lshlrev_b32 v40, 16, v252
    v_and_b32 v41, 0xffff0000, v252
    v_lshlrev_b32 v42, 16, v253
    v_and_b32 v43, 0xffff0000, v253
    v_add_f32 v116, 1.0, v116
    v_add_f32 v117, 1.0, v117
    v_add_f32 v118, 1.0, v118
    v_add_f32 v119, 1.0, v119
    v_rcp_f32 v116, v116
    v_rcp_f32 v117, v117
    v_rcp_f32 v118, v118
    v_rcp_f32 v119, v119
    s_nop 3
    v_mul_f32 v20, v112, v116
    v_mul_f32 v21, v113, v117
    v_mul_f32 v22, v114, v118
    v_mul_f32 v23, v115, v119
    s_waitcnt lgkmcnt(8)
    v_add_f32 v128, v128, v132
    v_add_f32 v136, v136, v140
    v_add_f32 v129, v129, v133
    v_add_f32 v137, v137, v141
    v_add_f32 v130, v130, v134
    v_add_f32 v138, v138, v142
    v_add_f32 v131, v131, v135
    v_add_f32 v139, v139, v143
    v_add_f32 v128, v128, v136
    v_add_f32 v129, v129, v137
    v_add_f32 v130, v130, v138
    v_add_f32 v131, v131, v139
    v_lshlrev_b32 v132, 16, v244
    v_and_b32 v133, 0xffff0000, v244
    v_lshlrev_b32 v134, 16, v245
    v_and_b32 v135, 0xffff0000, v245
    v_add_f32 v128, v128, v132
    v_add_f32 v129, v129, v133
    v_add_f32 v130, v130, v134
    v_add_f32 v131, v131, v135
    v_mul_f32 v132, 0xbfb8aa3b, v128
    v_mul_f32 v133, 0xbfb8aa3b, v129
    v_mul_f32 v134, 0xbfb8aa3b, v130
    v_mul_f32 v135, 0xbfb8aa3b, v131
    v_exp_f32 v132, v132
    v_exp_f32 v133, v133
    v_exp_f32 v134, v134
    v_exp_f32 v135, v135
    v_lshlrev_b32 v44, 16, v254
    v_and_b32 v45, 0xffff0000, v254
    v_lshlrev_b32 v46, 16, v255
    v_and_b32 v47, 0xffff0000, v255
    v_add_f32 v132, 1.0, v132
    v_add_f32 v133, 1.0, v133
    v_add_f32 v134, 1.0, v134
    v_add_f32 v135, 1.0, v135
    v_rcp_f32 v132, v132
    v_rcp_f32 v133, v133
    v_rcp_f32 v134, v134
    v_rcp_f32 v135, v135
    s_nop 3
    v_mul_f32 v24, v128, v132
    v_mul_f32 v25, v129, v133
    v_mul_f32 v26, v130, v134
    v_mul_f32 v27, v131, v135
    s_waitcnt lgkmcnt(4)
    v_add_f32 v144, v144, v148
    v_add_f32 v152, v152, v156
    v_add_f32 v145, v145, v149
    v_add_f32 v153, v153, v157
    v_add_f32 v146, v146, v150
    v_add_f32 v154, v154, v158
    v_add_f32 v147, v147, v151
    v_add_f32 v155, v155, v159
    v_add_f32 v144, v144, v152
    v_add_f32 v145, v145, v153
    v_add_f32 v146, v146, v154
    v_add_f32 v147, v147, v155
    v_lshlrev_b32 v148, 16, v246
    v_and_b32 v149, 0xffff0000, v246
    v_lshlrev_b32 v150, 16, v247
    v_and_b32 v151, 0xffff0000, v247
    v_add_f32 v144, v144, v148
    v_add_f32 v145, v145, v149
    v_add_f32 v146, v146, v150
    v_add_f32 v147, v147, v151
    v_mul_f32 v148, 0xbfb8aa3b, v144
    v_mul_f32 v149, 0xbfb8aa3b, v145
    v_mul_f32 v150, 0xbfb8aa3b, v146
    v_mul_f32 v151, 0xbfb8aa3b, v147
    v_exp_f32 v148, v148
    v_exp_f32 v149, v149
    v_exp_f32 v150, v150
    v_exp_f32 v151, v151
    v_lshlrev_b32 v48, 16, v2
    v_and_b32 v49, 0xffff0000, v2
    v_lshlrev_b32 v50, 16, v3
    v_and_b32 v51, 0xffff0000, v3
    v_add_f32 v148, 1.0, v148
    v_add_f32 v149, 1.0, v149
    v_add_f32 v150, 1.0, v150
    v_add_f32 v151, 1.0, v151
    v_rcp_f32 v148, v148
    v_rcp_f32 v149, v149
    v_rcp_f32 v150, v150
    v_rcp_f32 v151, v151
    s_nop 3
    v_mul_f32 v28, v144, v148
    v_mul_f32 v29, v145, v149
    v_mul_f32 v30, v146, v150
    v_mul_f32 v31, v147, v151
    s_waitcnt lgkmcnt(0)
    v_add_f32 v160, v160, v164
    v_add_f32 v168, v168, v172
    v_add_f32 v161, v161, v165
    v_add_f32 v169, v169, v173
    v_add_f32 v162, v162, v166
    v_add_f32 v170, v170, v174
    v_add_f32 v163, v163, v167
    v_add_f32 v171, v171, v175
    v_add_f32 v160, v160, v168
    v_add_f32 v161, v161, v169
    v_add_f32 v162, v162, v170
    v_add_f32 v163, v163, v171
    v_lshlrev_b32 v164, 16, v248
    v_and_b32 v165, 0xffff0000, v248
    v_lshlrev_b32 v166, 16, v249
    v_and_b32 v167, 0xffff0000, v249
    v_add_f32 v160, v160, v164
    v_add_f32 v161, v161, v165
    v_add_f32 v162, v162, v166
    v_add_f32 v163, v163, v167
    v_mul_f32 v164, 0xbfb8aa3b, v160
    v_mul_f32 v165, 0xbfb8aa3b, v161
    v_mul_f32 v166, 0xbfb8aa3b, v162
    v_mul_f32 v167, 0xbfb8aa3b, v163
    v_exp_f32 v164, v164
    v_exp_f32 v165, v165
    v_exp_f32 v166, v166
    v_exp_f32 v167, v167
    v_lshlrev_b32 v52, 16, v4
    v_and_b32 v53, 0xffff0000, v4
    v_lshlrev_b32 v54, 16, v5
    v_and_b32 v55, 0xffff0000, v5
    v_add_f32 v164, 1.0, v164
    v_add_f32 v165, 1.0, v165
    v_add_f32 v166, 1.0, v166
    v_add_f32 v167, 1.0, v167
    v_rcp_f32 v164, v164
    v_rcp_f32 v165, v165
    v_rcp_f32 v166, v166
    v_rcp_f32 v167, v167
    s_nop 3
    v_mul_f32 v32, v160, v164
    v_mul_f32 v33, v161, v165
    v_mul_f32 v34, v162, v166
    v_mul_f32 v35, v163, v167
    s_mov_b32 s60, 0
    s_mov_b64 exec, 0
K2_PB:
    ds_read_b128 v[96:99], v13 offset:0
    ds_read_b128 v[100:103], v13 offset:20480
    ds_read_b128 v[104:107], v15 offset:0
    ds_read_b128 v[108:111], v15 offset:20480
    ds_read_b128 v[112:115], v13 offset:1024
    ds_read_b128 v[116:119], v13 offset:21504
    ds_read_b128 v[120:123], v15 offset:1024
    ds_read_b128 v[124:127], v15 offset:21504
    ds_read_b128 v[128:131], v13 offset:2048
    ds_read_b128 v[132:135], v13 offset:22528
    ds_read_b128 v[136:139], v15 offset:2048
    ds_read_b128 v[140:143], v15 offset:22528
    ds_read_b128 v[144:147], v13 offset:3072
    ds_read_b128 v[148:151], v13 offset:23552
    ds_read_b128 v[152:155], v15 offset:3072
    ds_read_b128 v[156:159], v15 offset:23552
    ds_read_b128 v[160:163], v13 offset:4096
    ds_read_b128 v[164:167], v13 offset:24576
    ds_read_b128 v[168:171], v15 offset:4096
    ds_read_b128 v[172:175], v15 offset:24576
    s_waitcnt lgkmcnt(15)
    v_add_f32 v96, v96, v100
    v_add_f32 v104, v104, v108
    v_add_f32 v97, v97, v101
    v_add_f32 v105, v105, v109
    v_add_f32 v98, v98, v102
    v_add_f32 v106, v106, v110
    v_add_f32 v99, v99, v103
    v_add_f32 v107, v107, v111
    v_add_f32 v96, v96, v104
    v_add_f32 v97, v97, v105
    v_add_f32 v98, v98, v106
    v_add_f32 v99, v99, v107
    v_fma_f32 v96, v96, v16, v36
    v_fma_f32 v97, v97, v17, v37
    v_fma_f32 v98, v98, v18, v38
    v_fma_f32 v99, v99, v19, v39
    v_cvt_pk_bf16_f32 v100, v96, v97
    v_cvt_pk_bf16_f32 v101, v98, v99
    buffer_store_dwordx2 v[100:101], v14, s[56:59], 0 offen offset:0
    s_waitcnt lgkmcnt(12)
    v_add_f32 v112, v112, v116
    v_add_f32 v120, v120, v124
    v_add_f32 v113, v113, v117
    v_add_f32 v121, v121, v125
    v_add_f32 v114, v114, v118
    v_add_f32 v122, v122, v126
    v_add_f32 v115, v115, v119
    v_add_f32 v123, v123, v127
    v_add_f32 v112, v112, v120
    v_add_f32 v113, v113, v121
    v_add_f32 v114, v114, v122
    v_add_f32 v115, v115, v123
    v_fma_f32 v112, v112, v20, v40
    v_fma_f32 v113, v113, v21, v41
    v_fma_f32 v114, v114, v22, v42
    v_fma_f32 v115, v115, v23, v43
    v_cvt_pk_bf16_f32 v116, v112, v113
    v_cvt_pk_bf16_f32 v117, v114, v115
    buffer_store_dwordx2 v[116:117], v14, s[56:59], 0 offen offset:32
    s_waitcnt lgkmcnt(8)
    v_add_f32 v128, v128, v132
    v_add_f32 v136, v136, v140
    v_add_f32 v129, v129, v133
    v_add_f32 v137, v137, v141
    v_add_f32 v130, v130, v134
    v_add_f32 v138, v138, v142
    v_add_f32 v131, v131, v135
    v_add_f32 v139, v139, v143
    v_add_f32 v128, v128, v136
    v_add_f32 v129, v129, v137
    v_add_f32 v130, v130, v138
    v_add_f32 v131, v131, v139
    v_fma_f32 v128, v128, v24, v44
    v_fma_f32 v129, v129, v25, v45
    v_fma_f32 v130, v130, v26, v46
    v_fma_f32 v131, v131, v27, v47
    v_cvt_pk_bf16_f32 v132, v128, v129
    v_cvt_pk_bf16_f32 v133, v130, v131
    buffer_store_dwordx2 v[132:133], v14, s[56:59], 0 offen offset:64
    s_waitcnt lgkmcnt(4)
    v_add_f32 v144, v144, v148
    v_add_f32 v152, v152, v156
    v_add_f32 v145, v145, v149
    v_add_f32 v153, v153, v157
    v_add_f32 v146, v146, v150
    v_add_f32 v154, v154, v158
    v_add_f32 v147, v147, v151
    v_add_f32 v155, v155, v159
    v_add_f32 v144, v144, v152
    v_add_f32 v145, v145, v153
    v_add_f32 v146, v146, v154
    v_add_f32 v147, v147, v155
    v_fma_f32 v144, v144, v28, v48
    v_fma_f32 v145, v145, v29, v49
    v_fma_f32 v146, v146, v30, v50
    v_fma_f32 v147, v147, v31, v51
    v_cvt_pk_bf16_f32 v148, v144, v145
    v_cvt_pk_bf16_f32 v149, v146, v147
    buffer_store_dwordx2 v[148:149], v14, s[56:59], 0 offen offset:96
    s_waitcnt lgkmcnt(0)
    v_add_f32 v160, v160, v164
    v_add_f32 v168, v168, v172
    v_add_f32 v161, v161, v165
    v_add_f32 v169, v169, v173
    v_add_f32 v162, v162, v166
    v_add_f32 v170, v170, v174
    v_add_f32 v163, v163, v167
    v_add_f32 v171, v171, v175
    v_add_f32 v160, v160, v168
    v_add_f32 v161, v161, v169
    v_add_f32 v162, v162, v170
    v_add_f32 v163, v163, v171
    v_fma_f32 v160, v160, v32, v52
    v_fma_f32 v161, v161, v33, v53
    v_fma_f32 v162, v162, v34, v54
    v_fma_f32 v163, v163, v35, v55
    v_cvt_pk_bf16_f32 v164, v160, v161
    v_cvt_pk_bf16_f32 v165, v162, v163
    buffer_store_dwordx2 v[164:165], v14, s[56:59], 0 offen offset:128
    s_cmp_eq_u32 s60, 1
    s_cbranch_scc1 K2_PB_DONE
    s_mov_b32 s60, 1
    s_mov_b64 exec, -1
    s_barrier
    s_branch K2_PB
K2_PB_DONE:
    s_endpgm
K2_AT:
    s_setprio 3
    s_mov_b32 s28, s24
    s_mov_b32 s29, s25
    s_mov_b32 s30, 0x280000
    s_mov_b32 s31, 0x00020000
    s_add_u32 s32, s24, 0x400000
    s_addc_u32 s33, s25, 0
    s_mov_b32 s34, 0x280000
    s_mov_b32 s35, 0x00020000
    s_add_u32 s96, s24, 0x800000
    s_addc_u32 s97, s25, 0
    s_mov_b32 s98, 0x400000
    s_mov_b32 s99, 0x00020000
    s_add_u32 s40, s24, 0x1800000
    s_addc_u32 s41, s25, 0
    s_mov_b32 s42, 0x280000
    s_mov_b32 s43, 0x00020000
    s_and_b32 s27, s2, 7
    s_lshr_b32 s3, s2, 3
    s_and_b32 s36, s27, 3
    s_lshl_b32 s36, s36, 3
    s_lshr_b32 s37, s3, 2
    s_add_u32 s36, s36, s37
    s_lshr_b32 s37, s27, 2
    s_lshl_b32 s37, s37, 2
    s_and_b32 s3, s3, 3
    s_add_u32 s37, s37, s3
    s_lshl_b32 s44, s37, 2
    s_add_u32 s44, s44, s26
    s_sub_u32 s44, s44, 4
    s_lshl_b32 s45, s36, 1
    v_lshlrev_b32 v8, 4, v1
    v_and_b32 v12, 31, v1
    v_lshrrev_b32 v13, 5, v1
    v_mov_b32 v11, 0x7f000000
    v_lshlrev_b32 v9, 3, v12
    v_add_u32 v9, 1024, v9
    v_cmp_gt_u32 vcc, 32, v1
    v_mul_u32_u24 v2, 1280, v13
    v_add_u32 v2, v9, v2
    v_cndmask_b32 v3, v11, v9, vcc
    v_cndmask_b32 v4, v9, v11, vcc
    v_cmp_ge_u32 vcc, 20, v12
    s_lshl_b32 s47, s44, 6
    s_add_u32 s48, s47, s45
    v_cndmask_b32 v10, v11, v8, vcc
    s_add_u32 s49, s48, 0
    s_mul_i32 s49, s49, 1280
    buffer_load_dwordx4 v[212:215], v8, s[28:31], s49 offen
    buffer_load_dwordx2 v[216:217], v3, s[28:31], s49 offen
    buffer_load_dwordx2 v[218:219], v4, s[28:31], s49 offen
    s_add_i32 s49, s45, -8
    s_add_i32 s50, s49, s47
    s_mul_i32 s50, s50, 1280
    v_add_u32 v5, s50, v2
    buffer_load_dwordx2 v[120:121], v5, s[32:35], 0 offen
    s_max_i32 s49, s49, 0
    s_add_u32 s49, s49, s47
    s_mul_i32 s50, s49, 1280
    buffer_load_dwordx4 v[80:83], v8, s[32:35], s50 offen
    s_add_i32 s49, s45, -7
    s_max_i32 s49, s49, 0
    s_add_u32 s49, s49, s47
    s_mul_i32 s50, s49, 1280
    buffer_load_dwordx4 v[84:87], v8, s[32:35], s50 offen
    s_add_i32 s49, s45, -6
    s_add_i32 s50, s49, s47
    s_mul_i32 s50, s50, 1280
    v_add_u32 v5, s50, v2
    buffer_load_dwordx2 v[122:123], v5, s[32:35], 0 offen
    s_max_i32 s49, s49, 0
    s_add_u32 s49, s49, s47
    s_mul_i32 s50, s49, 1280
    buffer_load_dwordx4 v[88:91], v8, s[32:35], s50 offen
    s_add_i32 s49, s45, -8
    s_max_i32 s49, s49, 0
    s_add_u32 s49, s49, s47
    s_lshl_b32 s50, s49, 11
    buffer_load_dwordx4 v[132:135], v10, s[96:99], s50 offen
    buffer_load_dwordx4 v[136:139], v10, s[96:99], s50 offen offset:1024
    s_add_i32 s49, s45, -7
    s_max_i32 s49, s49, 0
    s_add_u32 s49, s49, s47
    s_lshl_b32 s50, s49, 11
    buffer_load_dwordx4 v[140:143], v10, s[96:99], s50 offen
    buffer_load_dwordx4 v[144:147], v10, s[96:99], s50 offen offset:1024
    s_add_i32 s49, s45, -6
    s_max_i32 s49, s49, 0
    s_add_u32 s49, s49, s47
    s_lshl_b32 s50, s49, 11
    buffer_load_dwordx4 v[148:151], v10, s[96:99], s50 offen
    buffer_load_dwordx4 v[152:155], v10, s[96:99], s50 offen offset:1024
    s_add_i32 s49, s45, -5
    s_max_i32 s49, s49, 0
    s_add_u32 s49, s49, s47
    s_mul_i32 s50, s49, 1280
    buffer_load_dwordx4 v[92:95], v8, s[32:35], s50 offen
    s_add_i32 s49, s45, -4
    s_add_i32 s50, s49, s47
    s_mul_i32 s50, s50, 1280
    v_add_u32 v5, s50, v2
    buffer_load_dwordx2 v[124:125], v5, s[32:35], 0 offen
    s_max_i32 s49, s49, 0
    s_add_u32 s49, s49, s47
    s_mul_i32 s50, s49, 1280
    buffer_load_dwordx4 v[96:99], v8, s[32:35], s50 offen
    s_add_i32 s49, s45, -3
    s_max_i32 s49, s49, 0
    s_add_u32 s49, s49, s47
    s_mul_i32 s50, s49, 1280
    buffer_load_dwordx4 v[100:103], v8, s[32:35], s50 offen
    s_add_i32 s49, s45, -2
    s_add_i32 s50, s49, s47
    s_mul_i32 s50, s50, 1280
    v_add_u32 v5, s50, v2
    buffer_load_dwordx2 v[126:127], v5, s[32:35], 0 offen
    s_max_i32 s49, s49, 0
    s_add_u32 s49, s49, s47
    s_mul_i32 s50, s49, 1280
    buffer_load_dwordx4 v[104:107], v8, s[32:35], s50 offen
    s_add_i32 s49, s45, -1
    s_max_i32 s49, s49, 0
    s_add_u32 s49, s49, s47
    s_mul_i32 s50, s49, 1280
    buffer_load_dwordx4 v[108:111], v8, s[32:35], s50 offen
    s_add_i32 s49, s45, 0
    s_add_i32 s50, s49, s47
    s_mul_i32 s50, s50, 1280
    v_add_u32 v5, s50, v2
    buffer_load_dwordx2 v[128:129], v5, s[32:35], 0 offen
    s_max_i32 s49, s49, 0
    s_add_u32 s49, s49, s47
    s_mul_i32 s50, s49, 1280
    buffer_load_dwordx4 v[112:115], v8, s[32:35], s50 offen
    s_add_i32 s49, s45, 1
    s_max_i32 s49, s49, 0
    s_add_u32 s49, s49, s47
    s_mul_i32 s50, s49, 1280
    buffer_load_dwordx4 v[116:119], v8, s[32:35], s50 offen
    s_add_u32 s49, s48, 1
    s_mul_i32 s49, s49, 1280
    buffer_load_dwordx4 v[220:223], v8, s[28:31], s49 offen
    buffer_load_dwordx2 v[224:225], v3, s[28:31], s49 offen
    buffer_load_dwordx2 v[226:227], v4, s[28:31], s49 offen
    s_add_i32 s49, s45, -5
    s_max_i32 s49, s49, 0
    s_add_u32 s49, s49, s47
    s_lshl_b32 s50, s49, 11
    buffer_load_dwordx4 v[156:159], v10, s[96:99], s50 offen
    buffer_load_dwordx4 v[160:163], v10, s[96:99], s50 offen offset:1024
    s_add_i32 s49, s45, -4
    s_max_i32 s49, s49, 0
    s_add_u32 s49, s49, s47
    s_lshl_b32 s50, s49, 11
    buffer_load_dwordx4 v[164:167], v10, s[96:99], s50 offen
    buffer_load_dwordx4 v[168:171], v10, s[96:99], s50 offen offset:1024
    s_add_i32 s49, s45, -3
    s_max_i32 s49, s49, 0
    s_add_u32 s49, s49, s47
    s_lshl_b32 s50, s49, 11
    buffer_load_dwordx4 v[172:175], v10, s[96:99], s50 offen
    buffer_load_dwordx4 v[176:179], v10, s[96:99], s50 offen offset:1024
    s_add_i32 s49, s45, -2
    s_max_i32 s49, s49, 0
    s_add_u32 s49, s49, s47
    s_lshl_b32 s50, s49, 11
    buffer_load_dwordx4 v[180:183], v10, s[96:99], s50 offen
    buffer_load_dwordx4 v[184:187], v10, s[96:99], s50 offen offset:1024
    s_add_i32 s49, s45, -1
    s_max_i32 s49, s49, 0
    s_add_u32 s49, s49, s47
    s_lshl_b32 s50, s49, 11
    buffer_load_dwordx4 v[188:191], v10, s[96:99], s50 offen
    buffer_load_dwordx4 v[192:195], v10, s[96:99], s50 offen offset:1024
    s_add_i32 s49, s45, 0
    s_max_i32 s49, s49, 0
    s_add_u32 s49, s49, s47
    s_lshl_b32 s50, s49, 11
    buffer_load_dwordx4 v[196:199], v10, s[96:99], s50 offen
    buffer_load_dwordx4 v[200:203], v10, s[96:99], s50 offen offset:1024
    s_add_i32 s49, s45, 1
    s_max_i32 s49, s49, 0
    s_add_u32 s49, s49, s47
    s_lshl_b32 s50, s49, 11
    buffer_load_dwordx4 v[204:207], v10, s[96:99], s50 offen
    buffer_load_dwordx4 v[208:211], v10, s[96:99], s50 offen offset:1024
    v_lshlrev_b32 v14, 2, v13
    v_sub_u32 v14, v12, v14
    v_cmp_le_i32 s[64:65], 0, v14
    v_cmp_le_i32 s[66:67], 1, v14
    v_cmp_le_i32 s[68:69], 2, v14
    v_cmp_le_i32 s[70:71], 3, v14
    v_cmp_le_i32 s[72:73], 8, v14
    v_cmp_le_i32 s[74:75], 9, v14
    v_cmp_le_i32 s[76:77], 10, v14
    v_cmp_le_i32 s[78:79], 11, v14
    v_cmp_le_i32 s[80:81], 16, v14
    v_cmp_le_i32 s[82:83], 17, v14
    v_cmp_le_i32 s[84:85], 18, v14
    v_cmp_le_i32 s[86:87], 19, v14
    v_cmp_le_i32 s[88:89], 24, v14
    v_cmp_le_i32 s[90:91], 25, v14
    v_cmp_le_i32 s[92:93], 26, v14
    v_cmp_le_i32 s[94:95], 27, v14
    v_mov_b32 v228, 0xf149f2ca
    v_mov_b32 v229, 0
    v_mov_b32 v235, 0xe0ad78ec
    s_mov_b32 s51, 0x3ea52b5c
    s_mov_b32 s100, s51
    s_mov_b32 s101, s51
    v_cndmask_b32 v32, v229, v228, s[64:65]
    v_cndmask_b32 v33, v229, v228, s[66:67]
    v_cndmask_b32 v34, v229, v228, s[68:69]
    v_cndmask_b32 v35, v229, v228, s[70:71]
    v_cndmask_b32 v36, v229, v228, s[72:73]
    v_cndmask_b32 v37, v229, v228, s[74:75]
    v_cndmask_b32 v38, v229, v228, s[76:77]
    v_cndmask_b32 v39, v229, v228, s[78:79]
    v_cndmask_b32 v40, v229, v228, s[80:81]
    v_cndmask_b32 v41, v229, v228, s[82:83]
    v_cndmask_b32 v42, v229, v228, s[84:85]
    v_cndmask_b32 v43, v229, v228, s[86:87]
    v_cndmask_b32 v44, v229, v228, s[88:89]
    v_cndmask_b32 v45, v229, v228, s[90:91]
    v_cndmask_b32 v46, v229, v228, s[92:93]
    v_cndmask_b32 v47, v229, v228, s[94:95]
    s_waitcnt vmcnt(36)
    s_add_i32 s49, s45, -8
    s_cmp_lt_i32 s49, 0
    s_cbranch_scc1 AT_INV_1
    v_mfma_f32_32x32x16_bf16 v[32:47], v[80:83], v[212:215], v[32:47]
    s_branch AT_NXT_2
AT_INV_1:
    v_mov_b32 v32, v228
    v_mov_b32 v33, v228
    v_mov_b32 v34, v228
    v_mov_b32 v35, v228
    v_mov_b32 v36, v228
    v_mov_b32 v37, v228
    v_mov_b32 v38, v228
    v_mov_b32 v39, v228
    v_mov_b32 v40, v228
    v_mov_b32 v41, v228
    v_mov_b32 v42, v228
    v_mov_b32 v43, v228
    v_mov_b32 v44, v228
    v_mov_b32 v45, v228
    v_mov_b32 v46, v228
    v_mov_b32 v47, v228
AT_NXT_2:
    s_waitcnt vmcnt(35)
    s_add_i32 s49, s45, -7
    s_cmp_lt_i32 s49, 0
    s_cbranch_scc1 AT_INV_3
    v_mfma_f32_32x32x16_bf16 v[48:63], v[84:87], v[212:215], 0
    s_branch AT_NXT_4
AT_INV_3:
    v_mov_b32 v48, v228
    v_mov_b32 v49, v228
    v_mov_b32 v50, v228
    v_mov_b32 v51, v228
    v_mov_b32 v52, v228
    v_mov_b32 v53, v228
    v_mov_b32 v54, v228
    v_mov_b32 v55, v228
    v_mov_b32 v56, v228
    v_mov_b32 v57, v228
    v_mov_b32 v58, v228
    v_mov_b32 v59, v228
    v_mov_b32 v60, v228
    v_mov_b32 v61, v228
    v_mov_b32 v62, v228
    v_mov_b32 v63, v228
AT_NXT_4:
    s_waitcnt vmcnt(33)
    s_add_i32 s49, s45, -6
    s_cmp_lt_i32 s49, 0
    s_cbranch_scc1 AT_INV_5
    v_mfma_f32_32x32x16_bf16 v[64:79], v[88:91], v[212:215], 0
    s_branch AT_NXT_6
AT_INV_5:
    v_mov_b32 v64, v228
    v_mov_b32 v65, v228
    v_mov_b32 v66, v228
    v_mov_b32 v67, v228
    v_mov_b32 v68, v228
    v_mov_b32 v69, v228
    v_mov_b32 v70, v228
    v_mov_b32 v71, v228
    v_mov_b32 v72, v228
    v_mov_b32 v73, v228
    v_mov_b32 v74, v228
    v_mov_b32 v75, v228
    v_mov_b32 v76, v228
    v_mov_b32 v77, v228
    v_mov_b32 v78, v228
    v_mov_b32 v79, v228
AT_NXT_6:
    s_nop 11
    s_add_i32 s49, s45, -8
    s_cmp_lt_i32 s49, 0
    s_cbranch_scc1 AT_NXT_8
    v_mfma_f32_32x32x8_bf16 v[32:47], v[120:121], v[216:217], v[32:47]
AT_NXT_8:
    s_add_i32 s49, s45, -7
    s_cmp_lt_i32 s49, 0
    s_cbranch_scc1 AT_NXT_10
    v_mfma_f32_32x32x8_bf16 v[48:63], v[120:121], v[218:219], v[48:63]
AT_NXT_10:
    s_add_i32 s49, s45, -6
    s_cmp_lt_i32 s49, 0
    s_cbranch_scc1 AT_NXT_12
    v_mfma_f32_32x32x8_bf16 v[64:79], v[122:123], v[216:217], v[64:79]
AT_NXT_12:
    s_nop 13
    v_max3_f32 v230, v32, v33, v34
    v_max3_f32 v232, v35, v36, v37
    v_max3_f32 v230, v230, v38, v39
    v_max3_f32 v232, v232, v40, v41
    v_max3_f32 v230, v230, v42, v43
    v_max3_f32 v232, v232, v44, v45
    v_max3_f32 v230, v230, v46, v47
    v_max3_f32 v232, v232, v48, v49
    v_max3_f32 v230, v230, v50, v51
    v_max3_f32 v232, v232, v52, v53
    v_max3_f32 v230, v230, v54, v55
    v_max3_f32 v232, v232, v56, v57
    v_max3_f32 v230, v230, v58, v59
    v_max3_f32 v232, v232, v60, v61
    v_max3_f32 v230, v230, v62, v63
    v_max3_f32 v232, v232, v64, v65
    v_max3_f32 v230, v230, v66, v67
    v_max3_f32 v232, v232, v68, v69
    v_max3_f32 v230, v230, v70, v71
    v_max3_f32 v232, v232, v72, v73
    v_max3_f32 v230, v230, v74, v75
    v_max3_f32 v232, v232, v76, v77
    v_max3_f32 v230, v230, v78, v79
    v_max3_f32 v230, v230, v232, v235
    v_mov_b32 v232, v230
    s_nop 1
    v_permlane32_swap_b32 v230, v232
    s_nop 0
    v_max_f32 v230, v230, v232
    v_mul_f32 v234, s51, v230
    v_sub_f32 v234, 0, v234
    v_mov_b32 v231, v230
    v_mov_b32 v242, v234
    v_fma_f32 v32, v32, s51, v234
    v_fma_f32 v33, v33, s51, v234
    v_fma_f32 v34, v34, s51, v234
    v_fma_f32 v35, v35, s51, v234
    v_fma_f32 v36, v36, s51, v234
    v_fma_f32 v37, v37, s51, v234
    v_fma_f32 v38, v38, s51, v234
    v_fma_f32 v39, v39, s51, v234
    v_fma_f32 v40, v40, s51, v234
    v_fma_f32 v41, v41, s51, v234
    v_fma_f32 v42, v42, s51, v234
    v_fma_f32 v43, v43, s51, v234
    v_fma_f32 v44, v44, s51, v234
    v_fma_f32 v45, v45, s51, v234
    v_fma_f32 v46, v46, s51, v234
    v_fma_f32 v47, v47, s51, v234
    v_exp_f32 v32, v32
    v_exp_f32 v33, v33
    v_exp_f32 v34, v34
    v_exp_f32 v35, v35
    v_exp_f32 v36, v36
    v_exp_f32 v37, v37
    v_exp_f32 v38, v38
    v_exp_f32 v39, v39
    v_exp_f32 v40, v40
    v_exp_f32 v41, v41
    v_exp_f32 v42, v42
    v_exp_f32 v43, v43
    v_exp_f32 v44, v44
    v_exp_f32 v45, v45
    v_exp_f32 v46, v46
    v_exp_f32 v47, v47
    s_nop 1
    v_cvt_pk_bf16_f32 v32, v32, v33
    v_cvt_pk_bf16_f32 v33, v34, v35
    v_cvt_pk_bf16_f32 v34, v36, v37
    v_cvt_pk_bf16_f32 v35, v38, v39
    v_cvt_pk_bf16_f32 v36, v40, v41
    v_cvt_pk_bf16_f32 v37, v42, v43
    v_cvt_pk_bf16_f32 v38, v44, v45
    v_cvt_pk_bf16_f32 v39, v46, v47
    s_waitcnt vmcnt(31)
    s_nop 0
    v_mfma_f32_32x32x16_bf16 v[16:31], v[132:135], v[32:35], 0
    v_fma_f32 v48, v48, s51, v234
    v_fma_f32 v49, v49, s51, v234
    v_fma_f32 v50, v50, s51, v234
    v_fma_f32 v51, v51, s51, v234
    v_fma_f32 v52, v52, s51, v234
    v_fma_f32 v53, v53, s51, v234
    v_fma_f32 v54, v54, s51, v234
    v_fma_f32 v55, v55, s51, v234
    v_fma_f32 v56, v56, s51, v234
    v_fma_f32 v57, v57, s51, v234
    v_fma_f32 v58, v58, s51, v234
    v_fma_f32 v59, v59, s51, v234
    v_fma_f32 v60, v60, s51, v234
    v_fma_f32 v61, v61, s51, v234
    v_fma_f32 v62, v62, s51, v234
    v_fma_f32 v63, v63, s51, v234
    v_mfma_f32_32x32x16_bf16 v[16:31], v[136:139], v[36:39], v[16:31]
    v_exp_f32 v48, v48
    v_exp_f32 v49, v49
    v_exp_f32 v50, v50
    v_exp_f32 v51, v51
    v_exp_f32 v52, v52
    v_exp_f32 v53, v53
    v_exp_f32 v54, v54
    v_exp_f32 v55, v55
    v_exp_f32 v56, v56
    v_exp_f32 v57, v57
    v_exp_f32 v58, v58
    v_exp_f32 v59, v59
    v_exp_f32 v60, v60
    v_exp_f32 v61, v61
    v_exp_f32 v62, v62
    v_exp_f32 v63, v63
    s_nop 1
    v_cvt_pk_bf16_f32 v48, v48, v49
    v_cvt_pk_bf16_f32 v49, v50, v51
    v_cvt_pk_bf16_f32 v50, v52, v53
    v_cvt_pk_bf16_f32 v51, v54, v55
    v_cvt_pk_bf16_f32 v52, v56, v57
    v_cvt_pk_bf16_f32 v53, v58, v59
    v_cvt_pk_bf16_f32 v54, v60, v61
    v_cvt_pk_bf16_f32 v55, v62, v63
    s_waitcnt vmcnt(29)
    s_nop 0
    v_mfma_f32_32x32x16_bf16 v[16:31], v[140:143], v[48:51], v[16:31]
    v_fma_f32 v64, v64, s51, v234
    v_fma_f32 v65, v65, s51, v234
    v_fma_f32 v66, v66, s51, v234
    v_fma_f32 v67, v67, s51, v234
    v_fma_f32 v68, v68, s51, v234
    v_fma_f32 v69, v69, s51, v234
    v_fma_f32 v70, v70, s51, v234
    v_fma_f32 v71, v71, s51, v234
    v_fma_f32 v72, v72, s51, v234
    v_fma_f32 v73, v73, s51, v234
    v_fma_f32 v74, v74, s51, v234
    v_fma_f32 v75, v75, s51, v234
    v_fma_f32 v76, v76, s51, v234
    v_fma_f32 v77, v77, s51, v234
    v_fma_f32 v78, v78, s51, v234
    v_fma_f32 v79, v79, s51, v234
    v_mfma_f32_32x32x16_bf16 v[16:31], v[144:147], v[52:55], v[16:31]
    v_exp_f32 v64, v64
    v_exp_f32 v65, v65
    v_exp_f32 v66, v66
    v_exp_f32 v67, v67
    v_exp_f32 v68, v68
    v_exp_f32 v69, v69
    v_exp_f32 v70, v70
    v_exp_f32 v71, v71
    v_exp_f32 v72, v72
    v_exp_f32 v73, v73
    v_exp_f32 v74, v74
    v_exp_f32 v75, v75
    v_exp_f32 v76, v76
    v_exp_f32 v77, v77
    v_exp_f32 v78, v78
    v_exp_f32 v79, v79
    s_nop 1
    v_cvt_pk_bf16_f32 v64, v64, v65
    v_cvt_pk_bf16_f32 v65, v66, v67
    v_cvt_pk_bf16_f32 v66, v68, v69
    v_cvt_pk_bf16_f32 v67, v70, v71
    v_cvt_pk_bf16_f32 v68, v72, v73
    v_cvt_pk_bf16_f32 v69, v74, v75
    v_cvt_pk_bf16_f32 v70, v76, v77
    v_cvt_pk_bf16_f32 v71, v78, v79
    s_waitcnt vmcnt(27)
    s_nop 0
    v_mfma_f32_32x32x16_bf16 v[16:31], v[148:151], v[64:67], v[16:31]
    s_nop 13
    v_mfma_f32_32x32x16_bf16 v[16:31], v[152:155], v[68:71], v[16:31]
    s_nop 3
    s_waitcnt vmcnt(26)
    s_add_i32 s49, s45, -5
    s_cmp_lt_i32 s49, 0
    s_cbranch_scc1 AT_INV_13
    v_mfma_f32_32x32x16_bf16 v[32:47], v[92:95], v[212:215], 0
    s_branch AT_NXT_14
AT_INV_13:
    v_mov_b32 v32, v228
    v_mov_b32 v33, v228
    v_mov_b32 v34, v228
    v_mov_b32 v35, v228
    v_mov_b32 v36, v228
    v_mov_b32 v37, v228
    v_mov_b32 v38, v228
    v_mov_b32 v39, v228
    v_mov_b32 v40, v228
    v_mov_b32 v41, v228
    v_mov_b32 v42, v228
    v_mov_b32 v43, v228
    v_mov_b32 v44, v228
    v_mov_b32 v45, v228
    v_mov_b32 v46, v228
    v_mov_b32 v47, v228
AT_NXT_14:
    s_waitcnt vmcnt(24)
    s_add_i32 s49, s45, -4
    s_cmp_lt_i32 s49, 0
    s_cbranch_scc1 AT_INV_15
    v_mfma_f32_32x32x16_bf16 v[48:63], v[96:99], v[212:215], 0
    s_branch AT_NXT_16
AT_INV_15:
    v_mov_b32 v48, v228
    v_mov_b32 v49, v228
    v_mov_b32 v50, v228
    v_mov_b32 v51, v228
    v_mov_b32 v52, v228
    v_mov_b32 v53, v228
    v_mov_b32 v54, v228
    v_mov_b32 v55, v228
    v_mov_b32 v56, v228
    v_mov_b32 v57, v228
    v_mov_b32 v58, v228
    v_mov_b32 v59, v228
    v_mov_b32 v60, v228
    v_mov_b32 v61, v228
    v_mov_b32 v62, v228
    v_mov_b32 v63, v228
AT_NXT_16:
    s_waitcnt vmcnt(23)
    s_add_i32 s49, s45, -3
    s_cmp_lt_i32 s49, 0
    s_cbranch_scc1 AT_INV_17
    v_mfma_f32_32x32x16_bf16 v[64:79], v[100:103], v[212:215], 0
    s_branch AT_NXT_18
AT_INV_17:
    v_mov_b32 v64, v228
    v_mov_b32 v65, v228
    v_mov_b32 v66, v228
    v_mov_b32 v67, v228
    v_mov_b32 v68, v228
    v_mov_b32 v69, v228
    v_mov_b32 v70, v228
    v_mov_b32 v71, v228
    v_mov_b32 v72, v228
    v_mov_b32 v73, v228
    v_mov_b32 v74, v228
    v_mov_b32 v75, v228
    v_mov_b32 v76, v228
    v_mov_b32 v77, v228
    v_mov_b32 v78, v228
    v_mov_b32 v79, v228
AT_NXT_18:
    s_nop 11
    s_add_i32 s49, s45, -5
    s_cmp_lt_i32 s49, 0
    s_cbranch_scc1 AT_NXT_20
    v_mfma_f32_32x32x8_bf16 v[32:47], v[122:123], v[218:219], v[32:47]
AT_NXT_20:
    s_add_i32 s49, s45, -4
    s_cmp_lt_i32 s49, 0
    s_cbranch_scc1 AT_NXT_22
    v_mfma_f32_32x32x8_bf16 v[48:63], v[124:125], v[216:217], v[48:63]
AT_NXT_22:
    s_add_i32 s49, s45, -3
    s_cmp_lt_i32 s49, 0
    s_cbranch_scc1 AT_NXT_24
    v_mfma_f32_32x32x8_bf16 v[64:79], v[124:125], v[218:219], v[64:79]
AT_NXT_24:
    s_nop 13
    v_max3_f32 v230, v32, v33, v34
    v_max3_f32 v232, v35, v36, v37
    v_max3_f32 v230, v230, v38, v39
    v_max3_f32 v232, v232, v40, v41
    v_max3_f32 v230, v230, v42, v43
    v_max3_f32 v232, v232, v44, v45
    v_max3_f32 v230, v230, v46, v47
    v_max3_f32 v232, v232, v48, v49
    v_max3_f32 v230, v230, v50, v51
    v_max3_f32 v232, v232, v52, v53
    v_max3_f32 v230, v230, v54, v55
    v_max3_f32 v232, v232, v56, v57
    v_max3_f32 v230, v230, v58, v59
    v_max3_f32 v232, v232, v60, v61
    v_max3_f32 v230, v230, v62, v63
    v_max3_f32 v232, v232, v64, v65
    v_max3_f32 v230, v230, v66, v67
    v_max3_f32 v232, v232, v68, v69
    v_max3_f32 v230, v230, v70, v71
    v_max3_f32 v232, v232, v72, v73
    v_max3_f32 v230, v230, v74, v75
    v_max3_f32 v232, v232, v76, v77
    v_max3_f32 v230, v230, v78, v79
    v_max3_f32 v230, v230, v232, v231
    v_mov_b32 v232, v230
    s_nop 1
    v_permlane32_swap_b32 v230, v232
    s_nop 0
    v_max_f32 v230, v230, v232
    v_mul_f32 v234, s51, v230
    v_sub_f32 v234, 0, v234
    v_sub_f32 v233, v234, v242
    v_exp_f32 v233, v233
    v_mov_b32 v231, v230
    v_mov_b32 v242, v234
    v_fma_f32 v32, v32, s51, v234
    v_fma_f32 v33, v33, s51, v234
    v_fma_f32 v34, v34, s51, v234
    v_fma_f32 v35, v35, s51, v234
    v_fma_f32 v36, v36, s51, v234
    v_fma_f32 v37, v37, s51, v234
    v_fma_f32 v38, v38, s51, v234
    v_fma_f32 v39, v39, s51, v234
    v_fma_f32 v40, v40, s51, v234
    v_fma_f32 v41, v41, s51, v234
    v_fma_f32 v42, v42, s51, v234
    v_fma_f32 v43, v43, s51, v234
    v_fma_f32 v44, v44, s51, v234
    v_fma_f32 v45, v45, s51, v234
    v_fma_f32 v46, v46, s51, v234
    v_fma_f32 v47, v47, s51, v234
    v_exp_f32 v32, v32
    v_exp_f32 v33, v33
    v_exp_f32 v34, v34
    v_exp_f32 v35, v35
    v_exp_f32 v36, v36
    v_exp_f32 v37, v37
    v_exp_f32 v38, v38
    v_exp_f32 v39, v39
    v_exp_f32 v40, v40
    v_exp_f32 v41, v41
    v_exp_f32 v42, v42
    v_exp_f32 v43, v43
    v_exp_f32 v44, v44
    v_exp_f32 v45, v45
    v_exp_f32 v46, v46
    v_exp_f32 v47, v47
    s_nop 1
    v_cvt_pk_bf16_f32 v32, v32, v33
    v_cvt_pk_bf16_f32 v33, v34, v35
    v_cvt_pk_bf16_f32 v34, v36, v37
    v_cvt_pk_bf16_f32 v35, v38, v39
    v_cvt_pk_bf16_f32 v36, v40, v41
    v_cvt_pk_bf16_f32 v37, v42, v43
    v_cvt_pk_bf16_f32 v38, v44, v45
    v_cvt_pk_bf16_f32 v39, v46, v47
    v_mul_f32 v16, v233, v16
    v_mul_f32 v17, v233, v17
    v_mul_f32 v18, v233, v18
    v_mul_f32 v19, v233, v19
    v_mul_f32 v20, v233, v20
    v_mul_f32 v21, v233, v21
    v_mul_f32 v22, v233, v22
    v_mul_f32 v23, v233, v23
    v_mul_f32 v24, v233, v24
    v_mul_f32 v25, v233, v25
    v_mul_f32 v26, v233, v26
    v_mul_f32 v27, v233, v27
    s_nop 1
    s_waitcnt vmcnt(12)
    s_nop 0
    v_mfma_f32_32x32x16_bf16 v[16:31], v[156:159], v[32:35], v[16:31]
    v_fma_f32 v48, v48, s51, v234
    v_fma_f32 v49, v49, s51, v234
    v_fma_f32 v50, v50, s51, v234
    v_fma_f32 v51, v51, s51, v234
    v_fma_f32 v52, v52, s51, v234
    v_fma_f32 v53, v53, s51, v234
    v_fma_f32 v54, v54, s51, v234
    v_fma_f32 v55, v55, s51, v234
    v_fma_f32 v56, v56, s51, v234
    v_fma_f32 v57, v57, s51, v234
    v_fma_f32 v58, v58, s51, v234
    v_fma_f32 v59, v59, s51, v234
    v_fma_f32 v60, v60, s51, v234
    v_fma_f32 v61, v61, s51, v234
    v_fma_f32 v62, v62, s51, v234
    v_fma_f32 v63, v63, s51, v234
    v_mfma_f32_32x32x16_bf16 v[16:31], v[160:163], v[36:39], v[16:31]
    v_exp_f32 v48, v48
    v_exp_f32 v49, v49
    v_exp_f32 v50, v50
    v_exp_f32 v51, v51
    v_exp_f32 v52, v52
    v_exp_f32 v53, v53
    v_exp_f32 v54, v54
    v_exp_f32 v55, v55
    v_exp_f32 v56, v56
    v_exp_f32 v57, v57
    v_exp_f32 v58, v58
    v_exp_f32 v59, v59
    v_exp_f32 v60, v60
    v_exp_f32 v61, v61
    v_exp_f32 v62, v62
    v_exp_f32 v63, v63
    s_nop 1
    v_cvt_pk_bf16_f32 v48, v48, v49
    v_cvt_pk_bf16_f32 v49, v50, v51
    v_cvt_pk_bf16_f32 v50, v52, v53
    v_cvt_pk_bf16_f32 v51, v54, v55
    v_cvt_pk_bf16_f32 v52, v56, v57
    v_cvt_pk_bf16_f32 v53, v58, v59
    v_cvt_pk_bf16_f32 v54, v60, v61
    v_cvt_pk_bf16_f32 v55, v62, v63
    s_waitcnt vmcnt(10)
    s_nop 0
    v_mfma_f32_32x32x16_bf16 v[16:31], v[164:167], v[48:51], v[16:31]
    v_fma_f32 v64, v64, s51, v234
    v_fma_f32 v65, v65, s51, v234
    v_fma_f32 v66, v66, s51, v234
    v_fma_f32 v67, v67, s51, v234
    v_fma_f32 v68, v68, s51, v234
    v_fma_f32 v69, v69, s51, v234
    v_fma_f32 v70, v70, s51, v234
    v_fma_f32 v71, v71, s51, v234
    v_fma_f32 v72, v72, s51, v234
    v_fma_f32 v73, v73, s51, v234
    v_fma_f32 v74, v74, s51, v234
    v_fma_f32 v75, v75, s51, v234
    v_fma_f32 v76, v76, s51, v234
    v_fma_f32 v77, v77, s51, v234
    v_fma_f32 v78, v78, s51, v234
    v_fma_f32 v79, v79, s51, v234
    v_mfma_f32_32x32x16_bf16 v[16:31], v[168:171], v[52:55], v[16:31]
    v_exp_f32 v64, v64
    v_exp_f32 v65, v65
    v_exp_f32 v66, v66
    v_exp_f32 v67, v67
    v_exp_f32 v68, v68
    v_exp_f32 v69, v69
    v_exp_f32 v70, v70
    v_exp_f32 v71, v71
    v_exp_f32 v72, v72
    v_exp_f32 v73, v73
    v_exp_f32 v74, v74
    v_exp_f32 v75, v75
    v_exp_f32 v76, v76
    v_exp_f32 v77, v77
    v_exp_f32 v78, v78
    v_exp_f32 v79, v79
    s_nop 1
    v_cvt_pk_bf16_f32 v64, v64, v65
    v_cvt_pk_bf16_f32 v65, v66, v67
    v_cvt_pk_bf16_f32 v66, v68, v69
    v_cvt_pk_bf16_f32 v67, v70, v71
    v_cvt_pk_bf16_f32 v68, v72, v73
    v_cvt_pk_bf16_f32 v69, v74, v75
    v_cvt_pk_bf16_f32 v70, v76, v77
    v_cvt_pk_bf16_f32 v71, v78, v79
    s_waitcnt vmcnt(8)
    s_nop 0
    v_mfma_f32_32x32x16_bf16 v[16:31], v[172:175], v[64:67], v[16:31]
    s_nop 13
    v_mfma_f32_32x32x16_bf16 v[16:31], v[176:179], v[68:71], v[16:31]
    s_nop 3
    v_cndmask_b32 v64, v228, v229, s[64:65]
    v_cndmask_b32 v65, v228, v229, s[66:67]
    v_cndmask_b32 v66, v228, v229, s[68:69]
    v_cndmask_b32 v67, v228, v229, s[70:71]
    v_cndmask_b32 v68, v228, v229, s[72:73]
    v_cndmask_b32 v69, v228, v229, s[74:75]
    v_cndmask_b32 v70, v228, v229, s[76:77]
    v_cndmask_b32 v71, v228, v229, s[78:79]
    v_cndmask_b32 v72, v228, v229, s[80:81]
    v_cndmask_b32 v73, v228, v229, s[82:83]
    v_cndmask_b32 v74, v228, v229, s[84:85]
    v_cndmask_b32 v75, v228, v229, s[86:87]
    v_cndmask_b32 v76, v228, v229, s[88:89]
    v_cndmask_b32 v77, v228, v229, s[90:91]
    v_cndmask_b32 v78, v228, v229, s[92:93]
    v_cndmask_b32 v79, v228, v229, s[94:95]
    s_add_i32 s49, s45, -2
    s_cmp_lt_i32 s49, 0
    s_cbranch_scc1 AT_INV_25
    v_mfma_f32_32x32x16_bf16 v[32:47], v[104:107], v[212:215], 0
    s_branch AT_NXT_26
AT_INV_25:
    v_mov_b32 v32, v228
    v_mov_b32 v33, v228
    v_mov_b32 v34, v228
    v_mov_b32 v35, v228
    v_mov_b32 v36, v228
    v_mov_b32 v37, v228
    v_mov_b32 v38, v228
    v_mov_b32 v39, v228
    v_mov_b32 v40, v228
    v_mov_b32 v41, v228
    v_mov_b32 v42, v228
    v_mov_b32 v43, v228
    v_mov_b32 v44, v228
    v_mov_b32 v45, v228
    v_mov_b32 v46, v228
    v_mov_b32 v47, v228
AT_NXT_26:
    s_add_i32 s49, s45, -1
    s_cmp_lt_i32 s49, 0
    s_cbranch_scc1 AT_INV_27
    v_mfma_f32_32x32x16_bf16 v[48:63], v[108:111], v[212:215], 0
    s_branch AT_NXT_28
AT_INV_27:
    v_mov_b32 v48, v228
    v_mov_b32 v49, v228
    v_mov_b32 v50, v228
    v_mov_b32 v51, v228
    v_mov_b32 v52, v228
    v_mov_b32 v53, v228
    v_mov_b32 v54, v228
    v_mov_b32 v55, v228
    v_mov_b32 v56, v228
    v_mov_b32 v57, v228
    v_mov_b32 v58, v228
    v_mov_b32 v59, v228
    v_mov_b32 v60, v228
    v_mov_b32 v61, v228
    v_mov_b32 v62, v228
    v_mov_b32 v63, v228
AT_NXT_28:
    v_mfma_f32_32x32x16_bf16 v[64:79], v[112:115], v[212:215], v[64:79]
    s_nop 11
    s_add_i32 s49, s45, -2
    s_cmp_lt_i32 s49, 0
    s_cbranch_scc1 AT_NXT_30
    v_mfma_f32_32x32x8_bf16 v[32:47], v[126:127], v[216:217], v[32:47]
AT_NXT_30:
    s_add_i32 s49, s45, -1
    s_cmp_lt_i32 s49, 0
    s_cbranch_scc1 AT_NXT_32
    v_mfma_f32_32x32x8_bf16 v[48:63], v[126:127], v[218:219], v[48:63]
AT_NXT_32:
    v_mfma_f32_32x32x8_bf16 v[64:79], v[128:129], v[216:217], v[64:79]
    s_nop 13
    v_max3_f32 v230, v32, v33, v34
    v_max3_f32 v232, v35, v36, v37
    v_max3_f32 v230, v230, v38, v39
    v_max3_f32 v232, v232, v40, v41
    v_max3_f32 v230, v230, v42, v43
    v_max3_f32 v232, v232, v44, v45
    v_max3_f32 v230, v230, v46, v47
    v_max3_f32 v232, v232, v48, v49
    v_max3_f32 v230, v230, v50, v51
    v_max3_f32 v232, v232, v52, v53
    v_max3_f32 v230, v230, v54, v55
    v_max3_f32 v232, v232, v56, v57
    v_max3_f32 v230, v230, v58, v59
    v_max3_f32 v232, v232, v60, v61
    v_max3_f32 v230, v230, v62, v63
    v_max3_f32 v232, v232, v64, v65
    v_max3_f32 v230, v230, v66, v67
    v_max3_f32 v232, v232, v68, v69
    v_max3_f32 v230, v230, v70, v71
    v_max3_f32 v232, v232, v72, v73
    v_max3_f32 v230, v230, v74, v75
    v_max3_f32 v232, v232, v76, v77
    v_max3_f32 v230, v230, v78, v79
    v_max3_f32 v230, v230, v232, v231
    v_mov_b32 v232, v230
    s_nop 1
    v_permlane32_swap_b32 v230, v232
    s_nop 0
    v_max_f32 v230, v230, v232
    v_mul_f32 v234, s51, v230
    v_sub_f32 v234, 0, v234
    v_sub_f32 v233, v234, v242
    v_exp_f32 v233, v233
    v_mov_b32 v231, v230
    v_mov_b32 v242, v234
    v_fma_f32 v32, v32, s51, v234
    v_fma_f32 v33, v33, s51, v234
    v_fma_f32 v34, v34, s51, v234
    v_fma_f32 v35, v35, s51, v234
    v_fma_f32 v36, v36, s51, v234
    v_fma_f32 v37, v37, s51, v234
    v_fma_f32 v38, v38, s51, v234
    v_fma_f32 v39, v39, s51, v234
    v_fma_f32 v40, v40, s51, v234
    v_fma_f32 v41, v41, s51, v234
    v_fma_f32 v42, v42, s51, v234
    v_fma_f32 v43, v43, s51, v234
    v_fma_f32 v44, v44, s51, v234
    v_fma_f32 v45, v45, s51, v234
    v_fma_f32 v46, v46, s51, v234
    v_fma_f32 v47, v47, s51, v234
    v_exp_f32 v32, v32
    v_exp_f32 v33, v33
    v_exp_f32 v34, v34
    v_exp_f32 v35, v35
    v_exp_f32 v36, v36
    v_exp_f32 v37, v37
    v_exp_f32 v38, v38
    v_exp_f32 v39, v39
    v_exp_f32 v40, v40
    v_exp_f32 v41, v41
    v_exp_f32 v42, v42
    v_exp_f32 v43, v43
    v_exp_f32 v44, v44
    v_exp_f32 v45, v45
    v_exp_f32 v46, v46
    v_exp_f32 v47, v47
    s_nop 1
    v_cvt_pk_bf16_f32 v32, v32, v33
    v_cvt_pk_bf16_f32 v33, v34, v35
    v_cvt_pk_bf16_f32 v34, v36, v37
    v_cvt_pk_bf16_f32 v35, v38, v39
    v_cvt_pk_bf16_f32 v36, v40, v41
    v_cvt_pk_bf16_f32 v37, v42, v43
    v_cvt_pk_bf16_f32 v38, v44, v45
    v_cvt_pk_bf16_f32 v39, v46, v47
    v_mul_f32 v16, v233, v16
    v_mul_f32 v17, v233, v17
    v_mul_f32 v18, v233, v18
    v_mul_f32 v19, v233, v19
    v_mul_f32 v20, v233, v20
    v_mul_f32 v21, v233, v21
    v_mul_f32 v22, v233, v22
    v_mul_f32 v23, v233, v23
    v_mul_f32 v24, v233, v24
    v_mul_f32 v25, v233, v25
    v_mul_f32 v26, v233, v26
    v_mul_f32 v27, v233, v27
    s_nop 1
    s_waitcnt vmcnt(6)
    s_nop 0
    v_mfma_f32_32x32x16_bf16 v[16:31], v[180:183], v[32:35], v[16:31]
    v_fma_f32 v48, v48, s51, v234
    v_fma_f32 v49, v49, s51, v234
    v_fma_f32 v50, v50, s51, v234
    v_fma_f32 v51, v51, s51, v234
    v_fma_f32 v52, v52, s51, v234
    v_fma_f32 v53, v53, s51, v234
    v_fma_f32 v54, v54, s51, v234
    v_fma_f32 v55, v55, s51, v234
    v_fma_f32 v56, v56, s51, v234
    v_fma_f32 v57, v57, s51, v234
    v_fma_f32 v58, v58, s51, v234
    v_fma_f32 v59, v59, s51, v234
    v_fma_f32 v60, v60, s51, v234
    v_fma_f32 v61, v61, s51, v234
    v_fma_f32 v62, v62, s51, v234
    v_fma_f32 v63, v63, s51, v234
    v_mfma_f32_32x32x16_bf16 v[16:31], v[184:187], v[36:39], v[16:31]
    v_exp_f32 v48, v48
    v_exp_f32 v49, v49
    v_exp_f32 v50, v50
    v_exp_f32 v51, v51
    v_exp_f32 v52, v52
    v_exp_f32 v53, v53
    v_exp_f32 v54, v54
    v_exp_f32 v55, v55
    v_exp_f32 v56, v56
    v_exp_f32 v57, v57
    v_exp_f32 v58, v58
    v_exp_f32 v59, v59
    v_exp_f32 v60, v60
    v_exp_f32 v61, v61
    v_exp_f32 v62, v62
    v_exp_f32 v63, v63
    s_nop 1
    v_cvt_pk_bf16_f32 v48, v48, v49
    v_cvt_pk_bf16_f32 v49, v50, v51
    v_cvt_pk_bf16_f32 v50, v52, v53
    v_cvt_pk_bf16_f32 v51, v54, v55
    v_cvt_pk_bf16_f32 v52, v56, v57
    v_cvt_pk_bf16_f32 v53, v58, v59
    v_cvt_pk_bf16_f32 v54, v60, v61
    v_cvt_pk_bf16_f32 v55, v62, v63
    s_waitcnt vmcnt(4)
    s_nop 0
    v_mfma_f32_32x32x16_bf16 v[16:31], v[188:191], v[48:51], v[16:31]
    v_fma_f32 v64, v64, s51, v234
    v_fma_f32 v65, v65, s51, v234
    v_fma_f32 v66, v66, s51, v234
    v_fma_f32 v67, v67, s51, v234
    v_fma_f32 v68, v68, s51, v234
    v_fma_f32 v69, v69, s51, v234
    v_fma_f32 v70, v70, s51, v234
    v_fma_f32 v71, v71, s51, v234
    v_fma_f32 v72, v72, s51, v234
    v_fma_f32 v73, v73, s51, v234
    v_fma_f32 v74, v74, s51, v234
    v_fma_f32 v75, v75, s51, v234
    v_fma_f32 v76, v76, s51, v234
    v_fma_f32 v77, v77, s51, v234
    v_fma_f32 v78, v78, s51, v234
    v_fma_f32 v79, v79, s51, v234
    v_mfma_f32_32x32x16_bf16 v[16:31], v[192:195], v[52:55], v[16:31]
    v_exp_f32 v64, v64
    v_exp_f32 v65, v65
    v_exp_f32 v66, v66
    v_exp_f32 v67, v67
    v_exp_f32 v68, v68
    v_exp_f32 v69, v69
    v_exp_f32 v70, v70
    v_exp_f32 v71, v71
    v_exp_f32 v72, v72
    v_exp_f32 v73, v73
    v_exp_f32 v74, v74
    v_exp_f32 v75, v75
    v_exp_f32 v76, v76
    v_exp_f32 v77, v77
    v_exp_f32 v78, v78
    v_exp_f32 v79, v79
    s_nop 1
    v_cvt_pk_bf16_f32 v64, v64, v65
    v_cvt_pk_bf16_f32 v65, v66, v67
    v_cvt_pk_bf16_f32 v66, v68, v69
    v_cvt_pk_bf16_f32 v67, v70, v71
    v_cvt_pk_bf16_f32 v68, v72, v73
    v_cvt_pk_bf16_f32 v69, v74, v75
    v_cvt_pk_bf16_f32 v70, v76, v77
    v_cvt_pk_bf16_f32 v71, v78, v79
    s_waitcnt vmcnt(2)
    s_nop 0
    v_mfma_f32_32x32x16_bf16 v[16:31], v[196:199], v[64:67], v[16:31]
    s_nop 13
    v_mfma_f32_32x32x16_bf16 v[16:31], v[200:203], v[68:71], v[16:31]
    s_nop 3
    s_nop 15
    v_mov_b32 v232, v24
    v_mov_b32 v233, v24
    s_nop 1
    v_permlane32_swap_b32 v232, v233
    s_nop 0
    v_rcp_f32 v233, v233
    s_nop 5
    v_mul_f32 v16, v233, v16
    v_mul_f32 v17, v233, v17
    v_mul_f32 v18, v233, v18
    v_mul_f32 v19, v233, v19
    v_mul_f32 v20, v233, v20
    v_mul_f32 v21, v233, v21
    v_mul_f32 v22, v233, v22
    v_mul_f32 v23, v233, v23
    v_mul_f32 v24, v233, v24
    v_mul_f32 v25, v233, v25
    v_mul_f32 v26, v233, v26
    v_mul_f32 v27, v233, v27
    v_cvt_pk_bf16_f32 v236, v16, v17
    v_cvt_pk_bf16_f32 v237, v18, v19
    v_cvt_pk_bf16_f32 v238, v20, v21
    v_cvt_pk_bf16_f32 v239, v22, v23
    v_cvt_pk_bf16_f32 v240, v24, v25
    v_cvt_pk_bf16_f32 v241, v26, v27
    s_add_u32 s49, s45, 0
    s_lshl_b32 s49, s49, 1
    v_lshrrev_b32 v244, 4, v12
    v_add_u32 v244, s49, v244
    v_mul_u32_u24 v244, 20, v244
    v_and_b32 v245, 15, v12
    s_mul_i32 s49, s44, 5
    v_add_u32 v246, s49, v13
    v_lshrrev_b32 v247, 3, v246
    v_add_u32 v247, v244, v247
    v_lshlrev_b32 v247, 10, v247
    v_bfe_u32 v248, v246, 1, 2
    v_lshl_add_u32 v248, v248, 4, v245
    v_lshl_add_u32 v247, v248, 4, v247
    v_and_b32 v248, 1, v246
    v_lshl_add_u32 v247, v248, 3, v247
    buffer_store_dwordx2 v[236:237], v247, s[40:43], 0 offen sc1
    v_add_u32 v246, s49, v13
    v_add_u32 v246, 2, v246
    v_lshrrev_b32 v247, 3, v246
    v_add_u32 v247, v244, v247
    v_lshlrev_b32 v247, 10, v247
    v_bfe_u32 v248, v246, 1, 2
    v_lshl_add_u32 v248, v248, 4, v245
    v_lshl_add_u32 v247, v248, 4, v247
    v_and_b32 v248, 1, v246
    v_lshl_add_u32 v247, v248, 3, v247
    buffer_store_dwordx2 v[238:239], v247, s[40:43], 0 offen sc1
    v_add_u32 v246, s49, v13
    v_add_u32 v246, 4, v246
    v_lshrrev_b32 v247, 3, v246
    v_add_u32 v247, v244, v247
    v_lshlrev_b32 v247, 10, v247
    v_bfe_u32 v248, v246, 1, 2
    v_lshl_add_u32 v248, v248, 4, v245
    v_lshl_add_u32 v247, v248, 4, v247
    v_and_b32 v248, 1, v246
    v_lshl_add_u32 v247, v248, 3, v247
    v_cmp_eq_u32 vcc, 0, v13
    s_nop 1
    v_cndmask_b32 v247, v11, v247, vcc
    buffer_store_dwordx2 v[240:241], v247, s[40:43], 0 offen sc1
    v_cndmask_b32 v32, v229, v228, s[64:65]
    v_cndmask_b32 v33, v229, v228, s[66:67]
    v_cndmask_b32 v34, v229, v228, s[68:69]
    v_cndmask_b32 v35, v229, v228, s[70:71]
    v_cndmask_b32 v36, v229, v228, s[72:73]
    v_cndmask_b32 v37, v229, v228, s[74:75]
    v_cndmask_b32 v38, v229, v228, s[76:77]
    v_cndmask_b32 v39, v229, v228, s[78:79]
    v_cndmask_b32 v40, v229, v228, s[80:81]
    v_cndmask_b32 v41, v229, v228, s[82:83]
    v_cndmask_b32 v42, v229, v228, s[84:85]
    v_cndmask_b32 v43, v229, v228, s[86:87]
    v_cndmask_b32 v44, v229, v228, s[88:89]
    v_cndmask_b32 v45, v229, v228, s[90:91]
    v_cndmask_b32 v46, v229, v228, s[92:93]
    v_cndmask_b32 v47, v229, v228, s[94:95]
    s_add_i32 s49, s45, -7
    s_cmp_lt_i32 s49, 0
    s_cbranch_scc1 AT_INV_33
    v_mfma_f32_32x32x16_bf16 v[32:47], v[84:87], v[220:223], v[32:47]
    s_branch AT_NXT_34
AT_INV_33:
    v_mov_b32 v32, v228
    v_mov_b32 v33, v228
    v_mov_b32 v34, v228
    v_mov_b32 v35, v228
    v_mov_b32 v36, v228
    v_mov_b32 v37, v228
    v_mov_b32 v38, v228
    v_mov_b32 v39, v228
    v_mov_b32 v40, v228
    v_mov_b32 v41, v228
    v_mov_b32 v42, v228
    v_mov_b32 v43, v228
    v_mov_b32 v44, v228
    v_mov_b32 v45, v228
    v_mov_b32 v46, v228
    v_mov_b32 v47, v228
AT_NXT_34:
    s_add_i32 s49, s45, -6
    s_cmp_lt_i32 s49, 0
    s_cbranch_scc1 AT_INV_35
    v_mfma_f32_32x32x16_bf16 v[48:63], v[88:91], v[220:223], 0
    s_branch AT_NXT_36
AT_INV_35:
    v_mov_b32 v48, v228
    v_mov_b32 v49, v228
    v_mov_b32 v50, v228
    v_mov_b32 v51, v228
    v_mov_b32 v52, v228
    v_mov_b32 v53, v228
    v_mov_b32 v54, v228
    v_mov_b32 v55, v228
    v_mov_b32 v56, v228
    v_mov_b32 v57, v228
    v_mov_b32 v58, v228
    v_mov_b32 v59, v228
    v_mov_b32 v60, v228
    v_mov_b32 v61, v228
    v_mov_b32 v62, v228
    v_mov_b32 v63, v228
AT_NXT_36:
    s_add_i32 s49, s45, -5
    s_cmp_lt_i32 s49, 0
    s_cbranch_scc1 AT_INV_37
    v_mfma_f32_32x32x16_bf16 v[64:79], v[92:95], v[220:223], 0
    s_branch AT_NXT_38
AT_INV_37:
    v_mov_b32 v64, v228
    v_mov_b32 v65, v228
    v_mov_b32 v66, v228
    v_mov_b32 v67, v228
    v_mov_b32 v68, v228
    v_mov_b32 v69, v228
    v_mov_b32 v70, v228
    v_mov_b32 v71, v228
    v_mov_b32 v72, v228
    v_mov_b32 v73, v228
    v_mov_b32 v74, v228
    v_mov_b32 v75, v228
    v_mov_b32 v76, v228
    v_mov_b32 v77, v228
    v_mov_b32 v78, v228
    v_mov_b32 v79, v228
AT_NXT_38:
    s_nop 11
    s_add_i32 s49, s45, -7
    s_cmp_lt_i32 s49, 0
    s_cbranch_scc1 AT_NXT_40
    v_mfma_f32_32x32x8_bf16 v[32:47], v[120:121], v[226:227], v[32:47]
AT_NXT_40:
    s_add_i32 s49, s45, -6
    s_cmp_lt_i32 s49, 0
    s_cbranch_scc1 AT_NXT_42
    v_mfma_f32_32x32x8_bf16 v[48:63], v[122:123], v[224:225], v[48:63]
AT_NXT_42:
    s_add_i32 s49, s45, -5
    s_cmp_lt_i32 s49, 0
    s_cbranch_scc1 AT_NXT_44
    v_mfma_f32_32x32x8_bf16 v[64:79], v[122:123], v[226:227], v[64:79]
AT_NXT_44:
    s_nop 13
    v_max3_f32 v230, v32, v33, v34
    v_max3_f32 v232, v35, v36, v37
    v_max3_f32 v230, v230, v38, v39
    v_max3_f32 v232, v232, v40, v41
    v_max3_f32 v230, v230, v42, v43
    v_max3_f32 v232, v232, v44, v45
    v_max3_f32 v230, v230, v46, v47
    v_max3_f32 v232, v232, v48, v49
    v_max3_f32 v230, v230, v50, v51
    v_max3_f32 v232, v232, v52, v53
    v_max3_f32 v230, v230, v54, v55
    v_max3_f32 v232, v232, v56, v57
    v_max3_f32 v230, v230, v58, v59
    v_max3_f32 v232, v232, v60, v61
    v_max3_f32 v230, v230, v62, v63
    v_max3_f32 v232, v232, v64, v65
    v_max3_f32 v230, v230, v66, v67
    v_max3_f32 v232, v232, v68, v69
    v_max3_f32 v230, v230, v70, v71
    v_max3_f32 v232, v232, v72, v73
    v_max3_f32 v230, v230, v74, v75
    v_max3_f32 v232, v232, v76, v77
    v_max3_f32 v230, v230, v78, v79
    v_max3_f32 v230, v230, v232, v235
    v_mov_b32 v232, v230
    s_nop 1
    v_permlane32_swap_b32 v230, v232
    s_nop 0
    v_max_f32 v230, v230, v232
    v_mul_f32 v234, s51, v230
    v_sub_f32 v234, 0, v234
    v_mov_b32 v231, v230
    v_mov_b32 v242, v234
    v_fma_f32 v32, v32, s51, v234
    v_fma_f32 v33, v33, s51, v234
    v_fma_f32 v34, v34, s51, v234
    v_fma_f32 v35, v35, s51, v234
    v_fma_f32 v36, v36, s51, v234
    v_fma_f32 v37, v37, s51, v234
    v_fma_f32 v38, v38, s51, v234
    v_fma_f32 v39, v39, s51, v234
    v_fma_f32 v40, v40, s51, v234
    v_fma_f32 v41, v41, s51, v234
    v_fma_f32 v42, v42, s51, v234
    v_fma_f32 v43, v43, s51, v234
    v_fma_f32 v44, v44, s51, v234
    v_fma_f32 v45, v45, s51, v234
    v_fma_f32 v46, v46, s51, v234
    v_fma_f32 v47, v47, s51, v234
    v_exp_f32 v32, v32
    v_exp_f32 v33, v33
    v_exp_f32 v34, v34
    v_exp_f32 v35, v35
    v_exp_f32 v36, v36
    v_exp_f32 v37, v37
    v_exp_f32 v38, v38
    v_exp_f32 v39, v39
    v_exp_f32 v40, v40
    v_exp_f32 v41, v41
    v_exp_f32 v42, v42
    v_exp_f32 v43, v43
    v_exp_f32 v44, v44
    v_exp_f32 v45, v45
    v_exp_f32 v46, v46
    v_exp_f32 v47, v47
    s_nop 1
    v_cvt_pk_bf16_f32 v32, v32, v33
    v_cvt_pk_bf16_f32 v33, v34, v35
    v_cvt_pk_bf16_f32 v34, v36, v37
    v_cvt_pk_bf16_f32 v35, v38, v39
    v_cvt_pk_bf16_f32 v36, v40, v41
    v_cvt_pk_bf16_f32 v37, v42, v43
    v_cvt_pk_bf16_f32 v38, v44, v45
    v_cvt_pk_bf16_f32 v39, v46, v47
    s_nop 0
    v_mfma_f32_32x32x16_bf16 v[16:31], v[140:143], v[32:35], 0
    v_fma_f32 v48, v48, s51, v234
    v_fma_f32 v49, v49, s51, v234
    v_fma_f32 v50, v50, s51, v234
    v_fma_f32 v51, v51, s51, v234
    v_fma_f32 v52, v52, s51, v234
    v_fma_f32 v53, v53, s51, v234
    v_fma_f32 v54, v54, s51, v234
    v_fma_f32 v55, v55, s51, v234
    v_fma_f32 v56, v56, s51, v234
    v_fma_f32 v57, v57, s51, v234
    v_fma_f32 v58, v58, s51, v234
    v_fma_f32 v59, v59, s51, v234
    v_fma_f32 v60, v60, s51, v234
    v_fma_f32 v61, v61, s51, v234
    v_fma_f32 v62, v62, s51, v234
    v_fma_f32 v63, v63, s51, v234
    v_mfma_f32_32x32x16_bf16 v[16:31], v[144:147], v[36:39], v[16:31]
    v_exp_f32 v48, v48
    v_exp_f32 v49, v49
    v_exp_f32 v50, v50
    v_exp_f32 v51, v51
    v_exp_f32 v52, v52
    v_exp_f32 v53, v53
    v_exp_f32 v54, v54
    v_exp_f32 v55, v55
    v_exp_f32 v56, v56
    v_exp_f32 v57, v57
    v_exp_f32 v58, v58
    v_exp_f32 v59, v59
    v_exp_f32 v60, v60
    v_exp_f32 v61, v61
    v_exp_f32 v62, v62
    v_exp_f32 v63, v63
    s_nop 1
    v_cvt_pk_bf16_f32 v48, v48, v49
    v_cvt_pk_bf16_f32 v49, v50, v51
    v_cvt_pk_bf16_f32 v50, v52, v53
    v_cvt_pk_bf16_f32 v51, v54, v55
    v_cvt_pk_bf16_f32 v52, v56, v57
    v_cvt_pk_bf16_f32 v53, v58, v59
    v_cvt_pk_bf16_f32 v54, v60, v61
    v_cvt_pk_bf16_f32 v55, v62, v63
    s_nop 0
    v_mfma_f32_32x32x16_bf16 v[16:31], v[148:151], v[48:51], v[16:31]
    v_fma_f32 v64, v64, s51, v234
    v_fma_f32 v65, v65, s51, v234
    v_fma_f32 v66, v66, s51, v234
    v_fma_f32 v67, v67, s51, v234
    v_fma_f32 v68, v68, s51, v234
    v_fma_f32 v69, v69, s51, v234
    v_fma_f32 v70, v70, s51, v234
    v_fma_f32 v71, v71, s51, v234
    v_fma_f32 v72, v72, s51, v234
    v_fma_f32 v73, v73, s51, v234
    v_fma_f32 v74, v74, s51, v234
    v_fma_f32 v75, v75, s51, v234
    v_fma_f32 v76, v76, s51, v234
    v_fma_f32 v77, v77, s51, v234
    v_fma_f32 v78, v78, s51, v234
    v_fma_f32 v79, v79, s51, v234
    v_mfma_f32_32x32x16_bf16 v[16:31], v[152:155], v[52:55], v[16:31]
    v_exp_f32 v64, v64
    v_exp_f32 v65, v65
    v_exp_f32 v66, v66
    v_exp_f32 v67, v67
    v_exp_f32 v68, v68
    v_exp_f32 v69, v69
    v_exp_f32 v70, v70
    v_exp_f32 v71, v71
    v_exp_f32 v72, v72
    v_exp_f32 v73, v73
    v_exp_f32 v74, v74
    v_exp_f32 v75, v75
    v_exp_f32 v76, v76
    v_exp_f32 v77, v77
    v_exp_f32 v78, v78
    v_exp_f32 v79, v79
    s_nop 1
    v_cvt_pk_bf16_f32 v64, v64, v65
    v_cvt_pk_bf16_f32 v65, v66, v67
    v_cvt_pk_bf16_f32 v66, v68, v69
    v_cvt_pk_bf16_f32 v67, v70, v71
    v_cvt_pk_bf16_f32 v68, v72, v73
    v_cvt_pk_bf16_f32 v69, v74, v75
    v_cvt_pk_bf16_f32 v70, v76, v77
    v_cvt_pk_bf16_f32 v71, v78, v79
    s_nop 0
    v_mfma_f32_32x32x16_bf16 v[16:31], v[156:159], v[64:67], v[16:31]
    s_nop 13
    v_mfma_f32_32x32x16_bf16 v[16:31], v[160:163], v[68:71], v[16:31]
    s_nop 3
    s_add_i32 s49, s45, -4
    s_cmp_lt_i32 s49, 0
    s_cbranch_scc1 AT_INV_45
    v_mfma_f32_32x32x16_bf16 v[32:47], v[96:99], v[220:223], 0
    s_branch AT_NXT_46
AT_INV_45:
    v_mov_b32 v32, v228
    v_mov_b32 v33, v228
    v_mov_b32 v34, v228
    v_mov_b32 v35, v228
    v_mov_b32 v36, v228
    v_mov_b32 v37, v228
    v_mov_b32 v38, v228
    v_mov_b32 v39, v228
    v_mov_b32 v40, v228
    v_mov_b32 v41, v228
    v_mov_b32 v42, v228
    v_mov_b32 v43, v228
    v_mov_b32 v44, v228
    v_mov_b32 v45, v228
    v_mov_b32 v46, v228
    v_mov_b32 v47, v228
AT_NXT_46:
    s_add_i32 s49, s45, -3
    s_cmp_lt_i32 s49, 0
    s_cbranch_scc1 AT_INV_47
    v_mfma_f32_32x32x16_bf16 v[48:63], v[100:103], v[220:223], 0
    s_branch AT_NXT_48
AT_INV_47:
    v_mov_b32 v48, v228
    v_mov_b32 v49, v228
    v_mov_b32 v50, v228
    v_mov_b32 v51, v228
    v_mov_b32 v52, v228
    v_mov_b32 v53, v228
    v_mov_b32 v54, v228
    v_mov_b32 v55, v228
    v_mov_b32 v56, v228
    v_mov_b32 v57, v228
    v_mov_b32 v58, v228
    v_mov_b32 v59, v228
    v_mov_b32 v60, v228
    v_mov_b32 v61, v228
    v_mov_b32 v62, v228
    v_mov_b32 v63, v228
AT_NXT_48:
    s_add_i32 s49, s45, -2
    s_cmp_lt_i32 s49, 0
    s_cbranch_scc1 AT_INV_49
    v_mfma_f32_32x32x16_bf16 v[64:79], v[104:107], v[220:223], 0
    s_branch AT_NXT_50
AT_INV_49:
    v_mov_b32 v64, v228
    v_mov_b32 v65, v228
    v_mov_b32 v66, v228
    v_mov_b32 v67, v228
    v_mov_b32 v68, v228
    v_mov_b32 v69, v228
    v_mov_b32 v70, v228
    v_mov_b32 v71, v228
    v_mov_b32 v72, v228
    v_mov_b32 v73, v228
    v_mov_b32 v74, v228
    v_mov_b32 v75, v228
    v_mov_b32 v76, v228
    v_mov_b32 v77, v228
    v_mov_b32 v78, v228
    v_mov_b32 v79, v228
AT_NXT_50:
    s_nop 11
    s_add_i32 s49, s45, -4
    s_cmp_lt_i32 s49, 0
    s_cbranch_scc1 AT_NXT_52
    v_mfma_f32_32x32x8_bf16 v[32:47], v[124:125], v[224:225], v[32:47]
AT_NXT_52:
    s_add_i32 s49, s45, -3
    s_cmp_lt_i32 s49, 0
    s_cbranch_scc1 AT_NXT_54
    v_mfma_f32_32x32x8_bf16 v[48:63], v[124:125], v[226:227], v[48:63]
AT_NXT_54:
    s_add_i32 s49, s45, -2
    s_cmp_lt_i32 s49, 0
    s_cbranch_scc1 AT_NXT_56
    v_mfma_f32_32x32x8_bf16 v[64:79], v[126:127], v[224:225], v[64:79]
AT_NXT_56:
    s_nop 13
    v_max3_f32 v230, v32, v33, v34
    v_max3_f32 v232, v35, v36, v37
    v_max3_f32 v230, v230, v38, v39
    v_max3_f32 v232, v232, v40, v41
    v_max3_f32 v230, v230, v42, v43
    v_max3_f32 v232, v232, v44, v45
    v_max3_f32 v230, v230, v46, v47
    v_max3_f32 v232, v232, v48, v49
    v_max3_f32 v230, v230, v50, v51
    v_max3_f32 v232, v232, v52, v53
    v_max3_f32 v230, v230, v54, v55
    v_max3_f32 v232, v232, v56, v57
    v_max3_f32 v230, v230, v58, v59
    v_max3_f32 v232, v232, v60, v61
    v_max3_f32 v230, v230, v62, v63
    v_max3_f32 v232, v232, v64, v65
    v_max3_f32 v230, v230, v66, v67
    v_max3_f32 v232, v232, v68, v69
    v_max3_f32 v230, v230, v70, v71
    v_max3_f32 v232, v232, v72, v73
    v_max3_f32 v230, v230, v74, v75
    v_max3_f32 v232, v232, v76, v77
    v_max3_f32 v230, v230, v78, v79
    v_max3_f32 v230, v230, v232, v231
    v_mov_b32 v232, v230
    s_nop 1
    v_permlane32_swap_b32 v230, v232
    s_nop 0
    v_max_f32 v230, v230, v232
    v_mul_f32 v234, s51, v230
    v_sub_f32 v234, 0, v234
    v_sub_f32 v233, v234, v242
    v_exp_f32 v233, v233
    v_mov_b32 v231, v230
    v_mov_b32 v242, v234
    v_fma_f32 v32, v32, s51, v234
    v_fma_f32 v33, v33, s51, v234
    v_fma_f32 v34, v34, s51, v234
    v_fma_f32 v35, v35, s51, v234
    v_fma_f32 v36, v36, s51, v234
    v_fma_f32 v37, v37, s51, v234
    v_fma_f32 v38, v38, s51, v234
    v_fma_f32 v39, v39, s51, v234
    v_fma_f32 v40, v40, s51, v234
    v_fma_f32 v41, v41, s51, v234
    v_fma_f32 v42, v42, s51, v234
    v_fma_f32 v43, v43, s51, v234
    v_fma_f32 v44, v44, s51, v234
    v_fma_f32 v45, v45, s51, v234
    v_fma_f32 v46, v46, s51, v234
    v_fma_f32 v47, v47, s51, v234
    v_exp_f32 v32, v32
    v_exp_f32 v33, v33
    v_exp_f32 v34, v34
    v_exp_f32 v35, v35
    v_exp_f32 v36, v36
    v_exp_f32 v37, v37
    v_exp_f32 v38, v38
    v_exp_f32 v39, v39
    v_exp_f32 v40, v40
    v_exp_f32 v41, v41
    v_exp_f32 v42, v42
    v_exp_f32 v43, v43
    v_exp_f32 v44, v44
    v_exp_f32 v45, v45
    v_exp_f32 v46, v46
    v_exp_f32 v47, v47
    s_nop 1
    v_cvt_pk_bf16_f32 v32, v32, v33
    v_cvt_pk_bf16_f32 v33, v34, v35
    v_cvt_pk_bf16_f32 v34, v36, v37
    v_cvt_pk_bf16_f32 v35, v38, v39
    v_cvt_pk_bf16_f32 v36, v40, v41
    v_cvt_pk_bf16_f32 v37, v42, v43
    v_cvt_pk_bf16_f32 v38, v44, v45
    v_cvt_pk_bf16_f32 v39, v46, v47
    v_mul_f32 v16, v233, v16
    v_mul_f32 v17, v233, v17
    v_mul_f32 v18, v233, v18
    v_mul_f32 v19, v233, v19
    v_mul_f32 v20, v233, v20
    v_mul_f32 v21, v233, v21
    v_mul_f32 v22, v233, v22
    v_mul_f32 v23, v233, v23
    v_mul_f32 v24, v233, v24
    v_mul_f32 v25, v233, v25
    v_mul_f32 v26, v233, v26
    v_mul_f32 v27, v233, v27
    s_nop 1
    s_nop 0
    v_mfma_f32_32x32x16_bf16 v[16:31], v[164:167], v[32:35], v[16:31]
    v_fma_f32 v48, v48, s51, v234
    v_fma_f32 v49, v49, s51, v234
    v_fma_f32 v50, v50, s51, v234
    v_fma_f32 v51, v51, s51, v234
    v_fma_f32 v52, v52, s51, v234
    v_fma_f32 v53, v53, s51, v234
    v_fma_f32 v54, v54, s51, v234
    v_fma_f32 v55, v55, s51, v234
    v_fma_f32 v56, v56, s51, v234
    v_fma_f32 v57, v57, s51, v234
    v_fma_f32 v58, v58, s51, v234
    v_fma_f32 v59, v59, s51, v234
    v_fma_f32 v60, v60, s51, v234
    v_fma_f32 v61, v61, s51, v234
    v_fma_f32 v62, v62, s51, v234
    v_fma_f32 v63, v63, s51, v234
    v_mfma_f32_32x32x16_bf16 v[16:31], v[168:171], v[36:39], v[16:31]
    v_exp_f32 v48, v48
    v_exp_f32 v49, v49
    v_exp_f32 v50, v50
    v_exp_f32 v51, v51
    v_exp_f32 v52, v52
    v_exp_f32 v53, v53
    v_exp_f32 v54, v54
    v_exp_f32 v55, v55
    v_exp_f32 v56, v56
    v_exp_f32 v57, v57
    v_exp_f32 v58, v58
    v_exp_f32 v59, v59
    v_exp_f32 v60, v60
    v_exp_f32 v61, v61
    v_exp_f32 v62, v62
    v_exp_f32 v63, v63
    s_nop 1
    v_cvt_pk_bf16_f32 v48, v48, v49
    v_cvt_pk_bf16_f32 v49, v50, v51
    v_cvt_pk_bf16_f32 v50, v52, v53
    v_cvt_pk_bf16_f32 v51, v54, v55
    v_cvt_pk_bf16_f32 v52, v56, v57
    v_cvt_pk_bf16_f32 v53, v58, v59
    v_cvt_pk_bf16_f32 v54, v60, v61
    v_cvt_pk_bf16_f32 v55, v62, v63
    s_nop 0
    v_mfma_f32_32x32x16_bf16 v[16:31], v[172:175], v[48:51], v[16:31]
    v_fma_f32 v64, v64, s51, v234
    v_fma_f32 v65, v65, s51, v234
    v_fma_f32 v66, v66, s51, v234
    v_fma_f32 v67, v67, s51, v234
    v_fma_f32 v68, v68, s51, v234
    v_fma_f32 v69, v69, s51, v234
    v_fma_f32 v70, v70, s51, v234
    v_fma_f32 v71, v71, s51, v234
    v_fma_f32 v72, v72, s51, v234
    v_fma_f32 v73, v73, s51, v234
    v_fma_f32 v74, v74, s51, v234
    v_fma_f32 v75, v75, s51, v234
    v_fma_f32 v76, v76, s51, v234
    v_fma_f32 v77, v77, s51, v234
    v_fma_f32 v78, v78, s51, v234
    v_fma_f32 v79, v79, s51, v234
    v_mfma_f32_32x32x16_bf16 v[16:31], v[176:179], v[52:55], v[16:31]
    v_exp_f32 v64, v64
    v_exp_f32 v65, v65
    v_exp_f32 v66, v66
    v_exp_f32 v67, v67
    v_exp_f32 v68, v68
    v_exp_f32 v69, v69
    v_exp_f32 v70, v70
    v_exp_f32 v71, v71
    v_exp_f32 v72, v72
    v_exp_f32 v73, v73
    v_exp_f32 v74, v74
    v_exp_f32 v75, v75
    v_exp_f32 v76, v76
    v_exp_f32 v77, v77
    v_exp_f32 v78, v78
    v_exp_f32 v79, v79
    s_nop 1
    v_cvt_pk_bf16_f32 v64, v64, v65
    v_cvt_pk_bf16_f32 v65, v66, v67
    v_cvt_pk_bf16_f32 v66, v68, v69
    v_cvt_pk_bf16_f32 v67, v70, v71
    v_cvt_pk_bf16_f32 v68, v72, v73
    v_cvt_pk_bf16_f32 v69, v74, v75
    v_cvt_pk_bf16_f32 v70, v76, v77
    v_cvt_pk_bf16_f32 v71, v78, v79
    s_nop 0
    v_mfma_f32_32x32x16_bf16 v[16:31], v[180:183], v[64:67], v[16:31]
    s_nop 13
    v_mfma_f32_32x32x16_bf16 v[16:31], v[184:187], v[68:71], v[16:31]
    s_nop 3
    v_cndmask_b32 v64, v228, v229, s[64:65]
    v_cndmask_b32 v65, v228, v229, s[66:67]
    v_cndmask_b32 v66, v228, v229, s[68:69]
    v_cndmask_b32 v67, v228, v229, s[70:71]
    v_cndmask_b32 v68, v228, v229, s[72:73]
    v_cndmask_b32 v69, v228, v229, s[74:75]
    v_cndmask_b32 v70, v228, v229, s[76:77]
    v_cndmask_b32 v71, v228, v229, s[78:79]
    v_cndmask_b32 v72, v228, v229, s[80:81]
    v_cndmask_b32 v73, v228, v229, s[82:83]
    v_cndmask_b32 v74, v228, v229, s[84:85]
    v_cndmask_b32 v75, v228, v229, s[86:87]
    v_cndmask_b32 v76, v228, v229, s[88:89]
    v_cndmask_b32 v77, v228, v229, s[90:91]
    v_cndmask_b32 v78, v228, v229, s[92:93]
    v_cndmask_b32 v79, v228, v229, s[94:95]
    s_add_i32 s49, s45, -1
    s_cmp_lt_i32 s49, 0
    s_cbranch_scc1 AT_INV_57
    v_mfma_f32_32x32x16_bf16 v[32:47], v[108:111], v[220:223], 0
    s_branch AT_NXT_58
AT_INV_57:
    v_mov_b32 v32, v228
    v_mov_b32 v33, v228
    v_mov_b32 v34, v228
    v_mov_b32 v35, v228
    v_mov_b32 v36, v228
    v_mov_b32 v37, v228
    v_mov_b32 v38, v228
    v_mov_b32 v39, v228
    v_mov_b32 v40, v228
    v_mov_b32 v41, v228
    v_mov_b32 v42, v228
    v_mov_b32 v43, v228
    v_mov_b32 v44, v228
    v_mov_b32 v45, v228
    v_mov_b32 v46, v228
    v_mov_b32 v47, v228
AT_NXT_58:
    s_add_i32 s49, s45, 0
    s_cmp_lt_i32 s49, 0
    s_cbranch_scc1 AT_INV_59
    v_mfma_f32_32x32x16_bf16 v[48:63], v[112:115], v[220:223], 0
    s_branch AT_NXT_60
AT_INV_59:
    v_mov_b32 v48, v228
    v_mov_b32 v49, v228
    v_mov_b32 v50, v228
    v_mov_b32 v51, v228
    v_mov_b32 v52, v228
    v_mov_b32 v53, v228
    v_mov_b32 v54, v228
    v_mov_b32 v55, v228
    v_mov_b32 v56, v228
    v_mov_b32 v57, v228
    v_mov_b32 v58, v228
    v_mov_b32 v59, v228
    v_mov_b32 v60, v228
    v_mov_b32 v61, v228
    v_mov_b32 v62, v228
    v_mov_b32 v63, v228
AT_NXT_60:
    v_mfma_f32_32x32x16_bf16 v[64:79], v[116:119], v[220:223], v[64:79]
    s_nop 11
    s_add_i32 s49, s45, -1
    s_cmp_lt_i32 s49, 0
    s_cbranch_scc1 AT_NXT_62
    v_mfma_f32_32x32x8_bf16 v[32:47], v[126:127], v[226:227], v[32:47]
AT_NXT_62:
    s_add_i32 s49, s45, 0
    s_cmp_lt_i32 s49, 0
    s_cbranch_scc1 AT_NXT_64
    v_mfma_f32_32x32x8_bf16 v[48:63], v[128:129], v[224:225], v[48:63]
AT_NXT_64:
    v_mfma_f32_32x32x8_bf16 v[64:79], v[128:129], v[226:227], v[64:79]
    s_nop 13
    v_max3_f32 v230, v32, v33, v34
    v_max3_f32 v232, v35, v36, v37
    v_max3_f32 v230, v230, v38, v39
    v_max3_f32 v232, v232, v40, v41
    v_max3_f32 v230, v230, v42, v43
    v_max3_f32 v232, v232, v44, v45
    v_max3_f32 v230, v230, v46, v47
    v_max3_f32 v232, v232, v48, v49
    v_max3_f32 v230, v230, v50, v51
    v_max3_f32 v232, v232, v52, v53
    v_max3_f32 v230, v230, v54, v55
    v_max3_f32 v232, v232, v56, v57
    v_max3_f32 v230, v230, v58, v59
    v_max3_f32 v232, v232, v60, v61
    v_max3_f32 v230, v230, v62, v63
    v_max3_f32 v232, v232, v64, v65
    v_max3_f32 v230, v230, v66, v67
    v_max3_f32 v232, v232, v68, v69
    v_max3_f32 v230, v230, v70, v71
    v_max3_f32 v232, v232, v72, v73
    v_max3_f32 v230, v230, v74, v75
    v_max3_f32 v232, v232, v76, v77
    v_max3_f32 v230, v230, v78, v79
    v_max3_f32 v230, v230, v232, v231
    v_mov_b32 v232, v230
    s_nop 1
    v_permlane32_swap_b32 v230, v232
    s_nop 0
    v_max_f32 v230, v230, v232
    v_mul_f32 v234, s51, v230
    v_sub_f32 v234, 0, v234
    v_sub_f32 v233, v234, v242
    v_exp_f32 v233, v233
    v_mov_b32 v231, v230
    v_mov_b32 v242, v234
    v_fma_f32 v32, v32, s51, v234
    v_fma_f32 v33, v33, s51, v234
    v_fma_f32 v34, v34, s51, v234
    v_fma_f32 v35, v35, s51, v234
    v_fma_f32 v36, v36, s51, v234
    v_fma_f32 v37, v37, s51, v234
    v_fma_f32 v38, v38, s51, v234
    v_fma_f32 v39, v39, s51, v234
    v_fma_f32 v40, v40, s51, v234
    v_fma_f32 v41, v41, s51, v234
    v_fma_f32 v42, v42, s51, v234
    v_fma_f32 v43, v43, s51, v234
    v_fma_f32 v44, v44, s51, v234
    v_fma_f32 v45, v45, s51, v234
    v_fma_f32 v46, v46, s51, v234
    v_fma_f32 v47, v47, s51, v234
    v_exp_f32 v32, v32
    v_exp_f32 v33, v33
    v_exp_f32 v34, v34
    v_exp_f32 v35, v35
    v_exp_f32 v36, v36
    v_exp_f32 v37, v37
    v_exp_f32 v38, v38
    v_exp_f32 v39, v39
    v_exp_f32 v40, v40
    v_exp_f32 v41, v41
    v_exp_f32 v42, v42
    v_exp_f32 v43, v43
    v_exp_f32 v44, v44
    v_exp_f32 v45, v45
    v_exp_f32 v46, v46
    v_exp_f32 v47, v47
    s_nop 1
    v_cvt_pk_bf16_f32 v32, v32, v33
    v_cvt_pk_bf16_f32 v33, v34, v35
    v_cvt_pk_bf16_f32 v34, v36, v37
    v_cvt_pk_bf16_f32 v35, v38, v39
    v_cvt_pk_bf16_f32 v36, v40, v41
    v_cvt_pk_bf16_f32 v37, v42, v43
    v_cvt_pk_bf16_f32 v38, v44, v45
    v_cvt_pk_bf16_f32 v39, v46, v47
    v_mul_f32 v16, v233, v16
    v_mul_f32 v17, v233, v17
    v_mul_f32 v18, v233, v18
    v_mul_f32 v19, v233, v19
    v_mul_f32 v20, v233, v20
    v_mul_f32 v21, v233, v21
    v_mul_f32 v22, v233, v22
    v_mul_f32 v23, v233, v23
    v_mul_f32 v24, v233, v24
    v_mul_f32 v25, v233, v25
    v_mul_f32 v26, v233, v26
    v_mul_f32 v27, v233, v27
    s_nop 1
    s_nop 0
    v_mfma_f32_32x32x16_bf16 v[16:31], v[188:191], v[32:35], v[16:31]
    v_fma_f32 v48, v48, s51, v234
    v_fma_f32 v49, v49, s51, v234
    v_fma_f32 v50, v50, s51, v234
    v_fma_f32 v51, v51, s51, v234
    v_fma_f32 v52, v52, s51, v234
    v_fma_f32 v53, v53, s51, v234
    v_fma_f32 v54, v54, s51, v234
    v_fma_f32 v55, v55, s51, v234
    v_fma_f32 v56, v56, s51, v234
    v_fma_f32 v57, v57, s51, v234
    v_fma_f32 v58, v58, s51, v234
    v_fma_f32 v59, v59, s51, v234
    v_fma_f32 v60, v60, s51, v234
    v_fma_f32 v61, v61, s51, v234
    v_fma_f32 v62, v62, s51, v234
    v_fma_f32 v63, v63, s51, v234
    v_mfma_f32_32x32x16_bf16 v[16:31], v[192:195], v[36:39], v[16:31]
    v_exp_f32 v48, v48
    v_exp_f32 v49, v49
    v_exp_f32 v50, v50
    v_exp_f32 v51, v51
    v_exp_f32 v52, v52
    v_exp_f32 v53, v53
    v_exp_f32 v54, v54
    v_exp_f32 v55, v55
    v_exp_f32 v56, v56
    v_exp_f32 v57, v57
    v_exp_f32 v58, v58
    v_exp_f32 v59, v59
    v_exp_f32 v60, v60
    v_exp_f32 v61, v61
    v_exp_f32 v62, v62
    v_exp_f32 v63, v63
    s_nop 1
    v_cvt_pk_bf16_f32 v48, v48, v49
    v_cvt_pk_bf16_f32 v49, v50, v51
    v_cvt_pk_bf16_f32 v50, v52, v53
    v_cvt_pk_bf16_f32 v51, v54, v55
    v_cvt_pk_bf16_f32 v52, v56, v57
    v_cvt_pk_bf16_f32 v53, v58, v59
    v_cvt_pk_bf16_f32 v54, v60, v61
    v_cvt_pk_bf16_f32 v55, v62, v63
    s_nop 0
    v_mfma_f32_32x32x16_bf16 v[16:31], v[196:199], v[48:51], v[16:31]
    v_fma_f32 v64, v64, s51, v234
    v_fma_f32 v65, v65, s51, v234
    v_fma_f32 v66, v66, s51, v234
    v_fma_f32 v67, v67, s51, v234
    v_fma_f32 v68, v68, s51, v234
    v_fma_f32 v69, v69, s51, v234
    v_fma_f32 v70, v70, s51, v234
    v_fma_f32 v71, v71, s51, v234
    v_fma_f32 v72, v72, s51, v234
    v_fma_f32 v73, v73, s51, v234
    v_fma_f32 v74, v74, s51, v234
    v_fma_f32 v75, v75, s51, v234
    v_fma_f32 v76, v76, s51, v234
    v_fma_f32 v77, v77, s51, v234
    v_fma_f32 v78, v78, s51, v234
    v_fma_f32 v79, v79, s51, v234
    v_mfma_f32_32x32x16_bf16 v[16:31], v[200:203], v[52:55], v[16:31]
    v_exp_f32 v64, v64
    v_exp_f32 v65, v65
    v_exp_f32 v66, v66
    v_exp_f32 v67, v67
    v_exp_f32 v68, v68
    v_exp_f32 v69, v69
    v_exp_f32 v70, v70
    v_exp_f32 v71, v71
    v_exp_f32 v72, v72
    v_exp_f32 v73, v73
    v_exp_f32 v74, v74
    v_exp_f32 v75, v75
    v_exp_f32 v76, v76
    v_exp_f32 v77, v77
    v_exp_f32 v78, v78
    v_exp_f32 v79, v79
    s_nop 1
    v_cvt_pk_bf16_f32 v64, v64, v65
    v_cvt_pk_bf16_f32 v65, v66, v67
    v_cvt_pk_bf16_f32 v66, v68, v69
    v_cvt_pk_bf16_f32 v67, v70, v71
    v_cvt_pk_bf16_f32 v68, v72, v73
    v_cvt_pk_bf16_f32 v69, v74, v75
    v_cvt_pk_bf16_f32 v70, v76, v77
    v_cvt_pk_bf16_f32 v71, v78, v79
    s_waitcnt vmcnt(0)
    s_nop 0
    v_mfma_f32_32x32x16_bf16 v[16:31], v[204:207], v[64:67], v[16:31]
    s_nop 13
    v_mfma_f32_32x32x16_bf16 v[16:31], v[208:211], v[68:71], v[16:31]
    s_nop 3
    s_nop 15
    v_mov_b32 v232, v24
    v_mov_b32 v233, v24
    s_nop 1
    v_permlane32_swap_b32 v232, v233
    s_nop 0
    v_rcp_f32 v233, v233
    s_nop 5
    v_mul_f32 v16, v233, v16
    v_mul_f32 v17, v233, v17
    v_mul_f32 v18, v233, v18
    v_mul_f32 v19, v233, v19
    v_mul_f32 v20, v233, v20
    v_mul_f32 v21, v233, v21
    v_mul_f32 v22, v233, v22
    v_mul_f32 v23, v233, v23
    v_mul_f32 v24, v233, v24
    v_mul_f32 v25, v233, v25
    v_mul_f32 v26, v233, v26
    v_mul_f32 v27, v233, v27
    v_cvt_pk_bf16_f32 v236, v16, v17
    v_cvt_pk_bf16_f32 v237, v18, v19
    v_cvt_pk_bf16_f32 v238, v20, v21
    v_cvt_pk_bf16_f32 v239, v22, v23
    v_cvt_pk_bf16_f32 v240, v24, v25
    v_cvt_pk_bf16_f32 v241, v26, v27
    s_add_u32 s49, s45, 1
    s_lshl_b32 s49, s49, 1
    v_lshrrev_b32 v244, 4, v12
    v_add_u32 v244, s49, v244
    v_mul_u32_u24 v244, 20, v244
    v_and_b32 v245, 15, v12
    s_mul_i32 s49, s44, 5
    v_add_u32 v246, s49, v13
    v_lshrrev_b32 v247, 3, v246
    v_add_u32 v247, v244, v247
    v_lshlrev_b32 v247, 10, v247
    v_bfe_u32 v248, v246, 1, 2
    v_lshl_add_u32 v248, v248, 4, v245
    v_lshl_add_u32 v247, v248, 4, v247
    v_and_b32 v248, 1, v246
    v_lshl_add_u32 v247, v248, 3, v247
    buffer_store_dwordx2 v[236:237], v247, s[40:43], 0 offen sc1
    v_add_u32 v246, s49, v13
    v_add_u32 v246, 2, v246
    v_lshrrev_b32 v247, 3, v246
    v_add_u32 v247, v244, v247
    v_lshlrev_b32 v247, 10, v247
    v_bfe_u32 v248, v246, 1, 2
    v_lshl_add_u32 v248, v248, 4, v245
    v_lshl_add_u32 v247, v248, 4, v247
    v_and_b32 v248, 1, v246
    v_lshl_add_u32 v247, v248, 3, v247
    buffer_store_dwordx2 v[238:239], v247, s[40:43], 0 offen sc1
    v_add_u32 v246, s49, v13
    v_add_u32 v246, 4, v246
    v_lshrrev_b32 v247, 3, v246
    v_add_u32 v247, v244, v247
    v_lshlrev_b32 v247, 10, v247
    v_bfe_u32 v248, v246, 1, 2
    v_lshl_add_u32 v248, v248, 4, v245
    v_lshl_add_u32 v247, v248, 4, v247
    v_and_b32 v248, 1, v246
    v_lshl_add_u32 v247, v248, 3, v247
    v_cmp_eq_u32 vcc, 0, v13
    s_nop 1
    v_cndmask_b32 v247, v11, v247, vcc
    buffer_store_dwordx2 v[240:241], v247, s[40:43], 0 offen sc1
    s_add_u32 s28, s24, 0x2800000
    s_addc_u32 s29, s25, 0
    s_mov_b32 s30, 0xc8000
    s_mov_b32 s31, 0x00020000
    s_add_u32 s32, s24, 0x2200000
    s_addc_u32 s33, s25, 0
    s_mov_b32 s34, 0x1000
    s_mov_b32 s35, 0x00020000
    s_sub_u32 s3, s26, 4
    s_mul_i32 s45, s3, 5
    s_mul_i32 s46, s45, 40
    s_mul_i32 s47, s37, 5
    s_add_u32 s46, s46, s47
    s_lshl_b32 s46, s46, 10
    v_add_u32 v9, 0x1000, v8
    s_waitcnt vmcnt(0)
    s_lshl_b32 s47, s36, 7
    s_lshl_b32 s48, s37, 2
    s_add_u32 s48, s48, s3
    s_lshl_b32 s48, s48, 2
    s_add_u32 s48, s48, s47
    v_mov_b32 v2, 1
    v_mov_b32 v3, s48
    s_mov_b64 exec, 1
    buffer_store_dword v2, v3, s[32:35], 0 offen sc1
    s_mov_b64 exec, -1
    buffer_load_dwordx4 v[96:99], v8, s[28:31], s46 offen offset:0
    buffer_load_dwordx4 v[100:103], v8, s[28:31], s46 offen offset:1024
    buffer_load_dwordx4 v[104:107], v8, s[28:31], s46 offen offset:2048
    buffer_load_dwordx4 v[108:111], v8, s[28:31], s46 offen offset:3072
    buffer_load_dwordx4 v[112:115], v9, s[28:31], s46 offen
    s_add_u32 s46, s46, 40960
    buffer_load_dwordx4 v[116:119], v8, s[28:31], s46 offen offset:0
    buffer_load_dwordx4 v[120:123], v8, s[28:31], s46 offen offset:1024
    buffer_load_dwordx4 v[124:127], v8, s[28:31], s46 offen offset:2048
    buffer_load_dwordx4 v[128:131], v8, s[28:31], s46 offen offset:3072
    buffer_load_dwordx4 v[132:135], v9, s[28:31], s46 offen
    s_add_u32 s46, s46, 40960
    buffer_load_dwordx4 v[136:139], v8, s[28:31], s46 offen offset:0
    buffer_load_dwordx4 v[140:143], v8, s[28:31], s46 offen offset:1024
    buffer_load_dwordx4 v[144:147], v8, s[28:31], s46 offen offset:2048
    buffer_load_dwordx4 v[148:151], v8, s[28:31], s46 offen offset:3072
    buffer_load_dwordx4 v[152:155], v9, s[28:31], s46 offen
    s_add_u32 s46, s46, 40960
    buffer_load_dwordx4 v[156:159], v8, s[28:31], s46 offen offset:0
    buffer_load_dwordx4 v[160:163], v8, s[28:31], s46 offen offset:1024
    buffer_load_dwordx4 v[164:167], v8, s[28:31], s46 offen offset:2048
    buffer_load_dwordx4 v[168:171], v8, s[28:31], s46 offen offset:3072
    buffer_load_dwordx4 v[172:175], v9, s[28:31], s46 offen
    s_add_u32 s46, s46, 40960
    buffer_load_dwordx4 v[176:179], v8, s[28:31], s46 offen offset:0
    buffer_load_dwordx4 v[180:183], v8, s[28:31], s46 offen offset:1024
    buffer_load_dwordx4 v[184:187], v8, s[28:31], s46 offen offset:2048
    buffer_load_dwordx4 v[188:191], v8, s[28:31], s46 offen offset:3072
    buffer_load_dwordx4 v[192:195], v9, s[28:31], s46 offen
    v_and_b32 v3, 31, v1
    v_lshlrev_b32 v3, 2, v3
    v_add_u32 v3, s47, v3
    s_barrier
    s_mov_b32 s49, 0
AT_POLL_65:
    buffer_load_dword v2, v3, s[32:35], 0 offen sc1
    s_waitcnt vmcnt(0)
    v_cmp_ne_u32 vcc, 1, v2
    s_add_u32 s49, s49, 1
    s_cmp_eq_u64 vcc, 0
    s_cbranch_scc1 AT_GO_66
    s_cmp_ge_u32 s49, 0x40000
    s_cbranch_scc1 AT_GO_66
    s_sleep 1
    s_branch AT_POLL_65
AT_GO_66:
    s_lshl_b32 s64, s36, 2
    s_add_u32 s64, s64, 0
    s_mul_i32 s64, s64, 20
    s_add_u32 s64, s64, s45
    s_lshl_b32 s64, s64, 10
    s_lshl_b32 s65, s36, 2
    s_add_u32 s65, s65, 1
    s_mul_i32 s65, s65, 20
    s_add_u32 s65, s65, s45
    s_lshl_b32 s65, s65, 10
    s_lshl_b32 s66, s36, 2
    s_add_u32 s66, s66, 2
    s_mul_i32 s66, s66, 20
    s_add_u32 s66, s66, s45
    s_lshl_b32 s66, s66, 10
    s_lshl_b32 s67, s36, 2
    s_add_u32 s67, s67, 3
    s_mul_i32 s67, s67, 20
    s_add_u32 s67, s67, s45
    s_lshl_b32 s67, s67, 10
    buffer_load_dwordx4 v[16:19], v8, s[40:43], s64 offen offset:0 sc1
    buffer_load_dwordx4 v[20:23], v8, s[40:43], s65 offen offset:0 sc1
    buffer_load_dwordx4 v[24:27], v8, s[40:43], s66 offen offset:0 sc1
    buffer_load_dwordx4 v[28:31], v8, s[40:43], s67 offen offset:0 sc1
    buffer_load_dwordx4 v[32:35], v8, s[40:43], s64 offen offset:1024 sc1
    buffer_load_dwordx4 v[36:39], v8, s[40:43], s65 offen offset:1024 sc1
    buffer_load_dwordx4 v[40:43], v8, s[40:43], s66 offen offset:1024 sc1
    buffer_load_dwordx4 v[44:47], v8, s[40:43], s67 offen offset:1024 sc1
    buffer_load_dwordx4 v[48:51], v8, s[40:43], s64 offen offset:2048 sc1
    buffer_load_dwordx4 v[52:55], v8, s[40:43], s65 offen offset:2048 sc1
    buffer_load_dwordx4 v[56:59], v8, s[40:43], s66 offen offset:2048 sc1
    buffer_load_dwordx4 v[60:63], v8, s[40:43], s67 offen offset:2048 sc1
    buffer_load_dwordx4 v[64:67], v8, s[40:43], s64 offen offset:3072 sc1
    buffer_load_dwordx4 v[68:71], v8, s[40:43], s65 offen offset:3072 sc1
    buffer_load_dwordx4 v[72:75], v8, s[40:43], s66 offen offset:3072 sc1
    buffer_load_dwordx4 v[76:79], v8, s[40:43], s67 offen offset:3072 sc1
    buffer_load_dwordx4 v[80:83], v9, s[40:43], s64 offen sc1
    buffer_load_dwordx4 v[84:87], v9, s[40:43], s65 offen sc1
    buffer_load_dwordx4 v[88:91], v9, s[40:43], s66 offen sc1
    buffer_load_dwordx4 v[92:95], v9, s[40:43], s67 offen sc1
    s_waitcnt vmcnt(16)
    v_mfma_f32_16x16x32_bf16 v[196:199], v[96:99], v[16:19], 0
    v_mfma_f32_16x16x32_bf16 v[200:203], v[96:99], v[20:23], 0
    v_mfma_f32_16x16x32_bf16 v[204:207], v[96:99], v[24:27], 0
    v_mfma_f32_16x16x32_bf16 v[208:211], v[96:99], v[28:31], 0
    v_mfma_f32_16x16x32_bf16 v[212:215], v[100:103], v[16:19], 0
    v_mfma_f32_16x16x32_bf16 v[216:219], v[100:103], v[20:23], 0
    v_mfma_f32_16x16x32_bf16 v[220:223], v[100:103], v[24:27], 0
    v_mfma_f32_16x16x32_bf16 v[224:227], v[100:103], v[28:31], 0
    v_mfma_f32_16x16x32_bf16 v[228:231], v[104:107], v[16:19], 0
    v_mfma_f32_16x16x32_bf16 v[232:235], v[104:107], v[20:23], 0
    v_mfma_f32_16x16x32_bf16 v[236:239], v[104:107], v[24:27], 0
    v_mfma_f32_16x16x32_bf16 v[240:243], v[104:107], v[28:31], 0
    s_waitcnt vmcnt(12)
    v_mfma_f32_16x16x32_bf16 v[196:199], v[116:119], v[32:35], v[196:199]
    v_mfma_f32_16x16x32_bf16 v[200:203], v[116:119], v[36:39], v[200:203]
    v_mfma_f32_16x16x32_bf16 v[204:207], v[116:119], v[40:43], v[204:207]
    v_mfma_f32_16x16x32_bf16 v[208:211], v[116:119], v[44:47], v[208:211]
    v_mfma_f32_16x16x32_bf16 v[212:215], v[120:123], v[32:35], v[212:215]
    v_mfma_f32_16x16x32_bf16 v[216:219], v[120:123], v[36:39], v[216:219]
    v_mfma_f32_16x16x32_bf16 v[220:223], v[120:123], v[40:43], v[220:223]
    v_mfma_f32_16x16x32_bf16 v[224:227], v[120:123], v[44:47], v[224:227]
    v_mfma_f32_16x16x32_bf16 v[228:231], v[124:127], v[32:35], v[228:231]
    v_mfma_f32_16x16x32_bf16 v[232:235], v[124:127], v[36:39], v[232:235]
    v_mfma_f32_16x16x32_bf16 v[236:239], v[124:127], v[40:43], v[236:239]
    v_mfma_f32_16x16x32_bf16 v[240:243], v[124:127], v[44:47], v[240:243]
    s_waitcnt vmcnt(8)
    v_mfma_f32_16x16x32_bf16 v[196:199], v[136:139], v[48:51], v[196:199]
    v_mfma_f32_16x16x32_bf16 v[200:203], v[136:139], v[52:55], v[200:203]
    v_mfma_f32_16x16x32_bf16 v[204:207], v[136:139], v[56:59], v[204:207]
    v_mfma_f32_16x16x32_bf16 v[208:211], v[136:139], v[60:63], v[208:211]
    v_mfma_f32_16x16x32_bf16 v[212:215], v[140:143], v[48:51], v[212:215]
    v_mfma_f32_16x16x32_bf16 v[216:219], v[140:143], v[52:55], v[216:219]
    v_mfma_f32_16x16x32_bf16 v[220:223], v[140:143], v[56:59], v[220:223]
    v_mfma_f32_16x16x32_bf16 v[224:227], v[140:143], v[60:63], v[224:227]
    v_mfma_f32_16x16x32_bf16 v[228:231], v[144:147], v[48:51], v[228:231]
    v_mfma_f32_16x16x32_bf16 v[232:235], v[144:147], v[52:55], v[232:235]
    v_mfma_f32_16x16x32_bf16 v[236:239], v[144:147], v[56:59], v[236:239]
    v_mfma_f32_16x16x32_bf16 v[240:243], v[144:147], v[60:63], v[240:243]
    s_waitcnt vmcnt(4)
    v_mfma_f32_16x16x32_bf16 v[196:199], v[156:159], v[64:67], v[196:199]
    v_mfma_f32_16x16x32_bf16 v[200:203], v[156:159], v[68:71], v[200:203]
    v_mfma_f32_16x16x32_bf16 v[204:207], v[156:159], v[72:75], v[204:207]
    v_mfma_f32_16x16x32_bf16 v[208:211], v[156:159], v[76:79], v[208:211]
    v_mfma_f32_16x16x32_bf16 v[212:215], v[160:163], v[64:67], v[212:215]
    v_mfma_f32_16x16x32_bf16 v[216:219], v[160:163], v[68:71], v[216:219]
    v_mfma_f32_16x16x32_bf16 v[220:223], v[160:163], v[72:75], v[220:223]
    v_mfma_f32_16x16x32_bf16 v[224:227], v[160:163], v[76:79], v[224:227]
    v_mfma_f32_16x16x32_bf16 v[228:231], v[164:167], v[64:67], v[228:231]
    v_mfma_f32_16x16x32_bf16 v[232:235], v[164:167], v[68:71], v[232:235]
    v_mfma_f32_16x16x32_bf16 v[236:239], v[164:167], v[72:75], v[236:239]
    v_mfma_f32_16x16x32_bf16 v[240:243], v[164:167], v[76:79], v[240:243]
    s_waitcnt vmcnt(0)
    v_mfma_f32_16x16x32_bf16 v[196:199], v[176:179], v[80:83], v[196:199]
    v_mfma_f32_16x16x32_bf16 v[200:203], v[176:179], v[84:87], v[200:203]
    v_mfma_f32_16x16x32_bf16 v[204:207], v[176:179], v[88:91], v[204:207]
    v_mfma_f32_16x16x32_bf16 v[208:211], v[176:179], v[92:95], v[208:211]
    v_mfma_f32_16x16x32_bf16 v[212:215], v[180:183], v[80:83], v[212:215]
    v_mfma_f32_16x16x32_bf16 v[216:219], v[180:183], v[84:87], v[216:219]
    v_mfma_f32_16x16x32_bf16 v[220:223], v[180:183], v[88:91], v[220:223]
    v_mfma_f32_16x16x32_bf16 v[224:227], v[180:183], v[92:95], v[224:227]
    v_mfma_f32_16x16x32_bf16 v[228:231], v[184:187], v[80:83], v[228:231]
    v_mfma_f32_16x16x32_bf16 v[232:235], v[184:187], v[84:87], v[232:235]
    v_mfma_f32_16x16x32_bf16 v[236:239], v[184:187], v[88:91], v[236:239]
    v_mfma_f32_16x16x32_bf16 v[240:243], v[184:187], v[92:95], v[240:243]
    s_nop 9
    s_mul_i32 s39, s3, 20480
    s_add_u32 s39, s39, 81920
    v_add_u32 v11, s39, v8
    ds_write_b128 v11, v[196:199] offset:0
    ds_write_b128 v11, v[200:203] offset:5120
    ds_write_b128 v11, v[204:207] offset:10240
    ds_write_b128 v11, v[208:211] offset:15360
    ds_write_b128 v11, v[212:215] offset:1024
    ds_write_b128 v11, v[216:219] offset:6144
    ds_write_b128 v11, v[220:223] offset:11264
    ds_write_b128 v11, v[224:227] offset:16384
    ds_write_b128 v11, v[228:231] offset:2048
    ds_write_b128 v11, v[232:235] offset:7168
    ds_write_b128 v11, v[236:239] offset:12288
    ds_write_b128 v11, v[240:243] offset:17408
    s_waitcnt lgkmcnt(0)
    v_mfma_f32_16x16x32_bf16 v[196:199], v[108:111], v[16:19], 0
    v_mfma_f32_16x16x32_bf16 v[200:203], v[108:111], v[20:23], 0
    v_mfma_f32_16x16x32_bf16 v[204:207], v[108:111], v[24:27], 0
    v_mfma_f32_16x16x32_bf16 v[208:211], v[108:111], v[28:31], 0
    v_mfma_f32_16x16x32_bf16 v[212:215], v[112:115], v[16:19], 0
    v_mfma_f32_16x16x32_bf16 v[216:219], v[112:115], v[20:23], 0
    v_mfma_f32_16x16x32_bf16 v[220:223], v[112:115], v[24:27], 0
    v_mfma_f32_16x16x32_bf16 v[224:227], v[112:115], v[28:31], 0
    v_mfma_f32_16x16x32_bf16 v[196:199], v[128:131], v[32:35], v[196:199]
    v_mfma_f32_16x16x32_bf16 v[200:203], v[128:131], v[36:39], v[200:203]
    v_mfma_f32_16x16x32_bf16 v[204:207], v[128:131], v[40:43], v[204:207]
    v_mfma_f32_16x16x32_bf16 v[208:211], v[128:131], v[44:47], v[208:211]
    v_mfma_f32_16x16x32_bf16 v[212:215], v[132:135], v[32:35], v[212:215]
    v_mfma_f32_16x16x32_bf16 v[216:219], v[132:135], v[36:39], v[216:219]
    v_mfma_f32_16x16x32_bf16 v[220:223], v[132:135], v[40:43], v[220:223]
    v_mfma_f32_16x16x32_bf16 v[224:227], v[132:135], v[44:47], v[224:227]
    v_mfma_f32_16x16x32_bf16 v[196:199], v[148:151], v[48:51], v[196:199]
    v_mfma_f32_16x16x32_bf16 v[200:203], v[148:151], v[52:55], v[200:203]
    v_mfma_f32_16x16x32_bf16 v[204:207], v[148:151], v[56:59], v[204:207]
    v_mfma_f32_16x16x32_bf16 v[208:211], v[148:151], v[60:63], v[208:211]
    v_mfma_f32_16x16x32_bf16 v[212:215], v[152:155], v[48:51], v[212:215]
    v_mfma_f32_16x16x32_bf16 v[216:219], v[152:155], v[52:55], v[216:219]
    v_mfma_f32_16x16x32_bf16 v[220:223], v[152:155], v[56:59], v[220:223]
    v_mfma_f32_16x16x32_bf16 v[224:227], v[152:155], v[60:63], v[224:227]
    v_mfma_f32_16x16x32_bf16 v[196:199], v[168:171], v[64:67], v[196:199]
    v_mfma_f32_16x16x32_bf16 v[200:203], v[168:171], v[68:71], v[200:203]
    v_mfma_f32_16x16x32_bf16 v[204:207], v[168:171], v[72:75], v[204:207]
    v_mfma_f32_16x16x32_bf16 v[208:211], v[168:171], v[76:79], v[208:211]
    v_mfma_f32_16x16x32_bf16 v[212:215], v[172:175], v[64:67], v[212:215]
    v_mfma_f32_16x16x32_bf16 v[216:219], v[172:175], v[68:71], v[216:219]
    v_mfma_f32_16x16x32_bf16 v[220:223], v[172:175], v[72:75], v[220:223]
    v_mfma_f32_16x16x32_bf16 v[224:227], v[172:175], v[76:79], v[224:227]
    v_mfma_f32_16x16x32_bf16 v[196:199], v[188:191], v[80:83], v[196:199]
    v_mfma_f32_16x16x32_bf16 v[200:203], v[188:191], v[84:87], v[200:203]
    v_mfma_f32_16x16x32_bf16 v[204:207], v[188:191], v[88:91], v[204:207]
    v_mfma_f32_16x16x32_bf16 v[208:211], v[188:191], v[92:95], v[208:211]
    v_mfma_f32_16x16x32_bf16 v[212:215], v[192:195], v[80:83], v[212:215]
    v_mfma_f32_16x16x32_bf16 v[216:219], v[192:195], v[84:87], v[216:219]
    v_mfma_f32_16x16x32_bf16 v[220:223], v[192:195], v[88:91], v[220:223]
    v_mfma_f32_16x16x32_bf16 v[224:227], v[192:195], v[92:95], v[224:227]
    s_nop 9
    ds_write_b128 v11, v[196:199] offset:3072
    ds_write_b128 v11, v[200:203] offset:8192
    ds_write_b128 v11, v[204:207] offset:13312
    ds_write_b128 v11, v[208:211] offset:18432
    ds_write_b128 v11, v[212:215] offset:4096
    ds_write_b128 v11, v[216:219] offset:9216
    ds_write_b128 v11, v[220:223] offset:14336
    ds_write_b128 v11, v[224:227] offset:19456
    s_waitcnt lgkmcnt(0)
    s_barrier
    s_endpgm
K2_END:
    s_endpgm
.section .rodata,"a"
.p2align 6
.amdhsa_kernel k1_kernel
  .amdhsa_next_free_vgpr 256
  .amdhsa_next_free_sgpr 102
  .amdhsa_accum_offset 256
  .amdhsa_group_segment_fixed_size 0
  .amdhsa_kernarg_size 88
  .amdhsa_user_sgpr_count 2
  .amdhsa_user_sgpr_kernarg_segment_ptr 1
  .amdhsa_system_sgpr_workgroup_id_x 1
.end_amdhsa_kernel
.p2align 6
.amdhsa_kernel k2_kernel
  .amdhsa_next_free_vgpr 256
  .amdhsa_next_free_sgpr 102
  .amdhsa_accum_offset 256
  .amdhsa_group_segment_fixed_size 0
  .amdhsa_kernarg_size 88
  .amdhsa_user_sgpr_count 2
  .amdhsa_user_sgpr_kernarg_segment_ptr 1
  .amdhsa_system_sgpr_workgroup_id_x 1
.end_amdhsa_kernel
```
